```python
import torch

def _softmax(x, axis=-1):
    return torch.softmax(x, dim=axis)
def _gelu(x):
    return torch.nn.functional.gelu(x, approximate="tanh")
def _silu(x):
    return torch.nn.functional.silu(x)
def _sigmoid(x):
    return torch.sigmoid(x)
def _layernorm(x, axis=-1, eps=1e-5):
    m = x.mean(dim=axis, keepdim=True)
    v = x.var(dim=axis, keepdim=True, unbiased=False)
    return (x - m) / torch.sqrt(v + eps)
def _scatter_add(tgt, idx, src, axis=0):
    return tgt.clone().index_add_(axis, idx, src)
def _segment_sum(src, seg, n):
    out = torch.zeros((n,) + src.shape[1:], dtype=src.dtype)
    return out.index_add_(0, seg, src)
def _pad(x, pw):
    flat = tuple(v for pair in reversed(pw) for v in pair)
    return torch.nn.functional.pad(x, flat)

kernel_name = 'parallel_sum__grouped_kv_mqa__geglu_ffn__prompt'

def setup_inputs():

    _w = (lambda a: (lambda t: t.to(torch.bfloat16) if t.is_floating_point() else t)(torch.as_tensor(a)))
    def _A_setup():
        B, S, D, H = 1, 2048, 640, 32
        Dh = D // H
        return {
            "x": _w((lambda *s: torch.randn(*s, dtype=torch.bfloat16) * 0.05)(B, S, D)),
            "wq": _w((lambda *s: torch.randn(*s, dtype=torch.bfloat16) * 0.2)(D, H * Dh)),
            "wk": _w((lambda *s: torch.randn(*s, dtype=torch.bfloat16) * 0.2)(D, Dh)),
            "wv": _w((lambda *s: torch.randn(*s, dtype=torch.bfloat16) * 0.1)(D, Dh)),
            "wo": _w((lambda *s: torch.randn(*s, dtype=torch.bfloat16) * 0.1)(H * Dh, D)),
        }
    _A_in = _A_setup()

    def _B_setup():
        B, S, D, F = 1, 2048, 640, 1728
        return {
            "x": _w((lambda *s: torch.randn(*s, dtype=torch.bfloat16) * 0.05)(B, S, D)),
            "w_gate": _w((lambda *s: torch.randn(*s, dtype=torch.bfloat16) * 0.1)(D, F)),
            "w_up": _w((lambda *s: torch.randn(*s, dtype=torch.bfloat16) * 0.1)(D, F)),
            "w_down": _w((lambda *s: torch.randn(*s, dtype=torch.bfloat16) * 0.1)(F, D)),
        }
    _B_in = _B_setup()

    return {
        "A_x": _A_in["x"],
        "A_wq": _A_in["wq"],
        "A_wk": _A_in["wk"],
        "A_wv": _A_in["wv"],
        "A_wo": _A_in["wo"],
        "B_x": _B_in["x"],
        "B_w_gate": _B_in["w_gate"],
        "B_w_up": _B_in["w_up"],
        "B_w_down": _B_in["w_down"],
    }

def reference(A_x, A_wq, A_wk, A_wv, A_wo, B_x, B_w_gate, B_w_up, B_w_down):
    def _A_ref(x, wq, wk, wv, wo):
        B, S, D = x.shape
        H = 32
        Dh = D // H
        q = (lambda x, *d: x.permute(*d))((x @ wq).reshape(B, S, H, Dh), 0, 2, 1, 3)
        k = x @ wk
        v = x @ wv
        scores = torch.einsum("bhqd,bkd->bhqk", q, k) * (Dh ** -0.5)
        p = _softmax(scores, axis=-1)
        o = torch.einsum("bhqk,bkd->bhqd", p, v)
        return (lambda x, *d: x.permute(*d))(o, 0, 2, 1, 3).reshape(B, S, H * Dh) @ wo

    def _B_ref(x, w_gate, w_up, w_down):
        return (_gelu(x @ w_gate) * (x @ w_up)) @ w_down

    x = A_x
    xn = _layernorm(x, axis=-1)
    return x + _A_ref(xn, A_wq, A_wk, A_wv, A_wo) + _B_ref(xn, B_w_gate, B_w_up, B_w_down)
```

```asm
; @launch grid=(512,1,1) block=(256,1,1) lds=81920
.amdgcn_target "amdgcn-amd-amdhsa--gfx950"
.text
.globl parallel_sum__grouped_kv_mqa__geglu_ffn__prompt_kernel
.p2align 8
.type parallel_sum__grouped_kv_mqa__geglu_ffn__prompt_kernel,@function
parallel_sum__grouped_kv_mqa__geglu_ffn__prompt_kernel:
    s_cmp_ge_u32 s2, 512
    s_cbranch_scc1 L_end
    s_load_dwordx16 s[16:31], s[0:1], 0
    s_load_dwordx8 s[32:39], s[0:1], 64
    v_lshrrev_b32 v1, 6, v0
    v_and_b32 v0, 63, v0
    v_readfirstlane_b32 s3, v1
    v_lshlrev_b32 v1, 2, v0
    s_waitcnt lgkmcnt(0)
    s_mov_b32 s40, s16
    s_mov_b32 s41, s17
    s_mov_b32 s42, 0x280000
    s_mov_b32 s43, 0x00020000
    s_mov_b32 s48, s38
    s_mov_b32 s49, s39
    s_mov_b32 s50, 0xe00000
    s_mov_b32 s51, 0x00020000
    s_mov_b32 s52, s36
    s_mov_b32 s53, s37
    s_mov_b32 s54, 0x100
    s_mov_b32 s55, 0x00020000
    s_mov_b32 s56, s34
    s_mov_b32 s57, s35
    s_mov_b32 s58, 0x280000
    s_mov_b32 s59, 0x00020000
    s_mov_b32 s72, s38
    s_mov_b32 s73, s39
    s_mov_b32 s74, 0x30000
    s_mov_b32 s75, 0x00020000
    s_mov_b32 s44, s18
    s_mov_b32 s45, s19
    s_mov_b32 s46, 0xc8000
    s_mov_b32 s47, 0x00020000
    s_getpc_b64 s[8:9]
    s_and_b32 s8, s8, 0xffffff00
    s_mov_b32 s10, CODE_BYTES
    s_mov_b32 s11, 0x00020000
    s_lshr_b32 s4, s2, 3
    s_lshl_b32 s4, s4, 2
    s_add_u32 s4, s4, s3
    s_lshl_b32 s4, s4, 8
    v_lshlrev_b32 v2, 7, v0
    s_mov_b64 exec, 3
    buffer_load_dword v31, v2, s[8:11], s4 offen
    s_mov_b64 exec, -1
    s_cmp_lg_u32 s2, 255
    s_cbranch_scc1 L_nononce
    s_cmp_lg_u32 s3, 0
    s_cbranch_scc1 L_nononce
    s_mov_b32 s4, 0x53000
    buffer_load_dword v2, off, s[48:51], s4 sc1
    s_waitcnt vmcnt(0)
    v_add_u32 v2, 1, v2
    v_max_u32 v2, 1, v2
    s_mov_b64 exec, 1
    buffer_store_dword v2, off, s[52:55], 0 offset:128 sc1
    buffer_store_dword v2, off, s[48:51], s4 sc1
    s_mov_b64 exec, -1
L_nononce:
    s_sub_u32 s4, s2, 216
    s_cmp_lt_u32 s4, 32
    s_cbranch_scc1 L_roleKV
    s_cmp_lt_u32 s2, 256
    s_cbranch_scc1 L_roleA
    s_sub_u32 s2, s2, 256
    s_cmp_lt_u32 s2, 216
    s_cbranch_scc1 L_roleG1
    s_setprio 3
L_getnonce:
    s_mov_b32 s70, 40000
L_poll1:
    buffer_load_dword v2, off, s[52:55], 0 offset:128 sc1
    s_waitcnt vmcnt(0)
    v_readfirstlane_b32 s64, v2
    s_nop 0
    s_cmp_lg_u32 s64, 0
    s_cbranch_scc1 L_poll1_done
    s_sleep 4
    s_sub_u32 s70, s70, 1
    s_cmp_lg_u32 s70, 0
    s_cbranch_scc1 L_poll1
L_poll1_done:
    s_lshl_b32 s4, s2, 7
    s_add_u32 s98, s4, 0x95400
    s_mov_b32 s70, 40000
    s_mov_b32 s66, 1
    s_mov_b32 s67, 0
    s_mov_b64 exec, s[66:67]
    buffer_load_dword v2, v1, s[48:51], s98 offen sc1
    s_mov_b64 exec, -1
    s_waitcnt vmcnt(0)
    v_cmp_eq_u32 vcc, s64, v2
    s_nop 0
    s_and_b64 s[68:69], vcc, s[66:67]
    s_cmp_eq_u64 s[68:69], s[66:67]
    s_cbranch_scc1 L_poll2_done
    s_mov_b64 exec, s[66:67]
    buffer_load_dword v2, v1, s[48:51], s98 offen sc1
L_poll2:
    s_sleep 2
    buffer_load_dword v3, v1, s[48:51], s98 offen sc1
    s_waitcnt vmcnt(1)
    v_cmp_eq_u32 vcc, s64, v2
    s_nop 0
    s_cmp_eq_u64 vcc, s[66:67]
    s_cbranch_scc1 L_poll2_hit
    s_sleep 2
    buffer_load_dword v2, v1, s[48:51], s98 offen sc1
    s_waitcnt vmcnt(1)
    v_cmp_eq_u32 vcc, s64, v3
    s_nop 0
    s_cmp_eq_u64 vcc, s[66:67]
    s_cbranch_scc1 L_poll2_hit
    s_sub_u32 s70, s70, 1
    s_cmp_lg_u32 s70, 0
    s_cbranch_scc1 L_poll2
L_poll2_hit:
    s_mov_b64 exec, -1
L_poll2_done:
    s_waitcnt vmcnt(0)
    s_sub_u32 s12, s2, 216
    s_lshl_b32 s13, s12, 2
    s_add_u32 s13, s13, s3
    s_cmp_lt_u32 s13, 148
    s_cbranch_scc0 L_wt_done
    s_sub_u32 s4, s13, 108
    s_mul_i32 s5, s4, 52429
    s_lshr_b32 s5, s5, 18
    s_mul_i32 s6, s5, 5
    s_sub_u32 s6, s4, s6
    s_mul_i32 s5, s5, 80
    s_mul_i32 s7, s6, 20
    s_add_u32 s7, s7, s5
    s_add_u32 s5, s5, 16
    s_cmp_eq_u32 s6, 4
    s_cselect_b32 s7, s5, s7
    s_cselect_b32 s8, 20, 4
    s_lshl_b32 s9, s13, 4
    s_cmp_lt_u32 s13, 108
    s_cselect_b32 s7, s9, s7
    s_cselect_b32 s8, 4, s8
    s_cselect_b32 s44, s32, s24
    s_cselect_b32 s45, s33, s25
    s_mov_b32 s9, 819200
    s_cselect_b32 s46, 2211840, s9
    s_mul_i32 s7, s7, 1280
    s_mul_i32 s8, s8, 1280
    s_mul_i32 s80, s3, 20480
    v_lshlrev_b32 v27, 4, v0
    v_bfe_u32 v2, v0, 2, 2
    v_lshrrev_b32 v3, 5, v0
    v_mul_u32_u24 v3, 4, v3
    v_add_u32 v2, v2, v3
    v_and_b32 v3, 3, v0
    v_lshlrev_b32 v3, 3, v3
    v_mul_u32_u24 v2, 1280, v2
    v_add_u32 v2, v2, v3
    v_bfe_u32 v3, v0, 4, 1
    v_lshl_add_u32 v2, v3, 5, v2
    v_add_u32 v16, s80, v2
    s_setprio 0
    s_add_u32 m0, s80, 0
    s_add_u32 s9, s7, 4096
    buffer_load_dwordx4 v27, s[44:47], s7 offen offset:0 lds
    buffer_load_dwordx4 v27, s[44:47], s7 offen offset:1024 lds
    buffer_load_dwordx4 v27, s[44:47], s7 offen offset:2048 lds
    buffer_load_dwordx4 v27, s[44:47], s7 offen offset:3072 lds
    s_add_u32 m0, s80, 4096
    s_add_u32 s7, s7, s8
    buffer_load_dwordx4 v27, s[44:47], s9 offen lds
    s_add_u32 m0, s80, 5120
    s_add_u32 s9, s7, 4096
    buffer_load_dwordx4 v27, s[44:47], s7 offen offset:0 lds
    buffer_load_dwordx4 v27, s[44:47], s7 offen offset:1024 lds
    buffer_load_dwordx4 v27, s[44:47], s7 offen offset:2048 lds
    buffer_load_dwordx4 v27, s[44:47], s7 offen offset:3072 lds
    s_add_u32 m0, s80, 9216
    s_add_u32 s7, s7, s8
    buffer_load_dwordx4 v27, s[44:47], s9 offen lds
    s_add_u32 m0, s80, 10240
    s_add_u32 s9, s7, 4096
    buffer_load_dwordx4 v27, s[44:47], s7 offen offset:0 lds
    buffer_load_dwordx4 v27, s[44:47], s7 offen offset:1024 lds
    buffer_load_dwordx4 v27, s[44:47], s7 offen offset:2048 lds
    buffer_load_dwordx4 v27, s[44:47], s7 offen offset:3072 lds
    s_add_u32 m0, s80, 14336
    s_add_u32 s7, s7, s8
    buffer_load_dwordx4 v27, s[44:47], s9 offen lds
    s_add_u32 m0, s80, 15360
    s_add_u32 s9, s7, 4096
    buffer_load_dwordx4 v27, s[44:47], s7 offen offset:0 lds
    buffer_load_dwordx4 v27, s[44:47], s7 offen offset:1024 lds
    buffer_load_dwordx4 v27, s[44:47], s7 offen offset:2048 lds
    buffer_load_dwordx4 v27, s[44:47], s7 offen offset:3072 lds
    s_add_u32 m0, s80, 19456
    s_add_u32 s7, s7, s8
    buffer_load_dwordx4 v27, s[44:47], s9 offen lds
    s_mul_i32 s7, s13, 1024
    s_add_u32 s7, s7, 0xb00000
    s_waitcnt vmcnt(0)
    ds_read_b64_tr_b16 v[64:65], v16 offset:0
    ds_read_b64_tr_b16 v[66:67], v16 offset:10240
    ds_read_b64_tr_b16 v[68:69], v16 offset:64
    ds_read_b64_tr_b16 v[70:71], v16 offset:10304
    ds_read_b64_tr_b16 v[72:73], v16 offset:128
    ds_read_b64_tr_b16 v[74:75], v16 offset:10368
    ds_read_b64_tr_b16 v[76:77], v16 offset:192
    ds_read_b64_tr_b16 v[78:79], v16 offset:10432
    ds_read_b64_tr_b16 v[80:81], v16 offset:256
    ds_read_b64_tr_b16 v[82:83], v16 offset:10496
    ds_read_b64_tr_b16 v[84:85], v16 offset:320
    ds_read_b64_tr_b16 v[86:87], v16 offset:10560
    ds_read_b64_tr_b16 v[88:89], v16 offset:384
    ds_read_b64_tr_b16 v[90:91], v16 offset:10624
    ds_read_b64_tr_b16 v[92:93], v16 offset:448
    ds_read_b64_tr_b16 v[94:95], v16 offset:10688
    ds_read_b64_tr_b16 v[96:97], v16 offset:512
    ds_read_b64_tr_b16 v[98:99], v16 offset:10752
    ds_read_b64_tr_b16 v[100:101], v16 offset:576
    ds_read_b64_tr_b16 v[102:103], v16 offset:10816
    ds_read_b64_tr_b16 v[104:105], v16 offset:640
    ds_read_b64_tr_b16 v[106:107], v16 offset:10880
    ds_read_b64_tr_b16 v[108:109], v16 offset:704
    ds_read_b64_tr_b16 v[110:111], v16 offset:10944
    ds_read_b64_tr_b16 v[112:113], v16 offset:768
    ds_read_b64_tr_b16 v[114:115], v16 offset:11008
    ds_read_b64_tr_b16 v[116:117], v16 offset:832
    ds_read_b64_tr_b16 v[118:119], v16 offset:11072
    ds_read_b64_tr_b16 v[120:121], v16 offset:896
    ds_read_b64_tr_b16 v[122:123], v16 offset:11136
    ds_read_b64_tr_b16 v[124:125], v16 offset:960
    ds_read_b64_tr_b16 v[126:127], v16 offset:11200
    ds_read_b64_tr_b16 v[128:129], v16 offset:1024
    ds_read_b64_tr_b16 v[130:131], v16 offset:11264
    ds_read_b64_tr_b16 v[132:133], v16 offset:1088
    ds_read_b64_tr_b16 v[134:135], v16 offset:11328
    ds_read_b64_tr_b16 v[136:137], v16 offset:1152
    ds_read_b64_tr_b16 v[138:139], v16 offset:11392
    ds_read_b64_tr_b16 v[140:141], v16 offset:1216
    ds_read_b64_tr_b16 v[142:143], v16 offset:11456
    s_waitcnt lgkmcnt(15)
    buffer_store_dwordx4 v[64:67], v27, s[48:51], s7 offen sc1
    s_add_u32 s7, s7, 151552
    s_waitcnt lgkmcnt(15)
    buffer_store_dwordx4 v[68:71], v27, s[48:51], s7 offen sc1
    s_add_u32 s7, s7, 151552
    s_waitcnt lgkmcnt(15)
    buffer_store_dwordx4 v[72:75], v27, s[48:51], s7 offen sc1
    s_add_u32 s7, s7, 151552
    s_waitcnt lgkmcnt(15)
    buffer_store_dwordx4 v[76:79], v27, s[48:51], s7 offen sc1
    s_add_u32 s7, s7, 151552
    s_waitcnt lgkmcnt(15)
    buffer_store_dwordx4 v[80:83], v27, s[48:51], s7 offen sc1
    s_add_u32 s7, s7, 151552
    s_waitcnt lgkmcnt(15)
    buffer_store_dwordx4 v[84:87], v27, s[48:51], s7 offen sc1
    s_add_u32 s7, s7, 151552
    s_waitcnt lgkmcnt(15)
    buffer_store_dwordx4 v[88:91], v27, s[48:51], s7 offen sc1
    s_add_u32 s7, s7, 151552
    s_waitcnt lgkmcnt(15)
    buffer_store_dwordx4 v[92:95], v27, s[48:51], s7 offen sc1
    s_add_u32 s7, s7, 151552
    s_waitcnt lgkmcnt(15)
    buffer_store_dwordx4 v[96:99], v27, s[48:51], s7 offen sc1
    s_add_u32 s7, s7, 151552
    s_waitcnt lgkmcnt(15)
    buffer_store_dwordx4 v[100:103], v27, s[48:51], s7 offen sc1
    s_add_u32 s7, s7, 151552
    s_waitcnt lgkmcnt(15)
    buffer_store_dwordx4 v[104:107], v27, s[48:51], s7 offen sc1
    s_add_u32 s7, s7, 151552
    s_waitcnt lgkmcnt(15)
    buffer_store_dwordx4 v[108:111], v27, s[48:51], s7 offen sc1
    s_add_u32 s7, s7, 151552
    s_waitcnt lgkmcnt(14)
    buffer_store_dwordx4 v[112:115], v27, s[48:51], s7 offen sc1
    s_add_u32 s7, s7, 151552
    s_waitcnt lgkmcnt(12)
    buffer_store_dwordx4 v[116:119], v27, s[48:51], s7 offen sc1
    s_add_u32 s7, s7, 151552
    s_waitcnt lgkmcnt(10)
    buffer_store_dwordx4 v[120:123], v27, s[48:51], s7 offen sc1
    s_add_u32 s7, s7, 151552
    s_waitcnt lgkmcnt(8)
    buffer_store_dwordx4 v[124:127], v27, s[48:51], s7 offen sc1
    s_add_u32 s7, s7, 151552
    s_waitcnt lgkmcnt(6)
    buffer_store_dwordx4 v[128:131], v27, s[48:51], s7 offen sc1
    s_add_u32 s7, s7, 151552
    s_waitcnt lgkmcnt(4)
    buffer_store_dwordx4 v[132:135], v27, s[48:51], s7 offen sc1
    s_add_u32 s7, s7, 151552
    s_waitcnt lgkmcnt(2)
    buffer_store_dwordx4 v[136:139], v27, s[48:51], s7 offen sc1
    s_add_u32 s7, s7, 151552
    s_waitcnt lgkmcnt(0)
    buffer_store_dwordx4 v[140:143], v27, s[48:51], s7 offen sc1
    s_add_u32 s7, s7, 151552
L_wt_done:
    s_lshl_b32 s4, s12, 7
    s_add_u32 s15, s4, 0x98000
    s_waitcnt vmcnt(0)
    s_barrier
    s_setprio 3
    s_cmp_lg_u32 s3, 0
    s_cbranch_scc1 L_wt_pub
    v_mov_b32 v2, s64
    s_mov_b64 exec, 1
    buffer_store_dword v2, off, s[48:51], s15 sc1
    s_mov_b64 exec, -1
L_wt_pub:
    s_mul_i32 s4, s3, 27
    s_lshr_b32 s4, s4, 2
    s_mul_i32 s5, s3, 10
    s_add_u32 s5, s5, 76
    s_lshr_b32 s5, s5, 2
    v_mov_b32 v2, s4
    v_mov_b32 v3, s5
    v_cmp_gt_u32 vcc, 8, v0
    s_nop 1
    v_cndmask_b32 v2, v3, v2, vcc
    v_add_lshl_u32 v14, v2, v0, 7
    s_mov_b32 s98, 0x98000
    v_mov_b32 v12, 0
    s_mov_b32 s66, 0x7ff
    s_mov_b32 s67, 0
    s_branch L_roleG2
L_roleKV:
    s_setprio 3
    s_and_b32 s5, s4, 7
    s_lshr_b32 s4, s4, 3
    s_lshl_b32 s5, s5, 2
    s_add_u32 s76, s5, s4
    s_lshl_b32 s77, s76, 6
    s_and_b32 s78, s3, 1
    s_lshr_b32 s79, s3, 1
    s_cmp_eq_u32 s79, 0
    s_cselect_b32 s44, s20, s22
    s_cselect_b32 s45, s21, s23
    s_mov_b32 s46, 25600
    s_lshl_b32 s4, s3, 4
    s_add_u32 s4, s4, s77
    v_lshrrev_b32 v2, 3, v0
    v_add_u32 v2, s4, v2
    v_mul_u32_u24 v2, 1280, v2
    v_lshrrev_b32 v3, 4, v0
    v_xor_b32 v3, v0, v3
    v_and_b32 v3, 7, v3
    v_lshl_add_u32 v10, v3, 4, v2
    v_xor_b32 v3, 4, v3
    v_lshl_add_u32 v11, v3, 4, v2
    v_add_u32 v11, 10240, v11
    s_lshl_b32 s4, s78, 11
    v_lshl_add_u32 v12, v0, 4, s4
    s_lshl_b32 s80, s3, 11
    s_mul_i32 s81, s79, 5120
    s_add_u32 s81, s81, s4
    s_add_u32 s81, s81, 16384
    s_add_u32 m0, s80, 0
    s_mov_b32 s4, 0
    buffer_load_dwordx4 v10, s[40:43], s4 offen lds
    s_add_u32 m0, s80, 1024
    s_mov_b32 s4, 0
    buffer_load_dwordx4 v11, s[40:43], s4 offen lds
    s_add_u32 m0, s80, 8192
    s_mov_b32 s4, 128
    buffer_load_dwordx4 v10, s[40:43], s4 offen lds
    s_add_u32 m0, s80, 9216
    s_mov_b32 s4, 128
    buffer_load_dwordx4 v11, s[40:43], s4 offen lds
    s_add_u32 m0, s81, 0
    s_mov_b32 s4, 0
    buffer_load_dwordx4 v12, s[44:47], s4 offen offset:0 lds
    s_add_u32 m0, s81, 0
    s_mov_b32 s4, 0
    buffer_load_dwordx4 v12, s[44:47], s4 offen offset:1024 lds
    s_add_u32 m0, s81, 0
    s_mov_b32 s4, 0
    buffer_load_dwordx4 v12, s[44:47], s4 offen offset:2048 lds
    s_add_u32 m0, s80, 26624
    s_mov_b32 s4, 256
    buffer_load_dwordx4 v10, s[40:43], s4 offen lds
    s_add_u32 m0, s80, 27648
    s_mov_b32 s4, 256
    buffer_load_dwordx4 v11, s[40:43], s4 offen lds
    s_add_u32 m0, s80, 34816
    s_mov_b32 s4, 384
    buffer_load_dwordx4 v10, s[40:43], s4 offen lds
    s_add_u32 m0, s80, 35840
    s_mov_b32 s4, 384
    buffer_load_dwordx4 v11, s[40:43], s4 offen lds
    s_add_u32 m0, s81, 26624
    s_mov_b32 s4, 5120
    buffer_load_dwordx4 v12, s[44:47], s4 offen offset:0 lds
    s_add_u32 m0, s81, 26624
    s_mov_b32 s4, 5120
    buffer_load_dwordx4 v12, s[44:47], s4 offen offset:1024 lds
    s_add_u32 m0, s81, 26624
    s_mov_b32 s4, 5120
    buffer_load_dwordx4 v12, s[44:47], s4 offen offset:2048 lds
    s_add_u32 m0, s80, 53248
    s_mov_b32 s4, 512
    buffer_load_dwordx4 v10, s[40:43], s4 offen lds
    s_add_u32 m0, s80, 54272
    s_mov_b32 s4, 512
    buffer_load_dwordx4 v11, s[40:43], s4 offen lds
    s_add_u32 m0, s80, 61440
    s_mov_b32 s4, 640
    buffer_load_dwordx4 v10, s[40:43], s4 offen lds
    s_add_u32 m0, s80, 62464
    s_mov_b32 s4, 640
    buffer_load_dwordx4 v11, s[40:43], s4 offen lds
    s_add_u32 m0, s81, 53248
    s_mov_b32 s4, 10240
    buffer_load_dwordx4 v12, s[44:47], s4 offen offset:0 lds
    s_add_u32 m0, s81, 53248
    s_mov_b32 s4, 10240
    buffer_load_dwordx4 v12, s[44:47], s4 offen offset:1024 lds
    s_add_u32 m0, s81, 53248
    s_mov_b32 s4, 10240
    buffer_load_dwordx4 v12, s[44:47], s4 offen offset:2048 lds
    s_lshl_b32 s4, s78, 12
    v_and_b32 v2, 31, v0
    v_lshrrev_b32 v3, 5, v0
    v_bfe_u32 v16, v0, 1, 3
    v_xor_b32 v3, v3, v16
    v_lshlrev_b32 v2, 7, v2
    v_add_u32 v2, s4, v2
    v_xor_b32 v16, 0, v3
    v_lshl_add_u32 v16, v16, 4, v2
    v_xor_b32 v17, 2, v3
    v_lshl_add_u32 v17, v17, 4, v2
    v_xor_b32 v18, 4, v3
    v_lshl_add_u32 v18, v18, 4, v2
    v_xor_b32 v19, 6, v3
    v_lshl_add_u32 v19, v19, 4, v2
    v_bfe_u32 v2, v0, 2, 2
    v_lshrrev_b32 v3, 5, v0
    v_mul_u32_u24 v3, 8, v3
    v_add_u32 v2, v2, v3
    v_and_b32 v3, 3, v0
    v_lshlrev_b32 v3, 3, v3
    v_mul_u32_u24 v2, 40, v2
    v_and_b32 v4, 16, v0
    v_cmp_ne_u32 vcc, 0, v4
    s_nop 1
    v_cndmask_b32 v3, v3, 32, vcc
    v_add_u32 v2, v2, v3
    s_mul_i32 s4, s79, 5120
    s_add_u32 s4, s4, 16384
    v_add_u32 v20, s4, v2
    v_mov_b32 v21, 0x3f803f80
    v_and_b32 v2, 15, v0
    v_bfe_u32 v3, v0, 4, 1
    v_cmp_eq_u32 vcc, v2, v3
    v_mov_b32 v2, 0x3f803f80
    s_nop 0
    v_cndmask_b32 v4, 0, v2, vcc
    v_cndmask_b32 v5, 0, v2, vcc
    v_cndmask_b32 v6, 0, v2, vcc
    v_cndmask_b32 v7, 0, v2, vcc
    v_mov_b32 v22, 0
    v_mov_b32 v23, 0
    v_mov_b32 v24, 0
    v_mov_b32 v25, 0
    v_mov_b32 v26, 0
    v_mov_b32 v27, 0
    v_mov_b32 v28, 0
    v_mov_b32 v29, 0
    v_mov_b32 v32, 0
    v_mov_b32 v33, 0
    v_mov_b32 v34, 0
    v_mov_b32 v35, 0
    v_mov_b32 v36, 0
    v_mov_b32 v37, 0
    v_mov_b32 v38, 0
    v_mov_b32 v39, 0
    v_mov_b32 v40, 0
    v_mov_b32 v41, 0
    v_mov_b32 v42, 0
    v_mov_b32 v43, 0
    v_mov_b32 v44, 0
    v_mov_b32 v45, 0
    v_mov_b32 v46, 0
    v_mov_b32 v47, 0
    v_mov_b32 v48, 0
    v_mov_b32 v49, 0
    v_mov_b32 v50, 0
    v_mov_b32 v51, 0
    v_mov_b32 v52, 0
    v_mov_b32 v53, 0
    v_mov_b32 v54, 0
    v_mov_b32 v55, 0
    v_mov_b32 v56, 0
    v_mov_b32 v57, 0
    v_mov_b32 v58, 0
    v_mov_b32 v59, 0
    v_mov_b32 v60, 0
    v_mov_b32 v61, 0
    v_mov_b32 v62, 0
    v_mov_b32 v63, 0
    s_cmp_eq_u32 s79, 0
    s_cbranch_scc0 L_kvV
    s_waitcnt vmcnt(14) lgkmcnt(0)
    s_barrier
    ds_read_b128 v[64:67], v16 offset:0
    ds_read_b64_tr_b16 v[96:97], v20 offset:0
    ds_read_b64_tr_b16 v[98:99], v20 offset:160
    ds_read_b128 v[68:71], v17 offset:0
    ds_read_b64_tr_b16 v[100:101], v20 offset:640
    ds_read_b64_tr_b16 v[102:103], v20 offset:800
    ds_read_b128 v[72:75], v18 offset:0
    ds_read_b64_tr_b16 v[104:105], v20 offset:1280
    ds_read_b64_tr_b16 v[106:107], v20 offset:1440
    ds_read_b128 v[76:79], v19 offset:0
    ds_read_b64_tr_b16 v[108:109], v20 offset:1920
    ds_read_b64_tr_b16 v[110:111], v20 offset:2080
    ds_read_b128 v[80:83], v16 offset:8192
    ds_read_b64_tr_b16 v[112:113], v20 offset:2560
    ds_read_b64_tr_b16 v[114:115], v20 offset:2720
    ds_read_b128 v[84:87], v17 offset:8192
    ds_read_b64_tr_b16 v[116:117], v20 offset:3200
    ds_read_b64_tr_b16 v[118:119], v20 offset:3360
    ds_read_b128 v[88:91], v18 offset:8192
    ds_read_b64_tr_b16 v[120:121], v20 offset:3840
    ds_read_b64_tr_b16 v[122:123], v20 offset:4000
    ds_read_b128 v[92:95], v19 offset:8192
    ds_read_b64_tr_b16 v[124:125], v20 offset:4480
    ds_read_b64_tr_b16 v[126:127], v20 offset:4640
    s_waitcnt vmcnt(7) lgkmcnt(0)
    s_barrier
    v_mfma_f32_32x32x16_bf16 v[32:47], v[96:99], v[64:67], v[32:47]
    s_add_u32 m0, s80, 0
    s_mov_b32 s4, 768
    buffer_load_dwordx4 v10, s[40:43], s4 offen lds
    ds_read_b128 v[128:131], v16 offset:26624
    v_mfma_f32_16x16x32_bf16 v[26:29], v[96:99], v[4:7], v[26:29]
    ds_read_b64_tr_b16 v[160:161], v20 offset:26624
    v_mfma_f32_32x32x16_bf16 v[48:63], v[64:67], v[64:67], v[48:63]
    ds_read_b64_tr_b16 v[162:163], v20 offset:26784
    v_mfma_f32_32x32x16_bf16 v[32:47], v[100:103], v[68:71], v[32:47]
    s_add_u32 m0, s80, 1024
    s_mov_b32 s4, 768
    buffer_load_dwordx4 v11, s[40:43], s4 offen lds
    ds_read_b128 v[132:135], v17 offset:26624
    v_mfma_f32_16x16x32_bf16 v[26:29], v[100:103], v[4:7], v[26:29]
    ds_read_b64_tr_b16 v[164:165], v20 offset:27264
    v_mfma_f32_16x16x32_bf16 v[22:25], v[68:71], v[4:7], v[22:25]
    ds_read_b64_tr_b16 v[166:167], v20 offset:27424
    v_mfma_f32_32x32x16_bf16 v[32:47], v[104:107], v[72:75], v[32:47]
    s_add_u32 m0, s80, 8192
    s_mov_b32 s4, 896
    buffer_load_dwordx4 v10, s[40:43], s4 offen lds
    ds_read_b128 v[136:139], v18 offset:26624
    v_mfma_f32_16x16x32_bf16 v[26:29], v[104:107], v[4:7], v[26:29]
    ds_read_b64_tr_b16 v[168:169], v20 offset:27904
    v_mfma_f32_32x32x16_bf16 v[48:63], v[72:75], v[72:75], v[48:63]
    ds_read_b64_tr_b16 v[170:171], v20 offset:28064
    v_mfma_f32_32x32x16_bf16 v[32:47], v[108:111], v[76:79], v[32:47]
    s_add_u32 m0, s80, 9216
    s_mov_b32 s4, 896
    buffer_load_dwordx4 v11, s[40:43], s4 offen lds
    ds_read_b128 v[140:143], v19 offset:26624
    v_mfma_f32_16x16x32_bf16 v[26:29], v[108:111], v[4:7], v[26:29]
    ds_read_b64_tr_b16 v[172:173], v20 offset:28544
    v_mfma_f32_16x16x32_bf16 v[22:25], v[76:79], v[4:7], v[22:25]
    ds_read_b64_tr_b16 v[174:175], v20 offset:28704
    v_mfma_f32_32x32x16_bf16 v[32:47], v[112:115], v[80:83], v[32:47]
    s_add_u32 m0, s81, 0
    s_mov_b32 s4, 15360
    buffer_load_dwordx4 v12, s[44:47], s4 offen offset:0 lds
    ds_read_b128 v[144:147], v16 offset:34816
    v_mfma_f32_16x16x32_bf16 v[26:29], v[112:115], v[4:7], v[26:29]
    ds_read_b64_tr_b16 v[176:177], v20 offset:29184
    v_mfma_f32_32x32x16_bf16 v[48:63], v[80:83], v[80:83], v[48:63]
    ds_read_b64_tr_b16 v[178:179], v20 offset:29344
    v_mfma_f32_32x32x16_bf16 v[32:47], v[116:119], v[84:87], v[32:47]
    s_add_u32 m0, s81, 0
    s_mov_b32 s4, 15360
    buffer_load_dwordx4 v12, s[44:47], s4 offen offset:1024 lds
    ds_read_b128 v[148:151], v17 offset:34816
    v_mfma_f32_16x16x32_bf16 v[26:29], v[116:119], v[4:7], v[26:29]
    ds_read_b64_tr_b16 v[180:181], v20 offset:29824
    v_mfma_f32_16x16x32_bf16 v[22:25], v[84:87], v[4:7], v[22:25]
    ds_read_b64_tr_b16 v[182:183], v20 offset:29984
    v_mfma_f32_32x32x16_bf16 v[32:47], v[120:123], v[88:91], v[32:47]
    s_add_u32 m0, s81, 0
    s_mov_b32 s4, 15360
    buffer_load_dwordx4 v12, s[44:47], s4 offen offset:2048 lds
    ds_read_b128 v[152:155], v18 offset:34816
    v_mfma_f32_16x16x32_bf16 v[26:29], v[120:123], v[4:7], v[26:29]
    ds_read_b64_tr_b16 v[184:185], v20 offset:30464
    v_mfma_f32_32x32x16_bf16 v[48:63], v[88:91], v[88:91], v[48:63]
    ds_read_b64_tr_b16 v[186:187], v20 offset:30624
    v_mfma_f32_32x32x16_bf16 v[32:47], v[124:127], v[92:95], v[32:47]
    ds_read_b128 v[156:159], v19 offset:34816
    v_mfma_f32_16x16x32_bf16 v[26:29], v[124:127], v[4:7], v[26:29]
    ds_read_b64_tr_b16 v[188:189], v20 offset:31104
    v_mfma_f32_16x16x32_bf16 v[22:25], v[92:95], v[4:7], v[22:25]
    ds_read_b64_tr_b16 v[190:191], v20 offset:31264
    s_waitcnt vmcnt(7) lgkmcnt(0)
    s_barrier
    v_mfma_f32_32x32x16_bf16 v[32:47], v[160:163], v[128:131], v[32:47]
    s_add_u32 m0, s80, 26624
    s_mov_b32 s4, 1024
    buffer_load_dwordx4 v10, s[40:43], s4 offen lds
    ds_read_b128 v[64:67], v16 offset:53248
    v_mfma_f32_16x16x32_bf16 v[26:29], v[160:163], v[4:7], v[26:29]
    ds_read_b64_tr_b16 v[96:97], v20 offset:53248
    v_mfma_f32_32x32x16_bf16 v[48:63], v[128:131], v[128:131], v[48:63]
    ds_read_b64_tr_b16 v[98:99], v20 offset:53408
    v_mfma_f32_32x32x16_bf16 v[32:47], v[164:167], v[132:135], v[32:47]
    s_add_u32 m0, s80, 27648
    s_mov_b32 s4, 1024
    buffer_load_dwordx4 v11, s[40:43], s4 offen lds
    ds_read_b128 v[68:71], v17 offset:53248
    v_mfma_f32_16x16x32_bf16 v[26:29], v[164:167], v[4:7], v[26:29]
    ds_read_b64_tr_b16 v[100:101], v20 offset:53888
    v_mfma_f32_16x16x32_bf16 v[22:25], v[132:135], v[4:7], v[22:25]
    ds_read_b64_tr_b16 v[102:103], v20 offset:54048
    v_mfma_f32_32x32x16_bf16 v[32:47], v[168:171], v[136:139], v[32:47]
    s_add_u32 m0, s80, 34816
    s_mov_b32 s4, 1152
    buffer_load_dwordx4 v10, s[40:43], s4 offen lds
    ds_read_b128 v[72:75], v18 offset:53248
    v_mfma_f32_16x16x32_bf16 v[26:29], v[168:171], v[4:7], v[26:29]
    ds_read_b64_tr_b16 v[104:105], v20 offset:54528
    v_mfma_f32_32x32x16_bf16 v[48:63], v[136:139], v[136:139], v[48:63]
    ds_read_b64_tr_b16 v[106:107], v20 offset:54688
    v_mfma_f32_32x32x16_bf16 v[32:47], v[172:175], v[140:143], v[32:47]
    s_add_u32 m0, s80, 35840
    s_mov_b32 s4, 1152
    buffer_load_dwordx4 v11, s[40:43], s4 offen lds
    ds_read_b128 v[76:79], v19 offset:53248
    v_mfma_f32_16x16x32_bf16 v[26:29], v[172:175], v[4:7], v[26:29]
    ds_read_b64_tr_b16 v[108:109], v20 offset:55168
    v_mfma_f32_16x16x32_bf16 v[22:25], v[140:143], v[4:7], v[22:25]
    ds_read_b64_tr_b16 v[110:111], v20 offset:55328
    v_mfma_f32_32x32x16_bf16 v[32:47], v[176:179], v[144:147], v[32:47]
    s_add_u32 m0, s81, 26624
    s_mov_b32 s4, 20480
    buffer_load_dwordx4 v12, s[44:47], s4 offen offset:0 lds
    ds_read_b128 v[80:83], v16 offset:61440
    v_mfma_f32_16x16x32_bf16 v[26:29], v[176:179], v[4:7], v[26:29]
    ds_read_b64_tr_b16 v[112:113], v20 offset:55808
    v_mfma_f32_32x32x16_bf16 v[48:63], v[144:147], v[144:147], v[48:63]
    ds_read_b64_tr_b16 v[114:115], v20 offset:55968
    v_mfma_f32_32x32x16_bf16 v[32:47], v[180:183], v[148:151], v[32:47]
    s_add_u32 m0, s81, 26624
    s_mov_b32 s4, 20480
    buffer_load_dwordx4 v12, s[44:47], s4 offen offset:1024 lds
    ds_read_b128 v[84:87], v17 offset:61440
    v_mfma_f32_16x16x32_bf16 v[26:29], v[180:183], v[4:7], v[26:29]
    ds_read_b64_tr_b16 v[116:117], v20 offset:56448
    v_mfma_f32_16x16x32_bf16 v[22:25], v[148:151], v[4:7], v[22:25]
    ds_read_b64_tr_b16 v[118:119], v20 offset:56608
    v_mfma_f32_32x32x16_bf16 v[32:47], v[184:187], v[152:155], v[32:47]
    s_add_u32 m0, s81, 26624
    s_mov_b32 s4, 20480
    buffer_load_dwordx4 v12, s[44:47], s4 offen offset:2048 lds
    ds_read_b128 v[88:91], v18 offset:61440
    v_mfma_f32_16x16x32_bf16 v[26:29], v[184:187], v[4:7], v[26:29]
    ds_read_b64_tr_b16 v[120:121], v20 offset:57088
    v_mfma_f32_32x32x16_bf16 v[48:63], v[152:155], v[152:155], v[48:63]
    ds_read_b64_tr_b16 v[122:123], v20 offset:57248
    v_mfma_f32_32x32x16_bf16 v[32:47], v[188:191], v[156:159], v[32:47]
    ds_read_b128 v[92:95], v19 offset:61440
    v_mfma_f32_16x16x32_bf16 v[26:29], v[188:191], v[4:7], v[26:29]
    ds_read_b64_tr_b16 v[124:125], v20 offset:57728
    v_mfma_f32_16x16x32_bf16 v[22:25], v[156:159], v[4:7], v[22:25]
    ds_read_b64_tr_b16 v[126:127], v20 offset:57888
    s_waitcnt vmcnt(7) lgkmcnt(0)
    s_barrier
    v_mfma_f32_32x32x16_bf16 v[32:47], v[96:99], v[64:67], v[32:47]
    buffer_load_dword v13, off, s[52:55], 0 offset:128 sc1
    ds_read_b128 v[128:131], v16 offset:0
    v_mfma_f32_16x16x32_bf16 v[26:29], v[96:99], v[4:7], v[26:29]
    ds_read_b64_tr_b16 v[160:161], v20 offset:0
    v_mfma_f32_32x32x16_bf16 v[48:63], v[64:67], v[64:67], v[48:63]
    ds_read_b64_tr_b16 v[162:163], v20 offset:160
    v_mfma_f32_32x32x16_bf16 v[32:47], v[100:103], v[68:71], v[32:47]
    ds_read_b128 v[132:135], v17 offset:0
    v_mfma_f32_16x16x32_bf16 v[26:29], v[100:103], v[4:7], v[26:29]
    ds_read_b64_tr_b16 v[164:165], v20 offset:640
    v_mfma_f32_16x16x32_bf16 v[22:25], v[68:71], v[4:7], v[22:25]
    ds_read_b64_tr_b16 v[166:167], v20 offset:800
    v_mfma_f32_32x32x16_bf16 v[32:47], v[104:107], v[72:75], v[32:47]
    ds_read_b128 v[136:139], v18 offset:0
    v_mfma_f32_16x16x32_bf16 v[26:29], v[104:107], v[4:7], v[26:29]
    ds_read_b64_tr_b16 v[168:169], v20 offset:1280
    v_mfma_f32_32x32x16_bf16 v[48:63], v[72:75], v[72:75], v[48:63]
    ds_read_b64_tr_b16 v[170:171], v20 offset:1440
    v_mfma_f32_32x32x16_bf16 v[32:47], v[108:111], v[76:79], v[32:47]
    ds_read_b128 v[140:143], v19 offset:0
    v_mfma_f32_16x16x32_bf16 v[26:29], v[108:111], v[4:7], v[26:29]
    ds_read_b64_tr_b16 v[172:173], v20 offset:1920
    v_mfma_f32_16x16x32_bf16 v[22:25], v[76:79], v[4:7], v[22:25]
    ds_read_b64_tr_b16 v[174:175], v20 offset:2080
    v_mfma_f32_32x32x16_bf16 v[32:47], v[112:115], v[80:83], v[32:47]
    ds_read_b128 v[144:147], v16 offset:8192
    v_mfma_f32_16x16x32_bf16 v[26:29], v[112:115], v[4:7], v[26:29]
    ds_read_b64_tr_b16 v[176:177], v20 offset:2560
    v_mfma_f32_32x32x16_bf16 v[48:63], v[80:83], v[80:83], v[48:63]
    ds_read_b64_tr_b16 v[178:179], v20 offset:2720
    v_mfma_f32_32x32x16_bf16 v[32:47], v[116:119], v[84:87], v[32:47]
    ds_read_b128 v[148:151], v17 offset:8192
    v_mfma_f32_16x16x32_bf16 v[26:29], v[116:119], v[4:7], v[26:29]
    ds_read_b64_tr_b16 v[180:181], v20 offset:3200
    v_mfma_f32_16x16x32_bf16 v[22:25], v[84:87], v[4:7], v[22:25]
    ds_read_b64_tr_b16 v[182:183], v20 offset:3360
    v_mfma_f32_32x32x16_bf16 v[32:47], v[120:123], v[88:91], v[32:47]
    ds_read_b128 v[152:155], v18 offset:8192
    v_mfma_f32_16x16x32_bf16 v[26:29], v[120:123], v[4:7], v[26:29]
    ds_read_b64_tr_b16 v[184:185], v20 offset:3840
    v_mfma_f32_32x32x16_bf16 v[48:63], v[88:91], v[88:91], v[48:63]
    ds_read_b64_tr_b16 v[186:187], v20 offset:4000
    v_mfma_f32_32x32x16_bf16 v[32:47], v[124:127], v[92:95], v[32:47]
    ds_read_b128 v[156:159], v19 offset:8192
    v_mfma_f32_16x16x32_bf16 v[26:29], v[124:127], v[4:7], v[26:29]
    ds_read_b64_tr_b16 v[188:189], v20 offset:4480
    v_mfma_f32_16x16x32_bf16 v[22:25], v[92:95], v[4:7], v[22:25]
    ds_read_b64_tr_b16 v[190:191], v20 offset:4640
    s_waitcnt vmcnt(1) lgkmcnt(0)
    s_barrier
    v_mfma_f32_32x32x16_bf16 v[32:47], v[160:163], v[128:131], v[32:47]
    ds_read_b128 v[64:67], v16 offset:26624
    v_mfma_f32_16x16x32_bf16 v[26:29], v[160:163], v[4:7], v[26:29]
    ds_read_b64_tr_b16 v[96:97], v20 offset:26624
    v_mfma_f32_32x32x16_bf16 v[48:63], v[128:131], v[128:131], v[48:63]
    ds_read_b64_tr_b16 v[98:99], v20 offset:26784
    v_mfma_f32_32x32x16_bf16 v[32:47], v[164:167], v[132:135], v[32:47]
    ds_read_b128 v[68:71], v17 offset:26624
    v_mfma_f32_16x16x32_bf16 v[26:29], v[164:167], v[4:7], v[26:29]
    ds_read_b64_tr_b16 v[100:101], v20 offset:27264
    v_mfma_f32_16x16x32_bf16 v[22:25], v[132:135], v[4:7], v[22:25]
    ds_read_b64_tr_b16 v[102:103], v20 offset:27424
    v_mfma_f32_32x32x16_bf16 v[32:47], v[168:171], v[136:139], v[32:47]
    ds_read_b128 v[72:75], v18 offset:26624
    v_mfma_f32_16x16x32_bf16 v[26:29], v[168:171], v[4:7], v[26:29]
    ds_read_b64_tr_b16 v[104:105], v20 offset:27904
    v_mfma_f32_32x32x16_bf16 v[48:63], v[136:139], v[136:139], v[48:63]
    ds_read_b64_tr_b16 v[106:107], v20 offset:28064
    v_mfma_f32_32x32x16_bf16 v[32:47], v[172:175], v[140:143], v[32:47]
    ds_read_b128 v[76:79], v19 offset:26624
    v_mfma_f32_16x16x32_bf16 v[26:29], v[172:175], v[4:7], v[26:29]
    ds_read_b64_tr_b16 v[108:109], v20 offset:28544
    v_mfma_f32_16x16x32_bf16 v[22:25], v[140:143], v[4:7], v[22:25]
    ds_read_b64_tr_b16 v[110:111], v20 offset:28704
    v_mfma_f32_32x32x16_bf16 v[32:47], v[176:179], v[144:147], v[32:47]
    ds_read_b128 v[80:83], v16 offset:34816
    v_mfma_f32_16x16x32_bf16 v[26:29], v[176:179], v[4:7], v[26:29]
    ds_read_b64_tr_b16 v[112:113], v20 offset:29184
    v_mfma_f32_32x32x16_bf16 v[48:63], v[144:147], v[144:147], v[48:63]
    ds_read_b64_tr_b16 v[114:115], v20 offset:29344
    v_mfma_f32_32x32x16_bf16 v[32:47], v[180:183], v[148:151], v[32:47]
    ds_read_b128 v[84:87], v17 offset:34816
    v_mfma_f32_16x16x32_bf16 v[26:29], v[180:183], v[4:7], v[26:29]
    ds_read_b64_tr_b16 v[116:117], v20 offset:29824
    v_mfma_f32_16x16x32_bf16 v[22:25], v[148:151], v[4:7], v[22:25]
    ds_read_b64_tr_b16 v[118:119], v20 offset:29984
    v_mfma_f32_32x32x16_bf16 v[32:47], v[184:187], v[152:155], v[32:47]
    ds_read_b128 v[88:91], v18 offset:34816
    v_mfma_f32_16x16x32_bf16 v[26:29], v[184:187], v[4:7], v[26:29]
    ds_read_b64_tr_b16 v[120:121], v20 offset:30464
    v_mfma_f32_32x32x16_bf16 v[48:63], v[152:155], v[152:155], v[48:63]
    ds_read_b64_tr_b16 v[122:123], v20 offset:30624
    v_mfma_f32_32x32x16_bf16 v[32:47], v[188:191], v[156:159], v[32:47]
    ds_read_b128 v[92:95], v19 offset:34816
    v_mfma_f32_16x16x32_bf16 v[26:29], v[188:191], v[4:7], v[26:29]
    ds_read_b64_tr_b16 v[124:125], v20 offset:31104
    v_mfma_f32_16x16x32_bf16 v[22:25], v[156:159], v[4:7], v[22:25]
    ds_read_b64_tr_b16 v[126:127], v20 offset:31264
    s_waitcnt lgkmcnt(0)
    v_mfma_f32_32x32x16_bf16 v[32:47], v[96:99], v[64:67], v[32:47]
    v_mfma_f32_16x16x32_bf16 v[26:29], v[96:99], v[4:7], v[26:29]
    v_mfma_f32_32x32x16_bf16 v[48:63], v[64:67], v[64:67], v[48:63]
    v_mfma_f32_32x32x16_bf16 v[32:47], v[100:103], v[68:71], v[32:47]
    v_mfma_f32_16x16x32_bf16 v[26:29], v[100:103], v[4:7], v[26:29]
    v_mfma_f32_16x16x32_bf16 v[22:25], v[68:71], v[4:7], v[22:25]
    v_mfma_f32_32x32x16_bf16 v[32:47], v[104:107], v[72:75], v[32:47]
    v_mfma_f32_16x16x32_bf16 v[26:29], v[104:107], v[4:7], v[26:29]
    v_mfma_f32_32x32x16_bf16 v[48:63], v[72:75], v[72:75], v[48:63]
    v_mfma_f32_32x32x16_bf16 v[32:47], v[108:111], v[76:79], v[32:47]
    v_mfma_f32_16x16x32_bf16 v[26:29], v[108:111], v[4:7], v[26:29]
    v_mfma_f32_16x16x32_bf16 v[22:25], v[76:79], v[4:7], v[22:25]
    v_mfma_f32_32x32x16_bf16 v[32:47], v[112:115], v[80:83], v[32:47]
    v_mfma_f32_16x16x32_bf16 v[26:29], v[112:115], v[4:7], v[26:29]
    v_mfma_f32_32x32x16_bf16 v[48:63], v[80:83], v[80:83], v[48:63]
    v_mfma_f32_32x32x16_bf16 v[32:47], v[116:119], v[84:87], v[32:47]
    v_mfma_f32_16x16x32_bf16 v[26:29], v[116:119], v[4:7], v[26:29]
    v_mfma_f32_16x16x32_bf16 v[22:25], v[84:87], v[4:7], v[22:25]
    v_mfma_f32_32x32x16_bf16 v[32:47], v[120:123], v[88:91], v[32:47]
    v_mfma_f32_16x16x32_bf16 v[26:29], v[120:123], v[4:7], v[26:29]
    v_mfma_f32_32x32x16_bf16 v[48:63], v[88:91], v[88:91], v[48:63]
    v_mfma_f32_32x32x16_bf16 v[32:47], v[124:127], v[92:95], v[32:47]
    v_mfma_f32_16x16x32_bf16 v[26:29], v[124:127], v[4:7], v[26:29]
    v_mfma_f32_16x16x32_bf16 v[22:25], v[92:95], v[4:7], v[22:25]
    s_waitcnt vmcnt(0)
    s_mov_b32 s70, 40000
    v_readfirstlane_b32 s64, v13
    s_nop 0
    s_cmp_lg_u32 s64, 0
    s_cbranch_scc1 L_poll3_done
L_poll3:
    buffer_load_dword v13, off, s[52:55], 0 offset:128 sc1
    s_waitcnt vmcnt(0)
    v_readfirstlane_b32 s64, v13
    s_nop 0
    s_cmp_lg_u32 s64, 0
    s_cbranch_scc1 L_poll3_done
    s_sleep 4
    s_sub_u32 s70, s70, 1
    s_cmp_lg_u32 s70, 0
    s_cbranch_scc1 L_poll3
L_poll3_done:
    s_lshl_b32 s4, s78, 8
    s_add_u32 s4, s4, 79872
    s_add_u32 s6, s4, 0
    s_lshl_b32 s5, s3, 8
    s_add_u32 s5, s5, 80896
    v_and_b32 v2, 15, v0
    v_lshrrev_b32 v3, 4, v0
    v_cmp_gt_u32 vcc, 2, v2
    v_lshl_add_u32 v2, v2, 2, v3
    v_lshlrev_b32 v2, 4, v2
    v_add_u32 v2, s6, v2
    s_mov_b64 exec, vcc
    ds_write_b128 v2, v[22:25]
    s_mov_b64 exec, -1
    v_and_b32 v2, 15, v0
    v_lshrrev_b32 v3, 4, v0
    v_cmp_gt_u32 vcc, 2, v2
    v_lshl_add_u32 v2, v2, 2, v3
    v_lshlrev_b32 v2, 4, v2
    v_add_u32 v2, s5, v2
    s_mov_b64 exec, vcc
    ds_write_b128 v2, v[26:29]
    s_mov_b64 exec, -1
    v_and_b32 v4, 31, v0
    v_and_b32 v2, 1, v0
    v_cmp_ne_u32 vcc, 0, v2
    s_nop 1
    v_cndmask_b32 v48, v48, v49, vcc
    v_cndmask_b32 v50, v50, v51, vcc
    v_cndmask_b32 v52, v52, v53, vcc
    v_cndmask_b32 v54, v54, v55, vcc
    v_cndmask_b32 v56, v56, v57, vcc
    v_cndmask_b32 v58, v58, v59, vcc
    v_cndmask_b32 v60, v60, v61, vcc
    v_cndmask_b32 v62, v62, v63, vcc
    v_and_b32 v2, 2, v0
    v_cmp_ne_u32 vcc, 0, v2
    s_nop 1
    v_cndmask_b32 v48, v48, v50, vcc
    v_cndmask_b32 v52, v52, v54, vcc
    v_cndmask_b32 v56, v56, v58, vcc
    v_cndmask_b32 v60, v60, v62, vcc
    v_and_b32 v2, 8, v0
    v_cmp_ne_u32 vcc, 0, v2
    s_nop 1
    v_cndmask_b32 v48, v48, v52, vcc
    v_cndmask_b32 v56, v56, v60, vcc
    v_and_b32 v2, 16, v0
    v_cmp_ne_u32 vcc, 0, v2
    s_nop 1
    v_cndmask_b32 v48, v48, v56, vcc
    v_lshlrev_b32 v4, 2, v4
    v_bfe_u32 v2, v0, 2, 1
    v_lshrrev_b32 v7, 5, v0
    v_cmp_eq_u32 vcc, v2, v7
    v_add_u32 v5, s6, v4
    s_mov_b64 exec, vcc
    ds_write_b32 v5, v48 offset:128
    s_mov_b64 exec, -1
    v_add_u32 v5, s4, v4
    v_add_u32 v6, s5, v4
    v_lshl_add_u32 v7, v7, 4, s5
    s_waitcnt lgkmcnt(0)
    s_barrier
    ds_read2_b32 v[26:27], v5 offset1:32
    ds_read2_b32 v[22:23], v5 offset0:128 offset1:160
    ds_read_b128 v[64:67], v7 offset:0
    ds_read_b128 v[68:71], v7 offset:32
    ds_read_b128 v[72:75], v7 offset:64
    s_mov_b32 s4, 0x3acccccd
    s_waitcnt lgkmcnt(0)
    v_add_f32 v26, v26, v22
    v_add_f32 v27, v27, v23
    v_mul_f32 v26, s4, v26
    v_mul_f32 v27, s4, v27
    v_fma_f32 v27, -v26, v26, v27
    v_max_f32 v27, 0, v27
    v_add_f32 v27, 0x3727c5ac, v27
    v_sqrt_f32 v30, v27
    v_sub_f32 v28, 0, v26
    v_rcp_f32 v29, v30
    s_lshl_b32 s4, s76, 1
    s_add_u32 s4, s4, s78
    s_mul_i32 s5, s76, 6144
    v_lshlrev_b32 v8, 4, v0
    s_lshl_b32 s4, s4, 9
    s_add_u32 s4, s4, 0x40000
    v_lshlrev_b32 v4, 2, v4
    v_mov_b32 v48, v28
    v_mov_b32 v49, s64
    v_mov_b32 v50, v27
    v_mov_b32 v51, s64
    buffer_store_dwordx4 v[48:51], v4, s[48:51], s4 offen sc1
    v_fma_f32 v32, v28, v64, v32
    v_fma_f32 v33, v28, v65, v33
    v_fma_f32 v34, v28, v66, v34
    v_fma_f32 v35, v28, v67, v35
    v_fma_f32 v36, v28, v68, v36
    v_fma_f32 v37, v28, v69, v37
    v_fma_f32 v38, v28, v70, v38
    v_fma_f32 v39, v28, v71, v39
    v_fma_f32 v40, v28, v72, v40
    v_fma_f32 v41, v28, v73, v41
    v_fma_f32 v42, v28, v74, v42
    v_fma_f32 v43, v28, v75, v43
    v_mul_f32 v32, v29, v32
    v_mul_f32 v33, v29, v33
    v_mul_f32 v34, v29, v34
    v_mul_f32 v35, v29, v35
    v_mul_f32 v36, v29, v36
    v_mul_f32 v37, v29, v37
    v_mul_f32 v38, v29, v38
    v_mul_f32 v39, v29, v39
    v_mul_f32 v40, v29, v40
    v_mul_f32 v41, v29, v41
    v_mul_f32 v42, v29, v42
    v_mul_f32 v43, v29, v43
    v_cvt_pk_bf16_f32 v80, v32, v33
    v_cvt_pk_bf16_f32 v81, v34, v35
    v_cvt_pk_bf16_f32 v82, v36, v37
    v_cvt_pk_bf16_f32 v83, v38, v39
    v_cvt_pk_bf16_f32 v84, v40, v41
    v_cvt_pk_bf16_f32 v85, v42, v43
    v_cmp_lt_u32 vcc, 31, v0
    v_mov_b32 v2, 0x3f80
    s_nop 0
    v_cndmask_b32 v84, v84, v21, vcc
    v_cndmask_b32 v85, v85, v2, vcc
    s_lshl_b32 s6, s78, 10
    s_add_u32 s6, s6, s5
    s_lshl_b32 s7, s78, 3
    s_add_u32 s7, s7, s5
    buffer_store_dwordx4 v[80:83], v8, s[48:51], s6 offen sc1
    buffer_store_dwordx2 v[84:85], v8, s[48:51], s7 offen offset:2048 sc1
    s_branch L_kvpub
L_kvV:
    s_waitcnt vmcnt(14) lgkmcnt(0)
    s_barrier
    ds_read_b128 v[64:67], v16 offset:0
    ds_read_b64_tr_b16 v[96:97], v20 offset:0
    ds_read_b64_tr_b16 v[98:99], v20 offset:160
    ds_read_b128 v[68:71], v17 offset:0
    ds_read_b64_tr_b16 v[100:101], v20 offset:640
    ds_read_b64_tr_b16 v[102:103], v20 offset:800
    ds_read_b128 v[72:75], v18 offset:0
    ds_read_b64_tr_b16 v[104:105], v20 offset:1280
    ds_read_b64_tr_b16 v[106:107], v20 offset:1440
    ds_read_b128 v[76:79], v19 offset:0
    ds_read_b64_tr_b16 v[108:109], v20 offset:1920
    ds_read_b64_tr_b16 v[110:111], v20 offset:2080
    ds_read_b128 v[80:83], v16 offset:8192
    ds_read_b64_tr_b16 v[112:113], v20 offset:2560
    ds_read_b64_tr_b16 v[114:115], v20 offset:2720
    ds_read_b128 v[84:87], v17 offset:8192
    ds_read_b64_tr_b16 v[116:117], v20 offset:3200
    ds_read_b64_tr_b16 v[118:119], v20 offset:3360
    ds_read_b128 v[88:91], v18 offset:8192
    ds_read_b64_tr_b16 v[120:121], v20 offset:3840
    ds_read_b64_tr_b16 v[122:123], v20 offset:4000
    ds_read_b128 v[92:95], v19 offset:8192
    ds_read_b64_tr_b16 v[124:125], v20 offset:4480
    ds_read_b64_tr_b16 v[126:127], v20 offset:4640
    s_waitcnt vmcnt(7) lgkmcnt(0)
    s_barrier
    v_mfma_f32_32x32x16_bf16 v[32:47], v[64:67], v[96:99], v[32:47]
    s_add_u32 m0, s80, 0
    s_mov_b32 s4, 768
    buffer_load_dwordx4 v10, s[40:43], s4 offen lds
    ds_read_b128 v[128:131], v16 offset:26624
    v_mfma_f32_16x16x32_bf16 v[26:29], v[96:99], v[4:7], v[26:29]
    ds_read_b64_tr_b16 v[160:161], v20 offset:26624
    v_mfma_f32_16x16x32_bf16 v[22:25], v[64:67], v[4:7], v[22:25]
    ds_read_b64_tr_b16 v[162:163], v20 offset:26784
    v_mfma_f32_32x32x16_bf16 v[32:47], v[68:71], v[100:103], v[32:47]
    s_add_u32 m0, s80, 1024
    s_mov_b32 s4, 768
    buffer_load_dwordx4 v11, s[40:43], s4 offen lds
    ds_read_b128 v[132:135], v17 offset:26624
    v_mfma_f32_16x16x32_bf16 v[26:29], v[100:103], v[4:7], v[26:29]
    ds_read_b64_tr_b16 v[164:165], v20 offset:27264
    v_mfma_f32_32x32x16_bf16 v[48:63], v[68:71], v[68:71], v[48:63]
    ds_read_b64_tr_b16 v[166:167], v20 offset:27424
    v_mfma_f32_32x32x16_bf16 v[32:47], v[72:75], v[104:107], v[32:47]
    s_add_u32 m0, s80, 8192
    s_mov_b32 s4, 896
    buffer_load_dwordx4 v10, s[40:43], s4 offen lds
    ds_read_b128 v[136:139], v18 offset:26624
    v_mfma_f32_16x16x32_bf16 v[26:29], v[104:107], v[4:7], v[26:29]
    ds_read_b64_tr_b16 v[168:169], v20 offset:27904
    v_mfma_f32_16x16x32_bf16 v[22:25], v[72:75], v[4:7], v[22:25]
    ds_read_b64_tr_b16 v[170:171], v20 offset:28064
    v_mfma_f32_32x32x16_bf16 v[32:47], v[76:79], v[108:111], v[32:47]
    s_add_u32 m0, s80, 9216
    s_mov_b32 s4, 896
    buffer_load_dwordx4 v11, s[40:43], s4 offen lds
    ds_read_b128 v[140:143], v19 offset:26624
    v_mfma_f32_16x16x32_bf16 v[26:29], v[108:111], v[4:7], v[26:29]
    ds_read_b64_tr_b16 v[172:173], v20 offset:28544
    v_mfma_f32_32x32x16_bf16 v[48:63], v[76:79], v[76:79], v[48:63]
    ds_read_b64_tr_b16 v[174:175], v20 offset:28704
    v_mfma_f32_32x32x16_bf16 v[32:47], v[80:83], v[112:115], v[32:47]
    s_add_u32 m0, s81, 0
    s_mov_b32 s4, 15360
    buffer_load_dwordx4 v12, s[44:47], s4 offen offset:0 lds
    ds_read_b128 v[144:147], v16 offset:34816
    v_mfma_f32_16x16x32_bf16 v[26:29], v[112:115], v[4:7], v[26:29]
    ds_read_b64_tr_b16 v[176:177], v20 offset:29184
    v_mfma_f32_16x16x32_bf16 v[22:25], v[80:83], v[4:7], v[22:25]
    ds_read_b64_tr_b16 v[178:179], v20 offset:29344
    v_mfma_f32_32x32x16_bf16 v[32:47], v[84:87], v[116:119], v[32:47]
    s_add_u32 m0, s81, 0
    s_mov_b32 s4, 15360
    buffer_load_dwordx4 v12, s[44:47], s4 offen offset:1024 lds
    ds_read_b128 v[148:151], v17 offset:34816
    v_mfma_f32_16x16x32_bf16 v[26:29], v[116:119], v[4:7], v[26:29]
    ds_read_b64_tr_b16 v[180:181], v20 offset:29824
    v_mfma_f32_32x32x16_bf16 v[48:63], v[84:87], v[84:87], v[48:63]
    ds_read_b64_tr_b16 v[182:183], v20 offset:29984
    v_mfma_f32_32x32x16_bf16 v[32:47], v[88:91], v[120:123], v[32:47]
    s_add_u32 m0, s81, 0
    s_mov_b32 s4, 15360
    buffer_load_dwordx4 v12, s[44:47], s4 offen offset:2048 lds
    ds_read_b128 v[152:155], v18 offset:34816
    v_mfma_f32_16x16x32_bf16 v[26:29], v[120:123], v[4:7], v[26:29]
    ds_read_b64_tr_b16 v[184:185], v20 offset:30464
    v_mfma_f32_16x16x32_bf16 v[22:25], v[88:91], v[4:7], v[22:25]
    ds_read_b64_tr_b16 v[186:187], v20 offset:30624
    v_mfma_f32_32x32x16_bf16 v[32:47], v[92:95], v[124:127], v[32:47]
    ds_read_b128 v[156:159], v19 offset:34816
    v_mfma_f32_16x16x32_bf16 v[26:29], v[124:127], v[4:7], v[26:29]
    ds_read_b64_tr_b16 v[188:189], v20 offset:31104
    v_mfma_f32_32x32x16_bf16 v[48:63], v[92:95], v[92:95], v[48:63]
    ds_read_b64_tr_b16 v[190:191], v20 offset:31264
    s_waitcnt vmcnt(7) lgkmcnt(0)
    s_barrier
    v_mfma_f32_32x32x16_bf16 v[32:47], v[128:131], v[160:163], v[32:47]
    s_add_u32 m0, s80, 26624
    s_mov_b32 s4, 1024
    buffer_load_dwordx4 v10, s[40:43], s4 offen lds
    ds_read_b128 v[64:67], v16 offset:53248
    v_mfma_f32_16x16x32_bf16 v[26:29], v[160:163], v[4:7], v[26:29]
    ds_read_b64_tr_b16 v[96:97], v20 offset:53248
    v_mfma_f32_16x16x32_bf16 v[22:25], v[128:131], v[4:7], v[22:25]
    ds_read_b64_tr_b16 v[98:99], v20 offset:53408
    v_mfma_f32_32x32x16_bf16 v[32:47], v[132:135], v[164:167], v[32:47]
    s_add_u32 m0, s80, 27648
    s_mov_b32 s4, 1024
    buffer_load_dwordx4 v11, s[40:43], s4 offen lds
    ds_read_b128 v[68:71], v17 offset:53248
    v_mfma_f32_16x16x32_bf16 v[26:29], v[164:167], v[4:7], v[26:29]
    ds_read_b64_tr_b16 v[100:101], v20 offset:53888
    v_mfma_f32_32x32x16_bf16 v[48:63], v[132:135], v[132:135], v[48:63]
    ds_read_b64_tr_b16 v[102:103], v20 offset:54048
    v_mfma_f32_32x32x16_bf16 v[32:47], v[136:139], v[168:171], v[32:47]
    s_add_u32 m0, s80, 34816
    s_mov_b32 s4, 1152
    buffer_load_dwordx4 v10, s[40:43], s4 offen lds
    ds_read_b128 v[72:75], v18 offset:53248
    v_mfma_f32_16x16x32_bf16 v[26:29], v[168:171], v[4:7], v[26:29]
    ds_read_b64_tr_b16 v[104:105], v20 offset:54528
    v_mfma_f32_16x16x32_bf16 v[22:25], v[136:139], v[4:7], v[22:25]
    ds_read_b64_tr_b16 v[106:107], v20 offset:54688
    v_mfma_f32_32x32x16_bf16 v[32:47], v[140:143], v[172:175], v[32:47]
    s_add_u32 m0, s80, 35840
    s_mov_b32 s4, 1152
    buffer_load_dwordx4 v11, s[40:43], s4 offen lds
    ds_read_b128 v[76:79], v19 offset:53248
    v_mfma_f32_16x16x32_bf16 v[26:29], v[172:175], v[4:7], v[26:29]
    ds_read_b64_tr_b16 v[108:109], v20 offset:55168
    v_mfma_f32_32x32x16_bf16 v[48:63], v[140:143], v[140:143], v[48:63]
    ds_read_b64_tr_b16 v[110:111], v20 offset:55328
    v_mfma_f32_32x32x16_bf16 v[32:47], v[144:147], v[176:179], v[32:47]
    s_add_u32 m0, s81, 26624
    s_mov_b32 s4, 20480
    buffer_load_dwordx4 v12, s[44:47], s4 offen offset:0 lds
    ds_read_b128 v[80:83], v16 offset:61440
    v_mfma_f32_16x16x32_bf16 v[26:29], v[176:179], v[4:7], v[26:29]
    ds_read_b64_tr_b16 v[112:113], v20 offset:55808
    v_mfma_f32_16x16x32_bf16 v[22:25], v[144:147], v[4:7], v[22:25]
    ds_read_b64_tr_b16 v[114:115], v20 offset:55968
    v_mfma_f32_32x32x16_bf16 v[32:47], v[148:151], v[180:183], v[32:47]
    s_add_u32 m0, s81, 26624
    s_mov_b32 s4, 20480
    buffer_load_dwordx4 v12, s[44:47], s4 offen offset:1024 lds
    ds_read_b128 v[84:87], v17 offset:61440
    v_mfma_f32_16x16x32_bf16 v[26:29], v[180:183], v[4:7], v[26:29]
    ds_read_b64_tr_b16 v[116:117], v20 offset:56448
    v_mfma_f32_32x32x16_bf16 v[48:63], v[148:151], v[148:151], v[48:63]
    ds_read_b64_tr_b16 v[118:119], v20 offset:56608
    v_mfma_f32_32x32x16_bf16 v[32:47], v[152:155], v[184:187], v[32:47]
    s_add_u32 m0, s81, 26624
    s_mov_b32 s4, 20480
    buffer_load_dwordx4 v12, s[44:47], s4 offen offset:2048 lds
    ds_read_b128 v[88:91], v18 offset:61440
    v_mfma_f32_16x16x32_bf16 v[26:29], v[184:187], v[4:7], v[26:29]
    ds_read_b64_tr_b16 v[120:121], v20 offset:57088
    v_mfma_f32_16x16x32_bf16 v[22:25], v[152:155], v[4:7], v[22:25]
    ds_read_b64_tr_b16 v[122:123], v20 offset:57248
    v_mfma_f32_32x32x16_bf16 v[32:47], v[156:159], v[188:191], v[32:47]
    ds_read_b128 v[92:95], v19 offset:61440
    v_mfma_f32_16x16x32_bf16 v[26:29], v[188:191], v[4:7], v[26:29]
    ds_read_b64_tr_b16 v[124:125], v20 offset:57728
    v_mfma_f32_32x32x16_bf16 v[48:63], v[156:159], v[156:159], v[48:63]
    ds_read_b64_tr_b16 v[126:127], v20 offset:57888
    s_waitcnt vmcnt(7) lgkmcnt(0)
    s_barrier
    v_mfma_f32_32x32x16_bf16 v[32:47], v[64:67], v[96:99], v[32:47]
    buffer_load_dword v13, off, s[52:55], 0 offset:128 sc1
    ds_read_b128 v[128:131], v16 offset:0
    v_mfma_f32_16x16x32_bf16 v[26:29], v[96:99], v[4:7], v[26:29]
    ds_read_b64_tr_b16 v[160:161], v20 offset:0
    v_mfma_f32_16x16x32_bf16 v[22:25], v[64:67], v[4:7], v[22:25]
    ds_read_b64_tr_b16 v[162:163], v20 offset:160
    v_mfma_f32_32x32x16_bf16 v[32:47], v[68:71], v[100:103], v[32:47]
    ds_read_b128 v[132:135], v17 offset:0
    v_mfma_f32_16x16x32_bf16 v[26:29], v[100:103], v[4:7], v[26:29]
    ds_read_b64_tr_b16 v[164:165], v20 offset:640
    v_mfma_f32_32x32x16_bf16 v[48:63], v[68:71], v[68:71], v[48:63]
    ds_read_b64_tr_b16 v[166:167], v20 offset:800
    v_mfma_f32_32x32x16_bf16 v[32:47], v[72:75], v[104:107], v[32:47]
    ds_read_b128 v[136:139], v18 offset:0
    v_mfma_f32_16x16x32_bf16 v[26:29], v[104:107], v[4:7], v[26:29]
    ds_read_b64_tr_b16 v[168:169], v20 offset:1280
    v_mfma_f32_16x16x32_bf16 v[22:25], v[72:75], v[4:7], v[22:25]
    ds_read_b64_tr_b16 v[170:171], v20 offset:1440
    v_mfma_f32_32x32x16_bf16 v[32:47], v[76:79], v[108:111], v[32:47]
    ds_read_b128 v[140:143], v19 offset:0
    v_mfma_f32_16x16x32_bf16 v[26:29], v[108:111], v[4:7], v[26:29]
    ds_read_b64_tr_b16 v[172:173], v20 offset:1920
    v_mfma_f32_32x32x16_bf16 v[48:63], v[76:79], v[76:79], v[48:63]
    ds_read_b64_tr_b16 v[174:175], v20 offset:2080
    v_mfma_f32_32x32x16_bf16 v[32:47], v[80:83], v[112:115], v[32:47]
    ds_read_b128 v[144:147], v16 offset:8192
    v_mfma_f32_16x16x32_bf16 v[26:29], v[112:115], v[4:7], v[26:29]
    ds_read_b64_tr_b16 v[176:177], v20 offset:2560
    v_mfma_f32_16x16x32_bf16 v[22:25], v[80:83], v[4:7], v[22:25]
    ds_read_b64_tr_b16 v[178:179], v20 offset:2720
    v_mfma_f32_32x32x16_bf16 v[32:47], v[84:87], v[116:119], v[32:47]
    ds_read_b128 v[148:151], v17 offset:8192
    v_mfma_f32_16x16x32_bf16 v[26:29], v[116:119], v[4:7], v[26:29]
    ds_read_b64_tr_b16 v[180:181], v20 offset:3200
    v_mfma_f32_32x32x16_bf16 v[48:63], v[84:87], v[84:87], v[48:63]
    ds_read_b64_tr_b16 v[182:183], v20 offset:3360
    v_mfma_f32_32x32x16_bf16 v[32:47], v[88:91], v[120:123], v[32:47]
    ds_read_b128 v[152:155], v18 offset:8192
    v_mfma_f32_16x16x32_bf16 v[26:29], v[120:123], v[4:7], v[26:29]
    ds_read_b64_tr_b16 v[184:185], v20 offset:3840
    v_mfma_f32_16x16x32_bf16 v[22:25], v[88:91], v[4:7], v[22:25]
    ds_read_b64_tr_b16 v[186:187], v20 offset:4000
    v_mfma_f32_32x32x16_bf16 v[32:47], v[92:95], v[124:127], v[32:47]
    ds_read_b128 v[156:159], v19 offset:8192
    v_mfma_f32_16x16x32_bf16 v[26:29], v[124:127], v[4:7], v[26:29]
    ds_read_b64_tr_b16 v[188:189], v20 offset:4480
    v_mfma_f32_32x32x16_bf16 v[48:63], v[92:95], v[92:95], v[48:63]
    ds_read_b64_tr_b16 v[190:191], v20 offset:4640
    s_waitcnt vmcnt(1) lgkmcnt(0)
    s_barrier
    v_mfma_f32_32x32x16_bf16 v[32:47], v[128:131], v[160:163], v[32:47]
    ds_read_b128 v[64:67], v16 offset:26624
    v_mfma_f32_16x16x32_bf16 v[26:29], v[160:163], v[4:7], v[26:29]
    ds_read_b64_tr_b16 v[96:97], v20 offset:26624
    v_mfma_f32_16x16x32_bf16 v[22:25], v[128:131], v[4:7], v[22:25]
    ds_read_b64_tr_b16 v[98:99], v20 offset:26784
    v_mfma_f32_32x32x16_bf16 v[32:47], v[132:135], v[164:167], v[32:47]
    ds_read_b128 v[68:71], v17 offset:26624
    v_mfma_f32_16x16x32_bf16 v[26:29], v[164:167], v[4:7], v[26:29]
    ds_read_b64_tr_b16 v[100:101], v20 offset:27264
    v_mfma_f32_32x32x16_bf16 v[48:63], v[132:135], v[132:135], v[48:63]
    ds_read_b64_tr_b16 v[102:103], v20 offset:27424
    v_mfma_f32_32x32x16_bf16 v[32:47], v[136:139], v[168:171], v[32:47]
    ds_read_b128 v[72:75], v18 offset:26624
    v_mfma_f32_16x16x32_bf16 v[26:29], v[168:171], v[4:7], v[26:29]
    ds_read_b64_tr_b16 v[104:105], v20 offset:27904
    v_mfma_f32_16x16x32_bf16 v[22:25], v[136:139], v[4:7], v[22:25]
    ds_read_b64_tr_b16 v[106:107], v20 offset:28064
    v_mfma_f32_32x32x16_bf16 v[32:47], v[140:143], v[172:175], v[32:47]
    ds_read_b128 v[76:79], v19 offset:26624
    v_mfma_f32_16x16x32_bf16 v[26:29], v[172:175], v[4:7], v[26:29]
    ds_read_b64_tr_b16 v[108:109], v20 offset:28544
    v_mfma_f32_32x32x16_bf16 v[48:63], v[140:143], v[140:143], v[48:63]
    ds_read_b64_tr_b16 v[110:111], v20 offset:28704
    v_mfma_f32_32x32x16_bf16 v[32:47], v[144:147], v[176:179], v[32:47]
    ds_read_b128 v[80:83], v16 offset:34816
    v_mfma_f32_16x16x32_bf16 v[26:29], v[176:179], v[4:7], v[26:29]
    ds_read_b64_tr_b16 v[112:113], v20 offset:29184
    v_mfma_f32_16x16x32_bf16 v[22:25], v[144:147], v[4:7], v[22:25]
    ds_read_b64_tr_b16 v[114:115], v20 offset:29344
    v_mfma_f32_32x32x16_bf16 v[32:47], v[148:151], v[180:183], v[32:47]
    ds_read_b128 v[84:87], v17 offset:34816
    v_mfma_f32_16x16x32_bf16 v[26:29], v[180:183], v[4:7], v[26:29]
    ds_read_b64_tr_b16 v[116:117], v20 offset:29824
    v_mfma_f32_32x32x16_bf16 v[48:63], v[148:151], v[148:151], v[48:63]
    ds_read_b64_tr_b16 v[118:119], v20 offset:29984
    v_mfma_f32_32x32x16_bf16 v[32:47], v[152:155], v[184:187], v[32:47]
    ds_read_b128 v[88:91], v18 offset:34816
    v_mfma_f32_16x16x32_bf16 v[26:29], v[184:187], v[4:7], v[26:29]
    ds_read_b64_tr_b16 v[120:121], v20 offset:30464
    v_mfma_f32_16x16x32_bf16 v[22:25], v[152:155], v[4:7], v[22:25]
    ds_read_b64_tr_b16 v[122:123], v20 offset:30624
    v_mfma_f32_32x32x16_bf16 v[32:47], v[156:159], v[188:191], v[32:47]
    ds_read_b128 v[92:95], v19 offset:34816
    v_mfma_f32_16x16x32_bf16 v[26:29], v[188:191], v[4:7], v[26:29]
    ds_read_b64_tr_b16 v[124:125], v20 offset:31104
    v_mfma_f32_32x32x16_bf16 v[48:63], v[156:159], v[156:159], v[48:63]
    ds_read_b64_tr_b16 v[126:127], v20 offset:31264
    s_waitcnt lgkmcnt(0)
    v_mfma_f32_32x32x16_bf16 v[32:47], v[64:67], v[96:99], v[32:47]
    v_mfma_f32_16x16x32_bf16 v[26:29], v[96:99], v[4:7], v[26:29]
    v_mfma_f32_16x16x32_bf16 v[22:25], v[64:67], v[4:7], v[22:25]
    v_mfma_f32_32x32x16_bf16 v[32:47], v[68:71], v[100:103], v[32:47]
    v_mfma_f32_16x16x32_bf16 v[26:29], v[100:103], v[4:7], v[26:29]
    v_mfma_f32_32x32x16_bf16 v[48:63], v[68:71], v[68:71], v[48:63]
    v_mfma_f32_32x32x16_bf16 v[32:47], v[72:75], v[104:107], v[32:47]
    v_mfma_f32_16x16x32_bf16 v[26:29], v[104:107], v[4:7], v[26:29]
    v_mfma_f32_16x16x32_bf16 v[22:25], v[72:75], v[4:7], v[22:25]
    v_mfma_f32_32x32x16_bf16 v[32:47], v[76:79], v[108:111], v[32:47]
    v_mfma_f32_16x16x32_bf16 v[26:29], v[108:111], v[4:7], v[26:29]
    v_mfma_f32_32x32x16_bf16 v[48:63], v[76:79], v[76:79], v[48:63]
    v_mfma_f32_32x32x16_bf16 v[32:47], v[80:83], v[112:115], v[32:47]
    v_mfma_f32_16x16x32_bf16 v[26:29], v[112:115], v[4:7], v[26:29]
    v_mfma_f32_16x16x32_bf16 v[22:25], v[80:83], v[4:7], v[22:25]
    v_mfma_f32_32x32x16_bf16 v[32:47], v[84:87], v[116:119], v[32:47]
    v_mfma_f32_16x16x32_bf16 v[26:29], v[116:119], v[4:7], v[26:29]
    v_mfma_f32_32x32x16_bf16 v[48:63], v[84:87], v[84:87], v[48:63]
    v_mfma_f32_32x32x16_bf16 v[32:47], v[88:91], v[120:123], v[32:47]
    v_mfma_f32_16x16x32_bf16 v[26:29], v[120:123], v[4:7], v[26:29]
    v_mfma_f32_16x16x32_bf16 v[22:25], v[88:91], v[4:7], v[22:25]
    v_mfma_f32_32x32x16_bf16 v[32:47], v[92:95], v[124:127], v[32:47]
    v_mfma_f32_16x16x32_bf16 v[26:29], v[124:127], v[4:7], v[26:29]
    v_mfma_f32_32x32x16_bf16 v[48:63], v[92:95], v[92:95], v[48:63]
    s_waitcnt vmcnt(0)
    s_mov_b32 s70, 40000
    v_readfirstlane_b32 s64, v13
    s_nop 0
    s_cmp_lg_u32 s64, 0
    s_cbranch_scc1 L_poll4_done
L_poll4:
    buffer_load_dword v13, off, s[52:55], 0 offset:128 sc1
    s_waitcnt vmcnt(0)
    v_readfirstlane_b32 s64, v13
    s_nop 0
    s_cmp_lg_u32 s64, 0
    s_cbranch_scc1 L_poll4_done
    s_sleep 4
    s_sub_u32 s70, s70, 1
    s_cmp_lg_u32 s70, 0
    s_cbranch_scc1 L_poll4
L_poll4_done:
    s_lshl_b32 s4, s78, 8
    s_add_u32 s4, s4, 79872
    s_add_u32 s6, s4, 512
    s_lshl_b32 s5, s3, 8
    s_add_u32 s5, s5, 80896
    v_and_b32 v2, 15, v0
    v_lshrrev_b32 v3, 4, v0
    v_cmp_gt_u32 vcc, 2, v2
    v_lshl_add_u32 v2, v2, 2, v3
    v_lshlrev_b32 v2, 4, v2
    v_add_u32 v2, s6, v2
    s_mov_b64 exec, vcc
    ds_write_b128 v2, v[22:25]
    s_mov_b64 exec, -1
    v_and_b32 v2, 15, v0
    v_lshrrev_b32 v3, 4, v0
    v_cmp_gt_u32 vcc, 2, v2
    v_lshl_add_u32 v2, v2, 2, v3
    v_lshlrev_b32 v2, 4, v2
    v_add_u32 v2, s5, v2
    s_mov_b64 exec, vcc
    ds_write_b128 v2, v[26:29]
    s_mov_b64 exec, -1
    v_and_b32 v4, 31, v0
    v_and_b32 v2, 1, v0
    v_cmp_ne_u32 vcc, 0, v2
    s_nop 1
    v_cndmask_b32 v48, v48, v49, vcc
    v_cndmask_b32 v50, v50, v51, vcc
    v_cndmask_b32 v52, v52, v53, vcc
    v_cndmask_b32 v54, v54, v55, vcc
    v_cndmask_b32 v56, v56, v57, vcc
    v_cndmask_b32 v58, v58, v59, vcc
    v_cndmask_b32 v60, v60, v61, vcc
    v_cndmask_b32 v62, v62, v63, vcc
    v_and_b32 v2, 2, v0
    v_cmp_ne_u32 vcc, 0, v2
    s_nop 1
    v_cndmask_b32 v48, v48, v50, vcc
    v_cndmask_b32 v52, v52, v54, vcc
    v_cndmask_b32 v56, v56, v58, vcc
    v_cndmask_b32 v60, v60, v62, vcc
    v_and_b32 v2, 8, v0
    v_cmp_ne_u32 vcc, 0, v2
    s_nop 1
    v_cndmask_b32 v48, v48, v52, vcc
    v_cndmask_b32 v56, v56, v60, vcc
    v_and_b32 v2, 16, v0
    v_cmp_ne_u32 vcc, 0, v2
    s_nop 1
    v_cndmask_b32 v48, v48, v56, vcc
    v_lshlrev_b32 v4, 2, v4
    v_bfe_u32 v2, v0, 2, 1
    v_lshrrev_b32 v7, 5, v0
    v_cmp_eq_u32 vcc, v2, v7
    v_add_u32 v5, s6, v4
    s_mov_b64 exec, vcc
    ds_write_b32 v5, v48 offset:128
    s_mov_b64 exec, -1
    v_add_u32 v5, s4, v4
    v_add_u32 v6, s5, v4
    v_lshl_add_u32 v7, v7, 4, s5
    s_waitcnt lgkmcnt(0)
    s_barrier
    ds_read2_b32 v[26:27], v5 offset1:32
    ds_read2_b32 v[22:23], v5 offset0:128 offset1:160
    ds_read_b32 v24, v6
    s_mov_b32 s4, 0x3acccccd
    s_waitcnt lgkmcnt(0)
    v_add_f32 v26, v26, v22
    v_add_f32 v27, v27, v23
    v_mul_f32 v26, s4, v26
    v_mul_f32 v27, s4, v27
    v_fma_f32 v27, -v26, v26, v27
    v_max_f32 v27, 0, v27
    v_add_f32 v27, 0x3727c5ac, v27
    v_sqrt_f32 v30, v27
    v_sub_f32 v28, 0, v26
    v_rcp_f32 v29, v30
    s_lshl_b32 s4, s76, 1
    s_add_u32 s4, s4, s78
    s_mul_i32 s5, s76, 6144
    v_lshlrev_b32 v8, 4, v0
    v_mul_f32 v28, v28, v29
    ds_write_b32 v6, v28
    ds_write_b32 v6, v29 offset:128
    s_waitcnt lgkmcnt(0)
    ds_read_b128 v[64:67], v7 offset:0
    ds_read_b128 v[80:83], v7 offset:128
    ds_read_b128 v[68:71], v7 offset:32
    ds_read_b128 v[84:87], v7 offset:160
    ds_read_b128 v[72:75], v7 offset:64
    ds_read_b128 v[88:91], v7 offset:192
    ds_read_b128 v[76:79], v7 offset:96
    ds_read_b128 v[92:95], v7 offset:224
    v_and_b32 v2, 31, v0
    v_cmp_gt_u32 vcc, 20, v2
    v_cmp_eq_u32 s[6:7], 20, v2
    s_nop 1
    v_cndmask_b32 v3, 0, v21, s[6:7]
    s_waitcnt lgkmcnt(0)
    v_mul_f32 v64, v24, v64
    v_mul_f32 v65, v24, v65
    v_mul_f32 v66, v24, v66
    v_mul_f32 v67, v24, v67
    v_mul_f32 v68, v24, v68
    v_mul_f32 v69, v24, v69
    v_mul_f32 v70, v24, v70
    v_mul_f32 v71, v24, v71
    v_mul_f32 v72, v24, v72
    v_mul_f32 v73, v24, v73
    v_mul_f32 v74, v24, v74
    v_mul_f32 v75, v24, v75
    v_mul_f32 v76, v24, v76
    v_mul_f32 v77, v24, v77
    v_mul_f32 v78, v24, v78
    v_mul_f32 v79, v24, v79
    v_fma_f32 v32, v32, v80, v64
    v_fma_f32 v33, v33, v81, v65
    v_fma_f32 v34, v34, v82, v66
    v_fma_f32 v35, v35, v83, v67
    v_fma_f32 v36, v36, v84, v68
    v_fma_f32 v37, v37, v85, v69
    v_fma_f32 v38, v38, v86, v70
    v_fma_f32 v39, v39, v87, v71
    v_fma_f32 v40, v40, v88, v72
    v_fma_f32 v41, v41, v89, v73
    v_fma_f32 v42, v42, v90, v74
    v_fma_f32 v43, v43, v91, v75
    v_fma_f32 v44, v44, v92, v76
    v_fma_f32 v45, v45, v93, v77
    v_fma_f32 v46, v46, v94, v78
    v_fma_f32 v47, v47, v95, v79
    v_cvt_pk_bf16_f32 v96, v32, v33
    v_cvt_pk_bf16_f32 v97, v34, v35
    v_cvt_pk_bf16_f32 v98, v36, v37
    v_cvt_pk_bf16_f32 v99, v38, v39
    v_cvt_pk_bf16_f32 v100, v40, v41
    v_cvt_pk_bf16_f32 v101, v42, v43
    v_cvt_pk_bf16_f32 v102, v44, v45
    v_cvt_pk_bf16_f32 v103, v46, v47
    v_cndmask_b32 v96, v3, v96, vcc
    v_cndmask_b32 v97, v3, v97, vcc
    v_cndmask_b32 v98, v3, v98, vcc
    v_cndmask_b32 v99, v3, v99, vcc
    v_cndmask_b32 v100, v3, v100, vcc
    v_cndmask_b32 v101, v3, v101, vcc
    v_cndmask_b32 v102, v3, v102, vcc
    v_cndmask_b32 v103, v3, v103, vcc
    v_lshrrev_b32 v9, 5, v0
    v_mul_u32_u24 v9, 128, v9
    v_sub_u32 v8, v8, v9
    s_mul_i32 s6, s78, 1536
    s_add_u32 s5, s5, s6
    s_mov_b32 exec_lo, 0xffffff
    s_mov_b32 exec_hi, 0xffffff
    buffer_store_dwordx4 v[96:99], v8, s[48:51], s5 offen offset:3072 sc1
    buffer_store_dwordx4 v[100:103], v8, s[48:51], s5 offen offset:3840 sc1
    s_mov_b64 exec, -1
L_kvpub:
    s_waitcnt vmcnt(0)
    s_barrier
    s_mov_b32 s44, s18
    s_mov_b32 s45, s19
    s_mov_b32 s46, 819200
    s_cmp_lg_u32 s3, 0
    s_cbranch_scc1 L_roleA2
    s_lshl_b32 s4, s76, 7
    s_add_u32 s4, s4, 0x80000
    v_mov_b32 v2, s64
    s_mov_b64 exec, 1
    buffer_store_dword v2, off, s[48:51], s4 sc1
    s_mov_b64 exec, -1
    s_branch L_roleA2
L_roleA:
    s_setprio 2
    s_lshr_b32 s5, s2, 3
    s_min_u32 s5, s5, 27
    s_lshl_b32 s5, s5, 2
    s_add_u32 s5, s5, s3
    v_lshlrev_b32 v2, 7, v0
    s_and_b32 s4, s2, 7
    s_mul_i32 s4, s4, 327680
    s_mul_i32 s6, s5, 2944
    s_add_u32 s4, s4, s6
    s_mov_b64 exec, 0x7fffff
    buffer_load_dword v31, v2, s[40:43], s4 offen
    s_bitcmp1_b32 s5, 0
    s_cselect_b32 s8, s20, s22
    s_cselect_b32 s9, s21, s23
    s_mov_b32 s10, 25600
    s_mov_b32 s11, 0x00020000
    s_lshr_b32 s6, s5, 1
    s_lshl_b32 s6, s6, 9
    s_mov_b64 exec, 0xf
    buffer_load_dword v31, v2, s[8:11], s6 offen
    s_mov_b64 exec, -1
    s_mul_i32 s6, s5, 18
    v_add_u32 v3, s6, v0
    v_mul_u32_u24 v4, 21846, v3
    v_lshrrev_b32 v4, 16, v4
    v_mul_u32_u24 v5, 896, v4
    v_lshl_add_u32 v3, v3, 7, v5
    s_and_b32 s6, s2, 3
    s_mul_i32 s6, s6, 320
    s_and_b32 s6, s6, 0xffffff80
    s_mov_b64 exec, 0x3ffff
    buffer_load_dword v31, v3, s[44:47], s6 offen
    s_mov_b64 exec, -1
L_roleA2:
    s_setprio 2
    s_and_b32 s4, s2, 3
    s_lshl_b32 s4, s4, 1
    s_bfe_u32 s5, s2, 0x10003
    s_add_u32 s79, s4, s5
    s_lshr_b32 s5, s2, 4
    s_and_b32 s4, s2, 4
    s_lshl_b32 s4, s4, 2
    s_add_u32 s76, s4, s5
    s_lshl_b32 s77, s76, 6
    s_lshl_b32 s4, s3, 4
    s_add_u32 s4, s4, s77
    v_lshrrev_b32 v2, 3, v0
    v_add_u32 v2, s4, v2
    v_mul_u32_u24 v2, 1280, v2
    v_lshrrev_b32 v3, 4, v0
    v_xor_b32 v3, v0, v3
    v_and_b32 v3, 7, v3
    v_lshl_add_u32 v10, v3, 4, v2
    v_xor_b32 v3, 4, v3
    v_lshl_add_u32 v11, v3, 4, v2
    v_add_u32 v11, 10240, v11
    s_mul_i32 s4, s3, 20480
    s_mul_i32 s5, s79, 160
    s_add_u32 s4, s4, s5
    s_lshl_b32 s80, s3, 11
    s_mul_i32 s81, s3, 3072
    s_add_u32 s81, s81, 8192
    s_and_b32 s6, s76, 3
    s_mul_i32 s6, s6, 5
    s_lshr_b32 s6, s6, 1
    s_mul_i32 s7, s79, 3
    s_add_u32 s6, s6, s7
    s_mul_i32 s7, s6, 6554
    s_lshr_b32 s7, s7, 16
    s_mul_i32 s7, s7, 10
    s_sub_u32 s6, s6, s7
    s_mov_b32 s6, 0
    s_mul_i32 s88, s6, 128
    s_mul_i32 s89, s6, 81920
    s_add_u32 m0, s80, 0
    s_nop 0
    buffer_load_dwordx4 v10, s[40:43], s88 offen lds
    s_add_u32 m0, s80, 1024
    s_nop 0
    buffer_load_dwordx4 v11, s[40:43], s88 offen lds
    s_add_u32 s88, s88, 128
    s_cmp_eq_u32 s88, 1280
    s_cselect_b32 s88, 0, s88
    v_mov_b32 v5, 0x40000000
    v_add_u32 v2, 0, v0
    v_mul_u32_u24 v3, 5462, v2
    v_lshrrev_b32 v3, 16, v3
    v_mul_u32_u24 v4, 12, v3
    v_sub_u32 v4, v2, v4
    v_cmp_lt_u32 vcc, 9, v4
    v_mul_u32_u24 v3, 1280, v3
    v_lshl_add_u32 v3, v4, 4, v3
    v_add_u32 v3, s4, v3
    v_cndmask_b32 v12, v3, v5, vcc
    v_add_u32 v2, 64, v0
    v_mul_u32_u24 v3, 5462, v2
    v_lshrrev_b32 v3, 16, v3
    v_mul_u32_u24 v4, 12, v3
    v_sub_u32 v4, v2, v4
    v_cmp_lt_u32 vcc, 9, v4
    v_mul_u32_u24 v3, 1280, v3
    v_lshl_add_u32 v3, v4, 4, v3
    v_add_u32 v3, s4, v3
    v_cndmask_b32 v13, v3, v5, vcc
    v_add_u32 v2, 128, v0
    v_mul_u32_u24 v3, 5462, v2
    v_lshrrev_b32 v3, 16, v3
    v_mul_u32_u24 v4, 12, v3
    v_sub_u32 v4, v2, v4
    v_cmp_lt_u32 vcc, 9, v4
    v_mul_u32_u24 v3, 1280, v3
    v_lshl_add_u32 v3, v4, 4, v3
    v_add_u32 v3, s4, v3
    v_cndmask_b32 v14, v3, v5, vcc
    s_add_u32 m0, s81, 0
    s_nop 0
    buffer_load_dwordx4 v12, s[44:47], s89 offen lds
    s_add_u32 m0, s81, 1024
    s_nop 0
    buffer_load_dwordx4 v13, s[44:47], s89 offen lds
    s_add_u32 m0, s81, 2048
    s_nop 0
    buffer_load_dwordx4 v14, s[44:47], s89 offen lds
    s_add_u32 s89, s89, 81920
    s_cmp_eq_u32 s89, 819200
    s_cselect_b32 s89, 0, s89
    s_add_u32 m0, s80, 20480
    s_nop 0
    buffer_load_dwordx4 v10, s[40:43], s88 offen lds
    s_add_u32 m0, s80, 21504
    s_nop 0
    buffer_load_dwordx4 v11, s[40:43], s88 offen lds
    s_add_u32 s88, s88, 128
    s_cmp_eq_u32 s88, 1280
    s_cselect_b32 s88, 0, s88
    s_add_u32 m0, s81, 20480
    s_nop 0
    buffer_load_dwordx4 v12, s[44:47], s89 offen lds
    s_add_u32 m0, s81, 21504
    s_nop 0
    buffer_load_dwordx4 v13, s[44:47], s89 offen lds
    s_add_u32 m0, s81, 22528
    s_nop 0
    buffer_load_dwordx4 v14, s[44:47], s89 offen lds
    s_add_u32 s89, s89, 81920
    s_cmp_eq_u32 s89, 819200
    s_cselect_b32 s89, 0, s89
    s_add_u32 m0, s80, 40960
    s_nop 0
    buffer_load_dwordx4 v10, s[40:43], s88 offen lds
    s_add_u32 m0, s80, 41984
    s_nop 0
    buffer_load_dwordx4 v11, s[40:43], s88 offen lds
    s_add_u32 s88, s88, 128
    s_cmp_eq_u32 s88, 1280
    s_cselect_b32 s88, 0, s88
    s_add_u32 m0, s81, 40960
    s_nop 0
    buffer_load_dwordx4 v12, s[44:47], s89 offen lds
    s_add_u32 m0, s81, 41984
    s_nop 0
    buffer_load_dwordx4 v13, s[44:47], s89 offen lds
    s_add_u32 m0, s81, 43008
    s_nop 0
    buffer_load_dwordx4 v14, s[44:47], s89 offen lds
    s_add_u32 s89, s89, 81920
    s_cmp_eq_u32 s89, 819200
    s_cselect_b32 s89, 0, s89
    s_add_u32 m0, s80, 61440
    s_nop 0
    buffer_load_dwordx4 v10, s[40:43], s88 offen lds
    s_add_u32 m0, s80, 62464
    s_nop 0
    buffer_load_dwordx4 v11, s[40:43], s88 offen lds
    s_add_u32 s88, s88, 128
    s_cmp_eq_u32 s88, 1280
    s_cselect_b32 s88, 0, s88
    s_add_u32 m0, s81, 61440
    s_nop 0
    buffer_load_dwordx4 v12, s[44:47], s89 offen lds
    s_add_u32 m0, s81, 62464
    s_nop 0
    buffer_load_dwordx4 v13, s[44:47], s89 offen lds
    s_add_u32 m0, s81, 63488
    s_nop 0
    buffer_load_dwordx4 v14, s[44:47], s89 offen lds
    s_add_u32 s89, s89, 81920
    s_cmp_eq_u32 s89, 819200
    s_cselect_b32 s89, 0, s89
    v_and_b32 v2, 31, v0
    v_lshrrev_b32 v3, 5, v0
    v_bfe_u32 v16, v0, 1, 3
    v_xor_b32 v3, v3, v16
    v_lshlrev_b32 v2, 7, v2
    v_add_u32 v2, 0, v2
    v_xor_b32 v16, 0, v3
    v_lshl_add_u32 v16, v16, 4, v2
    v_xor_b32 v17, 2, v3
    v_lshl_add_u32 v17, v17, 4, v2
    v_xor_b32 v18, 4, v3
    v_lshl_add_u32 v18, v18, 4, v2
    v_xor_b32 v19, 6, v3
    v_lshl_add_u32 v19, v19, 4, v2
    v_add_u32 v20, 40960, v16
    v_add_u32 v21, 40960, v17
    v_add_u32 v22, 40960, v18
    v_add_u32 v23, 40960, v19
    v_bfe_u32 v2, v0, 2, 2
    v_lshrrev_b32 v3, 5, v0
    v_mul_u32_u24 v3, 8, v3
    v_add_u32 v2, v2, v3
    v_and_b32 v3, 3, v0
    v_lshlrev_b32 v3, 3, v3
    v_mul_u32_u24 v2, 192, v2
    v_bfe_u32 v4, v0, 4, 1
    v_lshl_add_u32 v3, v4, 5, v3
    v_cmp_lt_u32 vcc, 39, v3
    s_mul_i32 s4, s3, 40
    v_add_u32 v3, s4, v3
    v_mov_b32 v4, 160
    v_cndmask_b32 v3, v3, v4, vcc
    v_add_u32 v2, 8192, v2
    v_add_u32 v24, v2, v3
    v_add_u32 v25, 40960, v24
    v_and_b32 v2, 15, v0
    v_bfe_u32 v3, v0, 4, 1
    v_cmp_eq_u32 vcc, v2, v3
    v_mov_b32 v2, 0x3f803f80
    s_nop 0
    v_cndmask_b32 v4, 0, v2, vcc
    v_cndmask_b32 v5, 0, v2, vcc
    v_cndmask_b32 v6, 0, v2, vcc
    v_cndmask_b32 v7, 0, v2, vcc
    v_mov_b32 v32, 0
    v_mov_b32 v33, 0
    v_mov_b32 v34, 0
    v_mov_b32 v35, 0
    v_mov_b32 v36, 0
    v_mov_b32 v37, 0
    v_mov_b32 v38, 0
    v_mov_b32 v39, 0
    v_mov_b32 v40, 0
    v_mov_b32 v41, 0
    v_mov_b32 v42, 0
    v_mov_b32 v43, 0
    v_mov_b32 v44, 0
    v_mov_b32 v45, 0
    v_mov_b32 v46, 0
    v_mov_b32 v47, 0
    v_mov_b32 v48, 0
    v_mov_b32 v49, 0
    v_mov_b32 v50, 0
    v_mov_b32 v51, 0
    v_mov_b32 v52, 0
    v_mov_b32 v53, 0
    v_mov_b32 v54, 0
    v_mov_b32 v55, 0
    v_mov_b32 v56, 0
    v_mov_b32 v57, 0
    v_mov_b32 v58, 0
    v_mov_b32 v59, 0
    v_mov_b32 v60, 0
    v_mov_b32 v61, 0
    v_mov_b32 v62, 0
    v_mov_b32 v63, 0
    v_mov_b32 v26, 0
    v_mov_b32 v27, 0
    v_mov_b32 v28, 0
    v_mov_b32 v29, 0
    s_waitcnt vmcnt(15) lgkmcnt(0)
    s_barrier
    ds_read_b128 v[64:67], v16 offset:0
    ds_read_b128 v[68:71], v16 offset:4096
    ds_read_b64_tr_b16 v[96:97], v24 offset:0
    ds_read_b64_tr_b16 v[98:99], v24 offset:768
    ds_read_b128 v[72:75], v17 offset:0
    ds_read_b128 v[76:79], v17 offset:4096
    ds_read_b64_tr_b16 v[100:101], v24 offset:3072
    ds_read_b64_tr_b16 v[102:103], v24 offset:3840
    ds_read_b128 v[80:83], v18 offset:0
    ds_read_b128 v[84:87], v18 offset:4096
    ds_read_b64_tr_b16 v[104:105], v24 offset:6144
    ds_read_b64_tr_b16 v[106:107], v24 offset:6912
    ds_read_b128 v[88:91], v19 offset:0
    ds_read_b128 v[92:95], v19 offset:4096
    ds_read_b64_tr_b16 v[108:109], v24 offset:9216
    ds_read_b64_tr_b16 v[110:111], v24 offset:9984
    s_waitcnt vmcnt(10) lgkmcnt(0)
    s_barrier
    v_mfma_f32_32x32x16_bf16 v[32:47], v[96:99], v[64:67], v[32:47]
    s_add_u32 m0, s80, 0
    s_nop 0
    buffer_load_dwordx4 v10, s[40:43], s88 offen lds
    ds_read_b128 v[112:115], v16 offset:20480
    v_mfma_f32_16x16x32_bf16 v[26:29], v[96:99], v[4:7], v[26:29]
    ds_read_b128 v[116:119], v16 offset:24576
    v_mfma_f32_32x32x16_bf16 v[48:63], v[96:99], v[68:71], v[48:63]
    s_add_u32 m0, s80, 1024
    s_nop 0
    buffer_load_dwordx4 v11, s[40:43], s88 offen lds
    s_add_u32 s88, s88, 128
    s_cmp_eq_u32 s88, 1280
    s_cselect_b32 s88, 0, s88
    ds_read_b64_tr_b16 v[144:145], v24 offset:20480
    ds_read_b64_tr_b16 v[146:147], v24 offset:21248
    v_mfma_f32_32x32x16_bf16 v[32:47], v[100:103], v[72:75], v[32:47]
    s_add_u32 m0, s81, 0
    s_nop 0
    buffer_load_dwordx4 v12, s[44:47], s89 offen lds
    ds_read_b128 v[120:123], v17 offset:20480
    v_mfma_f32_16x16x32_bf16 v[26:29], v[100:103], v[4:7], v[26:29]
    ds_read_b128 v[124:127], v17 offset:24576
    v_mfma_f32_32x32x16_bf16 v[48:63], v[100:103], v[76:79], v[48:63]
    s_add_u32 m0, s81, 1024
    s_nop 0
    buffer_load_dwordx4 v13, s[44:47], s89 offen lds
    ds_read_b64_tr_b16 v[148:149], v24 offset:23552
    ds_read_b64_tr_b16 v[150:151], v24 offset:24320
    v_mfma_f32_32x32x16_bf16 v[32:47], v[104:107], v[80:83], v[32:47]
    s_add_u32 m0, s81, 2048
    s_nop 0
    buffer_load_dwordx4 v14, s[44:47], s89 offen lds
    s_add_u32 s89, s89, 81920
    s_cmp_eq_u32 s89, 819200
    s_cselect_b32 s89, 0, s89
    ds_read_b128 v[128:131], v18 offset:20480
    v_mfma_f32_16x16x32_bf16 v[26:29], v[104:107], v[4:7], v[26:29]
    ds_read_b128 v[132:135], v18 offset:24576
    v_mfma_f32_32x32x16_bf16 v[48:63], v[104:107], v[84:87], v[48:63]
    ds_read_b64_tr_b16 v[152:153], v24 offset:26624
    ds_read_b64_tr_b16 v[154:155], v24 offset:27392
    v_mfma_f32_32x32x16_bf16 v[32:47], v[108:111], v[88:91], v[32:47]
    ds_read_b128 v[136:139], v19 offset:20480
    v_mfma_f32_16x16x32_bf16 v[26:29], v[108:111], v[4:7], v[26:29]
    ds_read_b128 v[140:143], v19 offset:24576
    v_mfma_f32_32x32x16_bf16 v[48:63], v[108:111], v[92:95], v[48:63]
    ds_read_b64_tr_b16 v[156:157], v24 offset:29696
    ds_read_b64_tr_b16 v[158:159], v24 offset:30464
    s_waitcnt vmcnt(10) lgkmcnt(0)
    s_barrier
    v_mfma_f32_32x32x16_bf16 v[32:47], v[144:147], v[112:115], v[32:47]
    s_add_u32 m0, s80, 20480
    s_nop 0
    buffer_load_dwordx4 v10, s[40:43], s88 offen lds
    ds_read_b128 v[64:67], v20 offset:0
    v_mfma_f32_16x16x32_bf16 v[26:29], v[144:147], v[4:7], v[26:29]
    ds_read_b128 v[68:71], v20 offset:4096
    v_mfma_f32_32x32x16_bf16 v[48:63], v[144:147], v[116:119], v[48:63]
    s_add_u32 m0, s80, 21504
    s_nop 0
    buffer_load_dwordx4 v11, s[40:43], s88 offen lds
    s_add_u32 s88, s88, 128
    s_cmp_eq_u32 s88, 1280
    s_cselect_b32 s88, 0, s88
    ds_read_b64_tr_b16 v[96:97], v25 offset:0
    ds_read_b64_tr_b16 v[98:99], v25 offset:768
    v_mfma_f32_32x32x16_bf16 v[32:47], v[148:151], v[120:123], v[32:47]
    s_add_u32 m0, s81, 20480
    s_nop 0
    buffer_load_dwordx4 v12, s[44:47], s89 offen lds
    ds_read_b128 v[72:75], v21 offset:0
    v_mfma_f32_16x16x32_bf16 v[26:29], v[148:151], v[4:7], v[26:29]
    ds_read_b128 v[76:79], v21 offset:4096
    v_mfma_f32_32x32x16_bf16 v[48:63], v[148:151], v[124:127], v[48:63]
    s_add_u32 m0, s81, 21504
    s_nop 0
    buffer_load_dwordx4 v13, s[44:47], s89 offen lds
    ds_read_b64_tr_b16 v[100:101], v25 offset:3072
    ds_read_b64_tr_b16 v[102:103], v25 offset:3840
    v_mfma_f32_32x32x16_bf16 v[32:47], v[152:155], v[128:131], v[32:47]
    s_add_u32 m0, s81, 22528
    s_nop 0
    buffer_load_dwordx4 v14, s[44:47], s89 offen lds
    s_add_u32 s89, s89, 81920
    s_cmp_eq_u32 s89, 819200
    s_cselect_b32 s89, 0, s89
    ds_read_b128 v[80:83], v22 offset:0
    v_mfma_f32_16x16x32_bf16 v[26:29], v[152:155], v[4:7], v[26:29]
    ds_read_b128 v[84:87], v22 offset:4096
    v_mfma_f32_32x32x16_bf16 v[48:63], v[152:155], v[132:135], v[48:63]
    ds_read_b64_tr_b16 v[104:105], v25 offset:6144
    ds_read_b64_tr_b16 v[106:107], v25 offset:6912
    v_mfma_f32_32x32x16_bf16 v[32:47], v[156:159], v[136:139], v[32:47]
    ds_read_b128 v[88:91], v23 offset:0
    v_mfma_f32_16x16x32_bf16 v[26:29], v[156:159], v[4:7], v[26:29]
    ds_read_b128 v[92:95], v23 offset:4096
    v_mfma_f32_32x32x16_bf16 v[48:63], v[156:159], v[140:143], v[48:63]
    ds_read_b64_tr_b16 v[108:109], v25 offset:9216
    ds_read_b64_tr_b16 v[110:111], v25 offset:9984
    s_waitcnt vmcnt(10) lgkmcnt(0)
    s_barrier
    v_mfma_f32_32x32x16_bf16 v[32:47], v[96:99], v[64:67], v[32:47]
    s_add_u32 m0, s80, 40960
    s_nop 0
    buffer_load_dwordx4 v10, s[40:43], s88 offen lds
    ds_read_b128 v[112:115], v20 offset:20480
    v_mfma_f32_16x16x32_bf16 v[26:29], v[96:99], v[4:7], v[26:29]
    ds_read_b128 v[116:119], v20 offset:24576
    v_mfma_f32_32x32x16_bf16 v[48:63], v[96:99], v[68:71], v[48:63]
    s_add_u32 m0, s80, 41984
    s_nop 0
    buffer_load_dwordx4 v11, s[40:43], s88 offen lds
    s_add_u32 s88, s88, 128
    s_cmp_eq_u32 s88, 1280
    s_cselect_b32 s88, 0, s88
    ds_read_b64_tr_b16 v[144:145], v25 offset:20480
    ds_read_b64_tr_b16 v[146:147], v25 offset:21248
    v_mfma_f32_32x32x16_bf16 v[32:47], v[100:103], v[72:75], v[32:47]
    s_add_u32 m0, s81, 40960
    s_nop 0
    buffer_load_dwordx4 v12, s[44:47], s89 offen lds
    ds_read_b128 v[120:123], v21 offset:20480
    v_mfma_f32_16x16x32_bf16 v[26:29], v[100:103], v[4:7], v[26:29]
    ds_read_b128 v[124:127], v21 offset:24576
    v_mfma_f32_32x32x16_bf16 v[48:63], v[100:103], v[76:79], v[48:63]
    s_add_u32 m0, s81, 41984
    s_nop 0
    buffer_load_dwordx4 v13, s[44:47], s89 offen lds
    ds_read_b64_tr_b16 v[148:149], v25 offset:23552
    ds_read_b64_tr_b16 v[150:151], v25 offset:24320
    v_mfma_f32_32x32x16_bf16 v[32:47], v[104:107], v[80:83], v[32:47]
    s_add_u32 m0, s81, 43008
    s_nop 0
    buffer_load_dwordx4 v14, s[44:47], s89 offen lds
    s_add_u32 s89, s89, 81920
    s_cmp_eq_u32 s89, 819200
    s_cselect_b32 s89, 0, s89
    ds_read_b128 v[128:131], v22 offset:20480
    v_mfma_f32_16x16x32_bf16 v[26:29], v[104:107], v[4:7], v[26:29]
    ds_read_b128 v[132:135], v22 offset:24576
    v_mfma_f32_32x32x16_bf16 v[48:63], v[104:107], v[84:87], v[48:63]
    ds_read_b64_tr_b16 v[152:153], v25 offset:26624
    ds_read_b64_tr_b16 v[154:155], v25 offset:27392
    v_mfma_f32_32x32x16_bf16 v[32:47], v[108:111], v[88:91], v[32:47]
    ds_read_b128 v[136:139], v23 offset:20480
    v_mfma_f32_16x16x32_bf16 v[26:29], v[108:111], v[4:7], v[26:29]
    ds_read_b128 v[140:143], v23 offset:24576
    v_mfma_f32_32x32x16_bf16 v[48:63], v[108:111], v[92:95], v[48:63]
    ds_read_b64_tr_b16 v[156:157], v25 offset:29696
    ds_read_b64_tr_b16 v[158:159], v25 offset:30464
    s_waitcnt vmcnt(10) lgkmcnt(0)
    s_barrier
    v_mfma_f32_32x32x16_bf16 v[32:47], v[144:147], v[112:115], v[32:47]
    s_add_u32 m0, s80, 61440
    s_nop 0
    buffer_load_dwordx4 v10, s[40:43], s88 offen lds
    ds_read_b128 v[64:67], v16 offset:0
    v_mfma_f32_16x16x32_bf16 v[26:29], v[144:147], v[4:7], v[26:29]
    ds_read_b128 v[68:71], v16 offset:4096
    v_mfma_f32_32x32x16_bf16 v[48:63], v[144:147], v[116:119], v[48:63]
    s_add_u32 m0, s80, 62464
    s_nop 0
    buffer_load_dwordx4 v11, s[40:43], s88 offen lds
    s_add_u32 s88, s88, 128
    s_cmp_eq_u32 s88, 1280
    s_cselect_b32 s88, 0, s88
    ds_read_b64_tr_b16 v[96:97], v24 offset:0
    ds_read_b64_tr_b16 v[98:99], v24 offset:768
    v_mfma_f32_32x32x16_bf16 v[32:47], v[148:151], v[120:123], v[32:47]
    s_add_u32 m0, s81, 61440
    s_nop 0
    buffer_load_dwordx4 v12, s[44:47], s89 offen lds
    ds_read_b128 v[72:75], v17 offset:0
    v_mfma_f32_16x16x32_bf16 v[26:29], v[148:151], v[4:7], v[26:29]
    ds_read_b128 v[76:79], v17 offset:4096
    v_mfma_f32_32x32x16_bf16 v[48:63], v[148:151], v[124:127], v[48:63]
    s_add_u32 m0, s81, 62464
    s_nop 0
    buffer_load_dwordx4 v13, s[44:47], s89 offen lds
    ds_read_b64_tr_b16 v[100:101], v24 offset:3072
    ds_read_b64_tr_b16 v[102:103], v24 offset:3840
    v_mfma_f32_32x32x16_bf16 v[32:47], v[152:155], v[128:131], v[32:47]
    s_add_u32 m0, s81, 63488
    s_nop 0
    buffer_load_dwordx4 v14, s[44:47], s89 offen lds
    s_add_u32 s89, s89, 81920
    s_cmp_eq_u32 s89, 819200
    s_cselect_b32 s89, 0, s89
    ds_read_b128 v[80:83], v18 offset:0
    v_mfma_f32_16x16x32_bf16 v[26:29], v[152:155], v[4:7], v[26:29]
    ds_read_b128 v[84:87], v18 offset:4096
    v_mfma_f32_32x32x16_bf16 v[48:63], v[152:155], v[132:135], v[48:63]
    ds_read_b64_tr_b16 v[104:105], v24 offset:6144
    ds_read_b64_tr_b16 v[106:107], v24 offset:6912
    v_mfma_f32_32x32x16_bf16 v[32:47], v[156:159], v[136:139], v[32:47]
    ds_read_b128 v[88:91], v19 offset:0
    v_mfma_f32_16x16x32_bf16 v[26:29], v[156:159], v[4:7], v[26:29]
    ds_read_b128 v[92:95], v19 offset:4096
    v_mfma_f32_32x32x16_bf16 v[48:63], v[156:159], v[140:143], v[48:63]
    ds_read_b64_tr_b16 v[108:109], v24 offset:9216
    ds_read_b64_tr_b16 v[110:111], v24 offset:9984
    s_waitcnt vmcnt(10) lgkmcnt(0)
    s_barrier
    v_mfma_f32_32x32x16_bf16 v[32:47], v[96:99], v[64:67], v[32:47]
    s_add_u32 m0, s80, 0
    s_nop 0
    buffer_load_dwordx4 v10, s[40:43], s88 offen lds
    ds_read_b128 v[112:115], v16 offset:20480
    v_mfma_f32_16x16x32_bf16 v[26:29], v[96:99], v[4:7], v[26:29]
    ds_read_b128 v[116:119], v16 offset:24576
    v_mfma_f32_32x32x16_bf16 v[48:63], v[96:99], v[68:71], v[48:63]
    s_add_u32 m0, s80, 1024
    s_nop 0
    buffer_load_dwordx4 v11, s[40:43], s88 offen lds
    s_add_u32 s88, s88, 128
    s_cmp_eq_u32 s88, 1280
    s_cselect_b32 s88, 0, s88
    ds_read_b64_tr_b16 v[144:145], v24 offset:20480
    ds_read_b64_tr_b16 v[146:147], v24 offset:21248
    v_mfma_f32_32x32x16_bf16 v[32:47], v[100:103], v[72:75], v[32:47]
    s_add_u32 m0, s81, 0
    s_nop 0
    buffer_load_dwordx4 v12, s[44:47], s89 offen lds
    ds_read_b128 v[120:123], v17 offset:20480
    v_mfma_f32_16x16x32_bf16 v[26:29], v[100:103], v[4:7], v[26:29]
    ds_read_b128 v[124:127], v17 offset:24576
    v_mfma_f32_32x32x16_bf16 v[48:63], v[100:103], v[76:79], v[48:63]
    s_add_u32 m0, s81, 1024
    s_nop 0
    buffer_load_dwordx4 v13, s[44:47], s89 offen lds
    ds_read_b64_tr_b16 v[148:149], v24 offset:23552
    ds_read_b64_tr_b16 v[150:151], v24 offset:24320
    v_mfma_f32_32x32x16_bf16 v[32:47], v[104:107], v[80:83], v[32:47]
    s_add_u32 m0, s81, 2048
    s_nop 0
    buffer_load_dwordx4 v14, s[44:47], s89 offen lds
    s_add_u32 s89, s89, 81920
    s_cmp_eq_u32 s89, 819200
    s_cselect_b32 s89, 0, s89
    ds_read_b128 v[128:131], v18 offset:20480
    v_mfma_f32_16x16x32_bf16 v[26:29], v[104:107], v[4:7], v[26:29]
    ds_read_b128 v[132:135], v18 offset:24576
    v_mfma_f32_32x32x16_bf16 v[48:63], v[104:107], v[84:87], v[48:63]
    ds_read_b64_tr_b16 v[152:153], v24 offset:26624
    ds_read_b64_tr_b16 v[154:155], v24 offset:27392
    v_mfma_f32_32x32x16_bf16 v[32:47], v[108:111], v[88:91], v[32:47]
    ds_read_b128 v[136:139], v19 offset:20480
    v_mfma_f32_16x16x32_bf16 v[26:29], v[108:111], v[4:7], v[26:29]
    ds_read_b128 v[140:143], v19 offset:24576
    v_mfma_f32_32x32x16_bf16 v[48:63], v[108:111], v[92:95], v[48:63]
    ds_read_b64_tr_b16 v[156:157], v24 offset:29696
    ds_read_b64_tr_b16 v[158:159], v24 offset:30464
    s_waitcnt vmcnt(10) lgkmcnt(0)
    s_barrier
    v_mfma_f32_32x32x16_bf16 v[32:47], v[144:147], v[112:115], v[32:47]
    s_add_u32 m0, s80, 20480
    s_nop 0
    buffer_load_dwordx4 v10, s[40:43], s88 offen lds
    ds_read_b128 v[64:67], v20 offset:0
    v_mfma_f32_16x16x32_bf16 v[26:29], v[144:147], v[4:7], v[26:29]
    ds_read_b128 v[68:71], v20 offset:4096
    v_mfma_f32_32x32x16_bf16 v[48:63], v[144:147], v[116:119], v[48:63]
    s_add_u32 m0, s80, 21504
    s_nop 0
    buffer_load_dwordx4 v11, s[40:43], s88 offen lds
    s_add_u32 s88, s88, 128
    s_cmp_eq_u32 s88, 1280
    s_cselect_b32 s88, 0, s88
    ds_read_b64_tr_b16 v[96:97], v25 offset:0
    ds_read_b64_tr_b16 v[98:99], v25 offset:768
    v_mfma_f32_32x32x16_bf16 v[32:47], v[148:151], v[120:123], v[32:47]
    s_add_u32 m0, s81, 20480
    s_nop 0
    buffer_load_dwordx4 v12, s[44:47], s89 offen lds
    ds_read_b128 v[72:75], v21 offset:0
    v_mfma_f32_16x16x32_bf16 v[26:29], v[148:151], v[4:7], v[26:29]
    ds_read_b128 v[76:79], v21 offset:4096
    v_mfma_f32_32x32x16_bf16 v[48:63], v[148:151], v[124:127], v[48:63]
    s_add_u32 m0, s81, 21504
    s_nop 0
    buffer_load_dwordx4 v13, s[44:47], s89 offen lds
    ds_read_b64_tr_b16 v[100:101], v25 offset:3072
    ds_read_b64_tr_b16 v[102:103], v25 offset:3840
    v_mfma_f32_32x32x16_bf16 v[32:47], v[152:155], v[128:131], v[32:47]
    s_add_u32 m0, s81, 22528
    s_nop 0
    buffer_load_dwordx4 v14, s[44:47], s89 offen lds
    s_add_u32 s89, s89, 81920
    s_cmp_eq_u32 s89, 819200
    s_cselect_b32 s89, 0, s89
    ds_read_b128 v[80:83], v22 offset:0
    v_mfma_f32_16x16x32_bf16 v[26:29], v[152:155], v[4:7], v[26:29]
    ds_read_b128 v[84:87], v22 offset:4096
    v_mfma_f32_32x32x16_bf16 v[48:63], v[152:155], v[132:135], v[48:63]
    ds_read_b64_tr_b16 v[104:105], v25 offset:6144
    ds_read_b64_tr_b16 v[106:107], v25 offset:6912
    v_mfma_f32_32x32x16_bf16 v[32:47], v[156:159], v[136:139], v[32:47]
    ds_read_b128 v[88:91], v23 offset:0
    v_mfma_f32_16x16x32_bf16 v[26:29], v[156:159], v[4:7], v[26:29]
    ds_read_b128 v[92:95], v23 offset:4096
    v_mfma_f32_32x32x16_bf16 v[48:63], v[156:159], v[140:143], v[48:63]
    ds_read_b64_tr_b16 v[108:109], v25 offset:9216
    ds_read_b64_tr_b16 v[110:111], v25 offset:9984
    s_waitcnt vmcnt(10) lgkmcnt(0)
    s_barrier
    v_lshlrev_b32 v14, 7, v0
    s_mov_b32 s98, 0x80000
    v_mfma_f32_32x32x16_bf16 v[32:47], v[96:99], v[64:67], v[32:47]
    buffer_load_dword v30, off, s[52:55], 0 offset:128 sc1
    ds_read_b128 v[112:115], v20 offset:20480
    v_mfma_f32_16x16x32_bf16 v[26:29], v[96:99], v[4:7], v[26:29]
    ds_read_b128 v[116:119], v20 offset:24576
    v_mfma_f32_32x32x16_bf16 v[48:63], v[96:99], v[68:71], v[48:63]
    ds_read_b64_tr_b16 v[144:145], v25 offset:20480
    ds_read_b64_tr_b16 v[146:147], v25 offset:21248
    v_mfma_f32_32x32x16_bf16 v[32:47], v[100:103], v[72:75], v[32:47]
    ds_read_b128 v[120:123], v21 offset:20480
    v_mfma_f32_16x16x32_bf16 v[26:29], v[100:103], v[4:7], v[26:29]
    ds_read_b128 v[124:127], v21 offset:24576
    v_mfma_f32_32x32x16_bf16 v[48:63], v[100:103], v[76:79], v[48:63]
    ds_read_b64_tr_b16 v[148:149], v25 offset:23552
    ds_read_b64_tr_b16 v[150:151], v25 offset:24320
    v_mfma_f32_32x32x16_bf16 v[32:47], v[104:107], v[80:83], v[32:47]
    ds_read_b128 v[128:131], v22 offset:20480
    v_mfma_f32_16x16x32_bf16 v[26:29], v[104:107], v[4:7], v[26:29]
    ds_read_b128 v[132:135], v22 offset:24576
    v_mfma_f32_32x32x16_bf16 v[48:63], v[104:107], v[84:87], v[48:63]
    ds_read_b64_tr_b16 v[152:153], v25 offset:26624
    ds_read_b64_tr_b16 v[154:155], v25 offset:27392
    v_mfma_f32_32x32x16_bf16 v[32:47], v[108:111], v[88:91], v[32:47]
    ds_read_b128 v[136:139], v23 offset:20480
    v_mfma_f32_16x16x32_bf16 v[26:29], v[108:111], v[4:7], v[26:29]
    ds_read_b128 v[140:143], v23 offset:24576
    v_mfma_f32_32x32x16_bf16 v[48:63], v[108:111], v[92:95], v[48:63]
    ds_read_b64_tr_b16 v[156:157], v25 offset:29696
    ds_read_b64_tr_b16 v[158:159], v25 offset:30464
    s_waitcnt vmcnt(6) lgkmcnt(0)
    s_barrier
    v_mfma_f32_32x32x16_bf16 v[32:47], v[144:147], v[112:115], v[32:47]
    ds_read_b128 v[64:67], v16 offset:0
    v_mfma_f32_16x16x32_bf16 v[26:29], v[144:147], v[4:7], v[26:29]
    ds_read_b128 v[68:71], v16 offset:4096
    v_mfma_f32_32x32x16_bf16 v[48:63], v[144:147], v[116:119], v[48:63]
    ds_read_b64_tr_b16 v[96:97], v24 offset:0
    ds_read_b64_tr_b16 v[98:99], v24 offset:768
    v_mfma_f32_32x32x16_bf16 v[32:47], v[148:151], v[120:123], v[32:47]
    ds_read_b128 v[72:75], v17 offset:0
    v_mfma_f32_16x16x32_bf16 v[26:29], v[148:151], v[4:7], v[26:29]
    ds_read_b128 v[76:79], v17 offset:4096
    v_mfma_f32_32x32x16_bf16 v[48:63], v[148:151], v[124:127], v[48:63]
    ds_read_b64_tr_b16 v[100:101], v24 offset:3072
    ds_read_b64_tr_b16 v[102:103], v24 offset:3840
    v_mfma_f32_32x32x16_bf16 v[32:47], v[152:155], v[128:131], v[32:47]
    ds_read_b128 v[80:83], v18 offset:0
    v_mfma_f32_16x16x32_bf16 v[26:29], v[152:155], v[4:7], v[26:29]
    ds_read_b128 v[84:87], v18 offset:4096
    v_mfma_f32_32x32x16_bf16 v[48:63], v[152:155], v[132:135], v[48:63]
    ds_read_b64_tr_b16 v[104:105], v24 offset:6144
    ds_read_b64_tr_b16 v[106:107], v24 offset:6912
    v_mfma_f32_32x32x16_bf16 v[32:47], v[156:159], v[136:139], v[32:47]
    ds_read_b128 v[88:91], v19 offset:0
    v_mfma_f32_16x16x32_bf16 v[26:29], v[156:159], v[4:7], v[26:29]
    ds_read_b128 v[92:95], v19 offset:4096
    v_mfma_f32_32x32x16_bf16 v[48:63], v[156:159], v[140:143], v[48:63]
    ds_read_b64_tr_b16 v[108:109], v24 offset:9216
    ds_read_b64_tr_b16 v[110:111], v24 offset:9984
    s_waitcnt vmcnt(1) lgkmcnt(0)
    s_barrier
    v_mfma_f32_32x32x16_bf16 v[32:47], v[96:99], v[64:67], v[32:47]
    ds_read_b128 v[112:115], v16 offset:20480
    v_mfma_f32_16x16x32_bf16 v[26:29], v[96:99], v[4:7], v[26:29]
    ds_read_b128 v[116:119], v16 offset:24576
    v_mfma_f32_32x32x16_bf16 v[48:63], v[96:99], v[68:71], v[48:63]
    ds_read_b64_tr_b16 v[144:145], v24 offset:20480
    ds_read_b64_tr_b16 v[146:147], v24 offset:21248
    v_mfma_f32_32x32x16_bf16 v[32:47], v[100:103], v[72:75], v[32:47]
    ds_read_b128 v[120:123], v17 offset:20480
    v_mfma_f32_16x16x32_bf16 v[26:29], v[100:103], v[4:7], v[26:29]
    ds_read_b128 v[124:127], v17 offset:24576
    v_mfma_f32_32x32x16_bf16 v[48:63], v[100:103], v[76:79], v[48:63]
    ds_read_b64_tr_b16 v[148:149], v24 offset:23552
    ds_read_b64_tr_b16 v[150:151], v24 offset:24320
    v_mfma_f32_32x32x16_bf16 v[32:47], v[104:107], v[80:83], v[32:47]
    ds_read_b128 v[128:131], v18 offset:20480
    v_mfma_f32_16x16x32_bf16 v[26:29], v[104:107], v[4:7], v[26:29]
    ds_read_b128 v[132:135], v18 offset:24576
    v_mfma_f32_32x32x16_bf16 v[48:63], v[104:107], v[84:87], v[48:63]
    ds_read_b64_tr_b16 v[152:153], v24 offset:26624
    ds_read_b64_tr_b16 v[154:155], v24 offset:27392
    v_mfma_f32_32x32x16_bf16 v[32:47], v[108:111], v[88:91], v[32:47]
    ds_read_b128 v[136:139], v19 offset:20480
    v_mfma_f32_16x16x32_bf16 v[26:29], v[108:111], v[4:7], v[26:29]
    ds_read_b128 v[140:143], v19 offset:24576
    v_mfma_f32_32x32x16_bf16 v[48:63], v[108:111], v[92:95], v[48:63]
    ds_read_b64_tr_b16 v[156:157], v24 offset:29696
    ds_read_b64_tr_b16 v[158:159], v24 offset:30464
    s_waitcnt lgkmcnt(0)
    s_barrier
    v_mfma_f32_32x32x16_bf16 v[32:47], v[144:147], v[112:115], v[32:47]
    s_mov_b32 s66, -1
    s_mov_b32 s67, 0
    s_mov_b64 exec, s[66:67]
    buffer_load_dword v8, v14, s[48:51], s98 offen sc1
    s_mov_b64 exec, -1
    v_mfma_f32_16x16x32_bf16 v[26:29], v[144:147], v[4:7], v[26:29]
    v_mfma_f32_32x32x16_bf16 v[48:63], v[144:147], v[116:119], v[48:63]
    v_mfma_f32_32x32x16_bf16 v[32:47], v[148:151], v[120:123], v[32:47]
    v_mfma_f32_16x16x32_bf16 v[26:29], v[148:151], v[4:7], v[26:29]
    v_mfma_f32_32x32x16_bf16 v[48:63], v[148:151], v[124:127], v[48:63]
    v_mfma_f32_32x32x16_bf16 v[32:47], v[152:155], v[128:131], v[32:47]
    v_mfma_f32_16x16x32_bf16 v[26:29], v[152:155], v[4:7], v[26:29]
    v_mfma_f32_32x32x16_bf16 v[48:63], v[152:155], v[132:135], v[48:63]
    v_mfma_f32_32x32x16_bf16 v[32:47], v[156:159], v[136:139], v[32:47]
    v_mfma_f32_16x16x32_bf16 v[26:29], v[156:159], v[4:7], v[26:29]
    v_mfma_f32_32x32x16_bf16 v[48:63], v[156:159], v[140:143], v[48:63]
    s_lshl_b32 s5, s3, 7
    s_add_u32 s5, s5, 57344
    v_and_b32 v2, 15, v0
    v_lshrrev_b32 v3, 4, v0
    v_cmp_gt_u32 vcc, 2, v2
    v_lshl_add_u32 v2, v2, 2, v3
    v_lshlrev_b32 v2, 4, v2
    v_add_u32 v2, s5, v2
    s_mov_b64 exec, vcc
    ds_write_b128 v2, v[26:29]
    s_mov_b64 exec, -1
    v_and_b32 v4, 31, v0
    v_lshrrev_b32 v7, 5, v0
    v_mul_u32_u24 v11, 384, v7
    v_min_u32 v5, 23, v4
    v_lshl_add_u32 v11, v5, 4, v11
    v_lshl_add_u32 v7, v7, 4, s5
    s_waitcnt lgkmcnt(0)
    ds_read_b128 v[64:67], v7 offset:0
    ds_read_b128 v[68:71], v7 offset:32
    ds_read_b128 v[72:75], v7 offset:64
    v_lshlrev_b32 v10, 4, v0
    v_lshlrev_b32 v4, 4, v4
    v_cmp_gt_u32 s[84:85], 32, v0
    v_mov_b32 v176, 0
    v_mov_b32 v177, 0
    v_mov_b32 v178, 0
    v_mov_b32 v179, 0
    v_mov_b32 v180, 0
    v_mov_b32 v181, 0
    v_mov_b32 v182, 0
    v_mov_b32 v183, 0
    v_mov_b32 v184, 0
    v_mov_b32 v185, 0
    v_mov_b32 v186, 0
    v_mov_b32 v187, 0
    v_mov_b32 v188, 0
    v_mov_b32 v189, 0
    v_mov_b32 v190, 0
    v_mov_b32 v191, 0
    v_mov_b32 v192, 0
    v_mov_b32 v193, 0
    v_mov_b32 v194, 0
    v_mov_b32 v195, 0
    v_mov_b32 v196, 0
    v_mov_b32 v197, 0
    v_mov_b32 v198, 0
    v_mov_b32 v199, 0
    v_mov_b32 v200, 0
    v_mov_b32 v201, 0
    v_mov_b32 v202, 0
    v_mov_b32 v203, 0
    v_mov_b32 v204, 0
    v_mov_b32 v205, 0
    v_mov_b32 v206, 0
    v_mov_b32 v207, 0
    v_mov_b32 v104, 0
    v_mov_b32 v105, 0
    v_mov_b32 v106, 0
    v_mov_b32 v107, 0
    v_mov_b32 v108, 0
    v_mov_b32 v109, 0
    v_mov_b32 v110, 0
    v_mov_b32 v111, 0
    v_mov_b32 v132, 0
    v_mov_b32 v133, 0
    v_mov_b32 v134, 0
    v_mov_b32 v135, 0
    v_mov_b32 v136, 0
    v_mov_b32 v137, 0
    v_mov_b32 v138, 0
    v_mov_b32 v139, 0
    s_mul_i32 s80, s3, 6144
    s_lshl_b32 s4, s76, 10
    s_add_u32 s4, s4, 0x40000
    s_waitcnt vmcnt(0)
    s_mov_b32 s70, 40000
    v_readfirstlane_b32 s64, v30
    s_nop 0
    s_cmp_lg_u32 s64, 0
    s_cbranch_scc1 L_poll5_done
L_poll5:
    buffer_load_dword v30, off, s[52:55], 0 offset:128 sc1
    s_waitcnt vmcnt(0)
    v_readfirstlane_b32 s64, v30
    s_nop 0
    s_cmp_lg_u32 s64, 0
    s_cbranch_scc1 L_poll5_done
    s_sleep 4
    s_sub_u32 s70, s70, 1
    s_cmp_lg_u32 s70, 0
    s_cbranch_scc1 L_poll5
L_poll5_done:
    s_sub_u32 s6, s2, 216
    s_cmp_lt_u32 s6, 40
    s_cbranch_scc0 L_a_nosig1
    s_cmp_lg_u32 s3, 0
    s_cbranch_scc1 L_a_nosig1
    s_lshl_b32 s6, s2, 7
    s_add_u32 s6, s6, 0x95400
    v_mov_b32 v2, s64
    s_mov_b64 exec, 1
    buffer_store_dword v2, off, s[48:51], s6 sc1
    s_mov_b64 exec, -1
L_a_nosig1:
    s_cmp_lg_u32 s3, 0
    s_cbranch_scc1 L_a_polled
    s_mov_b32 s70, 40000
    s_waitcnt vmcnt(0)
    v_cmp_eq_u32 vcc, s64, v8
    s_nop 0
    s_and_b64 s[68:69], vcc, s[66:67]
    s_cmp_eq_u64 s[68:69], s[66:67]
    s_cbranch_scc1 L_poll6_done
    s_mov_b64 exec, s[66:67]
    buffer_load_dword v8, v14, s[48:51], s98 offen sc1
L_poll6:
    s_sleep 2
    buffer_load_dword v9, v14, s[48:51], s98 offen sc1
    s_waitcnt vmcnt(1)
    v_cmp_eq_u32 vcc, s64, v8
    s_nop 0
    s_cmp_eq_u64 vcc, s[66:67]
    s_cbranch_scc1 L_poll6_hit
    s_sleep 2
    buffer_load_dword v8, v14, s[48:51], s98 offen sc1
    s_waitcnt vmcnt(1)
    v_cmp_eq_u32 vcc, s64, v9
    s_nop 0
    s_cmp_eq_u64 vcc, s[66:67]
    s_cbranch_scc1 L_poll6_hit
    s_sub_u32 s70, s70, 1
    s_cmp_lg_u32 s70, 0
    s_cbranch_scc1 L_poll6
L_poll6_hit:
    s_mov_b64 exec, -1
L_poll6_done:
L_a_polled:
    s_waitcnt lgkmcnt(0)
    s_barrier
    s_add_u32 s88, s38, s80
    s_addc_u32 s89, s39, 0
    s_mov_b32 s90, 20480
    s_mov_b32 s91, 0
    buffer_load_dwordx4 v[80:83], v4, s[48:51], s4 offen sc1
    buffer_load_dwordx4 v[84:87], v4, s[48:51], s4 offen offset:512 sc1
    buffer_load_dwordx4 v[112:115], v10, s[72:75], 0 offen sc1
    buffer_load_dwordx4 v[140:143], v10, s[72:75], 0 offen offset:2048 sc1
    buffer_load_dwordx4 v[116:119], v10, s[72:75], 0 offen offset:1024 sc1
    s_add_u32 m0, s80, 0
    s_nop 0
    global_load_lds_dwordx4 v10, s[88:89] offset:0 sc1
    s_add_u32 m0, s80, 0
    s_nop 0
    global_load_lds_dwordx4 v10, s[88:89] offset:1024 sc1
    s_add_u32 m0, s80, 0
    s_nop 0
    global_load_lds_dwordx4 v10, s[88:89] offset:2048 sc1
    s_add_u32 m0, s80, 0
    s_nop 0
    global_load_lds_dwordx4 v10, s[88:89] offset:3072 sc1
    s_add_u32 s88, s88, 4096
    s_addc_u32 s89, s89, 0
    s_add_u32 m0, s80, 4096
    s_nop 0
    global_load_lds_dwordx4 v10, s[88:89] offset:0 sc1
    s_add_u32 m0, s80, 4096
    s_nop 0
    global_load_lds_dwordx4 v10, s[88:89] offset:1024 sc1
    s_add_u32 s88, s88, s90
    s_addc_u32 s89, s89, s91
    s_add_u32 m0, s80, 24576
    s_nop 0
    global_load_lds_dwordx4 v10, s[88:89] offset:0 sc1
    s_lshr_b32 s5, s2, 3
    s_lshl_b32 s5, s5, 2
    s_add_u32 s5, s5, s3
    s_mul_i32 s5, s5, 1536
    s_mov_b64 exec, 0xfff
    buffer_load_dword v31, v14, s[72:75], s5 offen sc1
    s_mov_b64 exec, -1
    s_mov_b32 s4, 0x3ea52b5c
    s_waitcnt vmcnt(11)
    v_rsq_f32 v81, v82
    v_fma_f32 v32, v80, v64, v32
    v_fma_f32 v33, v80, v65, v33
    v_fma_f32 v34, v80, v66, v34
    v_fma_f32 v35, v80, v67, v35
    v_fma_f32 v36, v80, v68, v36
    v_fma_f32 v37, v80, v69, v37
    v_fma_f32 v38, v80, v70, v38
    v_fma_f32 v39, v80, v71, v39
    v_fma_f32 v40, v80, v72, v40
    v_fma_f32 v41, v80, v73, v41
    v_fma_f32 v42, v80, v74, v42
    v_fma_f32 v43, v80, v75, v43
    v_mul_f32 v81, s4, v81
    v_mul_f32 v32, v81, v32
    v_mul_f32 v33, v81, v33
    v_mul_f32 v34, v81, v34
    v_mul_f32 v35, v81, v35
    v_mul_f32 v36, v81, v36
    v_mul_f32 v37, v81, v37
    v_mul_f32 v38, v81, v38
    v_mul_f32 v39, v81, v39
    v_mul_f32 v40, v81, v40
    v_mul_f32 v41, v81, v41
    v_mul_f32 v42, v81, v42
    v_mul_f32 v43, v81, v43
    v_cvt_pk_bf16_f32 v160, v32, v33
    v_cvt_pk_bf16_f32 v161, v34, v35
    v_cvt_pk_bf16_f32 v162, v36, v37
    v_cvt_pk_bf16_f32 v163, v38, v39
    v_cvt_pk_bf16_f32 v164, v40, v41
    v_cvt_pk_bf16_f32 v165, v42, v43
    v_cndmask_b32 v164, 0, v164, s[84:85]
    v_cndmask_b32 v165, 0, v165, s[84:85]
    v_rsq_f32 v85, v86
    v_fma_f32 v48, v84, v64, v48
    v_fma_f32 v49, v84, v65, v49
    v_fma_f32 v50, v84, v66, v50
    v_fma_f32 v51, v84, v67, v51
    v_fma_f32 v52, v84, v68, v52
    v_fma_f32 v53, v84, v69, v53
    v_fma_f32 v54, v84, v70, v54
    v_fma_f32 v55, v84, v71, v55
    v_fma_f32 v56, v84, v72, v56
    v_fma_f32 v57, v84, v73, v57
    v_fma_f32 v58, v84, v74, v58
    v_fma_f32 v59, v84, v75, v59
    v_mul_f32 v85, s4, v85
    v_mul_f32 v48, v85, v48
    v_mul_f32 v49, v85, v49
    v_mul_f32 v50, v85, v50
    v_mul_f32 v51, v85, v51
    v_mul_f32 v52, v85, v52
    v_mul_f32 v53, v85, v53
    v_mul_f32 v54, v85, v54
    v_mul_f32 v55, v85, v55
    v_mul_f32 v56, v85, v56
    v_mul_f32 v57, v85, v57
    v_mul_f32 v58, v85, v58
    v_mul_f32 v59, v85, v59
    v_cvt_pk_bf16_f32 v166, v48, v49
    v_cvt_pk_bf16_f32 v167, v50, v51
    v_cvt_pk_bf16_f32 v168, v52, v53
    v_cvt_pk_bf16_f32 v169, v54, v55
    v_cvt_pk_bf16_f32 v170, v56, v57
    v_cvt_pk_bf16_f32 v171, v58, v59
    v_cndmask_b32 v170, 0, v170, s[84:85]
    v_cndmask_b32 v171, 0, v171, s[84:85]
    s_mov_b32 s83, 0
    s_waitcnt vmcnt(8)
    v_mfma_f32_32x32x16_bf16 v[64:79], v[112:115], v[160:163], 0
    v_mfma_f32_32x32x8_bf16 v[64:79], v[140:141], v[164:165], v[64:79]
    v_mfma_f32_32x32x16_bf16 v[32:47], v[116:119], v[160:163], 0
    v_mfma_f32_32x32x8_bf16 v[32:47], v[142:143], v[164:165], v[32:47]
    v_mfma_f32_32x32x16_bf16 v[80:95], v[112:115], v[166:169], 0
    v_mfma_f32_32x32x8_bf16 v[80:95], v[140:141], v[170:171], v[80:95]
    v_mfma_f32_32x32x16_bf16 v[48:63], v[116:119], v[166:169], 0
    v_mfma_f32_32x32x8_bf16 v[48:63], v[142:143], v[170:171], v[48:63]
    s_mov_b32 s4, 0xffff0000
    s_nop 4
    v_max3_f32 v12, v64, v65, v66
    v_max_f32 v12, v12, v67
    v_max3_f32 v12, v12, v68, v69
    v_max3_f32 v12, v12, v70, v71
    v_max3_f32 v12, v12, v72, v73
    v_max3_f32 v12, v12, v74, v75
    v_max3_f32 v12, v12, v76, v77
    v_max3_f32 v12, v12, v78, v79
    v_max3_f32 v12, v12, v32, v33
    v_max3_f32 v12, v12, v34, v35
    v_max3_f32 v12, v12, v36, v37
    v_max3_f32 v12, v12, v38, v39
    v_max3_f32 v12, v12, v40, v41
    v_max3_f32 v12, v12, v42, v43
    v_max3_f32 v12, v12, v44, v45
    v_max3_f32 v12, v12, v46, v47
    v_mov_b32 v2, v12
    s_nop 1
    v_permlane32_swap_b32 v12, v2
    v_max_f32 v12, v12, v2
    v_sub_f32 v2, 0xc2c00000, v12
    v_and_b32 v3, s4, v2
    v_sub_f32 v2, v2, v3
    v_and_b32 v4, s4, v2
    v_sub_f32 v2, v2, v4
    v_lshrrev_b32 v3, 16, v3
    v_or_b32 v3, v3, v4
    v_lshrrev_b32 v2, 16, v2
    v_cndmask_b32 v164, v3, v164, s[84:85]
    v_cndmask_b32 v165, v2, v165, s[84:85]
    v_mfma_f32_32x32x16_bf16 v[64:79], v[112:115], v[160:163], 0
    s_nop 0
    v_mfma_f32_32x32x8_bf16 v[64:79], v[140:141], v[164:165], v[64:79]
    v_max3_f32 v13, v80, v81, v82
    v_max_f32 v13, v13, v83
    v_max3_f32 v13, v13, v84, v85
    v_max3_f32 v13, v13, v86, v87
    v_max3_f32 v13, v13, v88, v89
    v_max3_f32 v13, v13, v90, v91
    v_max3_f32 v13, v13, v92, v93
    v_max3_f32 v13, v13, v94, v95
    v_max3_f32 v13, v13, v48, v49
    v_max3_f32 v13, v13, v50, v51
    v_max3_f32 v13, v13, v52, v53
    v_max3_f32 v13, v13, v54, v55
    v_max3_f32 v13, v13, v56, v57
    v_max3_f32 v13, v13, v58, v59
    v_max3_f32 v13, v13, v60, v61
    v_max3_f32 v13, v13, v62, v63
    v_mov_b32 v2, v13
    s_nop 1
    v_permlane32_swap_b32 v13, v2
    v_max_f32 v13, v13, v2
    v_sub_f32 v2, 0xc2c00000, v13
    v_and_b32 v3, s4, v2
    v_sub_f32 v2, v2, v3
    v_and_b32 v4, s4, v2
    v_sub_f32 v2, v2, v4
    v_lshrrev_b32 v3, 16, v3
    v_or_b32 v3, v3, v4
    v_lshrrev_b32 v2, 16, v2
    v_cndmask_b32 v170, v3, v170, s[84:85]
    v_cndmask_b32 v171, v2, v171, s[84:85]
    s_waitcnt vmcnt(2)
    s_barrier
    ds_read_b128 v[124:127], v11 offset:3072
    ds_read_b128 v[128:131], v11 offset:3840
    s_mov_b32 s86, 4
.p2align 6
L_a_loop:
    v_exp_f32 v64, v64
    v_exp_f32 v65, v65
    v_exp_f32 v66, v66
    v_mfma_f32_32x32x16_bf16 v[80:95], v[112:115], v[166:169], 0
    ds_read_b128 v[116:119], v10 offset:1024
    v_exp_f32 v67, v67
    v_cvt_pk_bf16_f32 v96, v64, v65
    v_exp_f32 v68, v68
    v_mfma_f32_32x32x8_bf16 v[80:95], v[140:141], v[170:171], v[80:95]
    v_exp_f32 v69, v69
    v_cvt_pk_bf16_f32 v97, v66, v67
    v_exp_f32 v70, v70
    v_exp_f32 v71, v71
    v_cvt_pk_bf16_f32 v98, v68, v69
    v_exp_f32 v72, v72
    v_exp_f32 v73, v73
    v_cvt_pk_bf16_f32 v99, v70, v71
    v_exp_f32 v74, v74
    v_mfma_f32_32x32x16_bf16 v[192:207], v[132:135], v[104:107], v[192:207]
    v_exp_f32 v75, v75
    v_cvt_pk_bf16_f32 v100, v72, v73
    v_exp_f32 v76, v76
    v_exp_f32 v77, v77
    v_cvt_pk_bf16_f32 v101, v74, v75
    v_exp_f32 v78, v78
    v_exp_f32 v79, v79
    v_cvt_pk_bf16_f32 v102, v76, v77
    v_mfma_f32_32x32x16_bf16 v[192:207], v[136:139], v[108:111], v[192:207]
    s_waitcnt lgkmcnt(0)
    v_cvt_pk_bf16_f32 v103, v78, v79
    v_exp_f32 v80, v80
    v_exp_f32 v81, v81
    v_exp_f32 v82, v82
    v_mfma_f32_32x32x16_bf16 v[64:79], v[116:119], v[160:163], 0
    ds_read_b128 v[132:135], v11 offset:4608
    ds_read_b128 v[136:139], v11 offset:5376
    s_add_u32 m0, s80, 24576
    v_exp_f32 v83, v83
    v_cvt_pk_bf16_f32 v104, v80, v81
    v_exp_f32 v84, v84
    v_mfma_f32_32x32x8_bf16 v[64:79], v[142:143], v[164:165], v[64:79]
    v_exp_f32 v85, v85
    v_cvt_pk_bf16_f32 v105, v82, v83
    v_exp_f32 v86, v86
    v_exp_f32 v87, v87
    v_cvt_pk_bf16_f32 v106, v84, v85
    v_exp_f32 v88, v88
    v_exp_f32 v89, v89
    v_cvt_pk_bf16_f32 v107, v86, v87
    v_exp_f32 v90, v90
    v_mfma_f32_32x32x16_bf16 v[176:191], v[124:127], v[96:99], v[176:191]
    global_load_lds_dwordx4 v10, s[88:89] offset:1024 sc1
    v_exp_f32 v91, v91
    v_cvt_pk_bf16_f32 v108, v88, v89
    v_exp_f32 v92, v92
    v_exp_f32 v93, v93
    v_cvt_pk_bf16_f32 v109, v90, v91
    v_exp_f32 v94, v94
    v_exp_f32 v95, v95
    v_cvt_pk_bf16_f32 v110, v92, v93
    v_mfma_f32_32x32x16_bf16 v[176:191], v[128:131], v[100:103], v[176:191]
    v_cvt_pk_bf16_f32 v111, v94, v95
    v_exp_f32 v64, v64
    v_exp_f32 v65, v65
    v_exp_f32 v66, v66
    v_mfma_f32_32x32x16_bf16 v[80:95], v[116:119], v[166:169], 0
    ds_read_b128 v[112:115], v10 offset:6144
    ds_read_b128 v[144:147], v10 offset:8192
    s_cmp_eq_u32 s86, 1
    v_exp_f32 v67, v67
    v_cvt_pk_bf16_f32 v96, v64, v65
    v_exp_f32 v68, v68
    v_mfma_f32_32x32x8_bf16 v[80:95], v[142:143], v[170:171], v[80:95]
    v_exp_f32 v69, v69
    v_cvt_pk_bf16_f32 v97, v66, v67
    v_exp_f32 v70, v70
    v_exp_f32 v71, v71
    v_cvt_pk_bf16_f32 v98, v68, v69
    v_exp_f32 v72, v72
    v_exp_f32 v73, v73
    v_cvt_pk_bf16_f32 v99, v70, v71
    v_exp_f32 v74, v74
    v_mfma_f32_32x32x16_bf16 v[192:207], v[124:127], v[104:107], v[192:207]
    s_cselect_b32 s91, -1, 0
    v_exp_f32 v75, v75
    v_cvt_pk_bf16_f32 v100, v72, v73
    v_exp_f32 v76, v76
    v_exp_f32 v77, v77
    v_cvt_pk_bf16_f32 v101, v74, v75
    v_exp_f32 v78, v78
    v_exp_f32 v79, v79
    v_cvt_pk_bf16_f32 v102, v76, v77
    v_mfma_f32_32x32x16_bf16 v[192:207], v[128:131], v[108:111], v[192:207]
    s_waitcnt lgkmcnt(0)
    v_cvt_pk_bf16_f32 v103, v78, v79
    v_exp_f32 v80, v80
    v_exp_f32 v81, v81
    v_exp_f32 v82, v82
    v_mfma_f32_32x32x16_bf16 v[64:79], v[112:115], v[160:163], 0
    ds_read_b128 v[124:127], v11 offset:9216
    ds_read_b128 v[128:131], v11 offset:9984
    s_add_u32 m0, s80, 24576
    v_exp_f32 v83, v83
    v_cvt_pk_bf16_f32 v104, v80, v81
    v_exp_f32 v84, v84
    v_mfma_f32_32x32x8_bf16 v[64:79], v[144:145], v[164:165], v[64:79]
    v_exp_f32 v85, v85
    v_cvt_pk_bf16_f32 v105, v82, v83
    v_exp_f32 v86, v86
    v_exp_f32 v87, v87
    v_cvt_pk_bf16_f32 v106, v84, v85
    v_exp_f32 v88, v88
    v_exp_f32 v89, v89
    v_cvt_pk_bf16_f32 v107, v86, v87
    v_exp_f32 v90, v90
    v_mfma_f32_32x32x16_bf16 v[176:191], v[132:135], v[96:99], v[176:191]
    global_load_lds_dwordx4 v10, s[88:89] offset:2048 sc1
    v_exp_f32 v91, v91
    v_cvt_pk_bf16_f32 v108, v88, v89
    v_exp_f32 v92, v92
    v_exp_f32 v93, v93
    v_cvt_pk_bf16_f32 v109, v90, v91
    v_exp_f32 v94, v94
    v_exp_f32 v95, v95
    v_cvt_pk_bf16_f32 v110, v92, v93
    v_mfma_f32_32x32x16_bf16 v[176:191], v[136:139], v[100:103], v[176:191]
    v_cvt_pk_bf16_f32 v111, v94, v95
    v_exp_f32 v64, v64
    v_exp_f32 v65, v65
    v_exp_f32 v66, v66
    v_mfma_f32_32x32x16_bf16 v[80:95], v[112:115], v[166:169], 0
    ds_read_b128 v[116:119], v10 offset:7168
    s_cmp_eq_u32 s86, 1
    v_exp_f32 v67, v67
    v_cvt_pk_bf16_f32 v96, v64, v65
    v_exp_f32 v68, v68
    v_mfma_f32_32x32x8_bf16 v[80:95], v[144:145], v[170:171], v[80:95]
    v_exp_f32 v69, v69
    v_cvt_pk_bf16_f32 v97, v66, v67
    v_exp_f32 v70, v70
    v_exp_f32 v71, v71
    v_cvt_pk_bf16_f32 v98, v68, v69
    v_exp_f32 v72, v72
    v_exp_f32 v73, v73
    v_cvt_pk_bf16_f32 v99, v70, v71
    v_exp_f32 v74, v74
    v_mfma_f32_32x32x16_bf16 v[192:207], v[132:135], v[104:107], v[192:207]
    s_cselect_b32 s90, -4096, s90
    v_exp_f32 v75, v75
    v_cvt_pk_bf16_f32 v100, v72, v73
    v_exp_f32 v76, v76
    v_exp_f32 v77, v77
    v_cvt_pk_bf16_f32 v101, v74, v75
    v_exp_f32 v78, v78
    v_exp_f32 v79, v79
    v_cvt_pk_bf16_f32 v102, v76, v77
    v_mfma_f32_32x32x16_bf16 v[192:207], v[136:139], v[108:111], v[192:207]
    s_waitcnt lgkmcnt(0)
    v_cvt_pk_bf16_f32 v103, v78, v79
    v_exp_f32 v80, v80
    v_exp_f32 v81, v81
    v_exp_f32 v82, v82
    v_mfma_f32_32x32x16_bf16 v[64:79], v[116:119], v[160:163], 0
    ds_read_b128 v[132:135], v11 offset:10752
    ds_read_b128 v[136:139], v11 offset:11520
    s_add_u32 m0, s80, 24576
    v_exp_f32 v83, v83
    v_cvt_pk_bf16_f32 v104, v80, v81
    v_exp_f32 v84, v84
    v_mfma_f32_32x32x8_bf16 v[64:79], v[146:147], v[164:165], v[64:79]
    v_exp_f32 v85, v85
    v_cvt_pk_bf16_f32 v105, v82, v83
    v_exp_f32 v86, v86
    v_exp_f32 v87, v87
    v_cvt_pk_bf16_f32 v106, v84, v85
    v_exp_f32 v88, v88
    v_exp_f32 v89, v89
    v_cvt_pk_bf16_f32 v107, v86, v87
    v_exp_f32 v90, v90
    v_mfma_f32_32x32x16_bf16 v[176:191], v[124:127], v[96:99], v[176:191]
    global_load_lds_dwordx4 v10, s[88:89] offset:3072 sc1
    v_exp_f32 v91, v91
    v_cvt_pk_bf16_f32 v108, v88, v89
    v_exp_f32 v92, v92
    v_exp_f32 v93, v93
    v_cvt_pk_bf16_f32 v109, v90, v91
    v_exp_f32 v94, v94
    v_exp_f32 v95, v95
    v_cvt_pk_bf16_f32 v110, v92, v93
    v_mfma_f32_32x32x16_bf16 v[176:191], v[128:131], v[100:103], v[176:191]
    v_cvt_pk_bf16_f32 v111, v94, v95
    v_exp_f32 v64, v64
    v_exp_f32 v65, v65
    v_exp_f32 v66, v66
    v_mfma_f32_32x32x16_bf16 v[80:95], v[116:119], v[166:169], 0
    ds_read_b128 v[112:115], v10 offset:12288
    ds_read_b128 v[140:143], v10 offset:14336
    s_add_u32 s88, s88, 4096
    v_exp_f32 v67, v67
    v_cvt_pk_bf16_f32 v96, v64, v65
    v_exp_f32 v68, v68
    v_mfma_f32_32x32x8_bf16 v[80:95], v[146:147], v[170:171], v[80:95]
    v_exp_f32 v69, v69
    v_cvt_pk_bf16_f32 v97, v66, v67
    v_exp_f32 v70, v70
    v_exp_f32 v71, v71
    v_cvt_pk_bf16_f32 v98, v68, v69
    v_exp_f32 v72, v72
    v_exp_f32 v73, v73
    v_cvt_pk_bf16_f32 v99, v70, v71
    v_exp_f32 v74, v74
    v_mfma_f32_32x32x16_bf16 v[192:207], v[124:127], v[104:107], v[192:207]
    s_addc_u32 s89, s89, 0
    v_exp_f32 v75, v75
    v_cvt_pk_bf16_f32 v100, v72, v73
    v_exp_f32 v76, v76
    v_exp_f32 v77, v77
    v_cvt_pk_bf16_f32 v101, v74, v75
    v_exp_f32 v78, v78
    v_exp_f32 v79, v79
    v_cvt_pk_bf16_f32 v102, v76, v77
    v_mfma_f32_32x32x16_bf16 v[192:207], v[128:131], v[108:111], v[192:207]
    s_waitcnt lgkmcnt(0)
    v_cvt_pk_bf16_f32 v103, v78, v79
    v_exp_f32 v80, v80
    v_exp_f32 v81, v81
    v_exp_f32 v82, v82
    v_mfma_f32_32x32x16_bf16 v[64:79], v[112:115], v[160:163], 0
    ds_read_b128 v[124:127], v11 offset:15360
    ds_read_b128 v[128:131], v11 offset:16128
    s_add_u32 m0, s80, 28672
    v_exp_f32 v83, v83
    v_cvt_pk_bf16_f32 v104, v80, v81
    v_exp_f32 v84, v84
    v_mfma_f32_32x32x8_bf16 v[64:79], v[140:141], v[164:165], v[64:79]
    v_exp_f32 v85, v85
    v_cvt_pk_bf16_f32 v105, v82, v83
    v_exp_f32 v86, v86
    v_exp_f32 v87, v87
    v_cvt_pk_bf16_f32 v106, v84, v85
    v_exp_f32 v88, v88
    v_exp_f32 v89, v89
    v_cvt_pk_bf16_f32 v107, v86, v87
    v_exp_f32 v90, v90
    v_mfma_f32_32x32x16_bf16 v[176:191], v[132:135], v[96:99], v[176:191]
    global_load_lds_dwordx4 v10, s[88:89] offset:0 sc1
    v_exp_f32 v91, v91
    v_cvt_pk_bf16_f32 v108, v88, v89
    v_exp_f32 v92, v92
    v_exp_f32 v93, v93
    v_cvt_pk_bf16_f32 v109, v90, v91
    v_exp_f32 v94, v94
    v_exp_f32 v95, v95
    v_cvt_pk_bf16_f32 v110, v92, v93
    v_mfma_f32_32x32x16_bf16 v[176:191], v[136:139], v[100:103], v[176:191]
    v_cvt_pk_bf16_f32 v111, v94, v95
    v_exp_f32 v64, v64
    v_exp_f32 v65, v65
    v_exp_f32 v66, v66
    v_mfma_f32_32x32x16_bf16 v[80:95], v[112:115], v[166:169], 0
    ds_read_b128 v[116:119], v10 offset:13312
    v_exp_f32 v67, v67
    v_cvt_pk_bf16_f32 v96, v64, v65
    v_exp_f32 v68, v68
    v_mfma_f32_32x32x8_bf16 v[80:95], v[140:141], v[170:171], v[80:95]
    v_exp_f32 v69, v69
    v_cvt_pk_bf16_f32 v97, v66, v67
    v_exp_f32 v70, v70
    v_exp_f32 v71, v71
    v_cvt_pk_bf16_f32 v98, v68, v69
    v_exp_f32 v72, v72
    v_exp_f32 v73, v73
    v_cvt_pk_bf16_f32 v99, v70, v71
    v_exp_f32 v74, v74
    v_mfma_f32_32x32x16_bf16 v[192:207], v[132:135], v[104:107], v[192:207]
    v_exp_f32 v75, v75
    v_cvt_pk_bf16_f32 v100, v72, v73
    v_exp_f32 v76, v76
    v_exp_f32 v77, v77
    v_cvt_pk_bf16_f32 v101, v74, v75
    v_exp_f32 v78, v78
    v_exp_f32 v79, v79
    v_cvt_pk_bf16_f32 v102, v76, v77
    v_mfma_f32_32x32x16_bf16 v[192:207], v[136:139], v[108:111], v[192:207]
    s_waitcnt lgkmcnt(0)
    v_cvt_pk_bf16_f32 v103, v78, v79
    v_exp_f32 v80, v80
    v_exp_f32 v81, v81
    v_exp_f32 v82, v82
    v_mfma_f32_32x32x16_bf16 v[64:79], v[116:119], v[160:163], 0
    ds_read_b128 v[132:135], v11 offset:16896
    ds_read_b128 v[136:139], v11 offset:17664
    s_add_u32 m0, s80, 28672
    v_exp_f32 v83, v83
    v_cvt_pk_bf16_f32 v104, v80, v81
    v_exp_f32 v84, v84
    v_mfma_f32_32x32x8_bf16 v[64:79], v[142:143], v[164:165], v[64:79]
    v_exp_f32 v85, v85
    v_cvt_pk_bf16_f32 v105, v82, v83
    v_exp_f32 v86, v86
    v_exp_f32 v87, v87
    v_cvt_pk_bf16_f32 v106, v84, v85
    v_exp_f32 v88, v88
    v_exp_f32 v89, v89
    v_cvt_pk_bf16_f32 v107, v86, v87
    v_exp_f32 v90, v90
    v_mfma_f32_32x32x16_bf16 v[176:191], v[124:127], v[96:99], v[176:191]
    global_load_lds_dwordx4 v10, s[88:89] offset:1024 sc1
    v_exp_f32 v91, v91
    v_cvt_pk_bf16_f32 v108, v88, v89
    v_exp_f32 v92, v92
    v_exp_f32 v93, v93
    v_cvt_pk_bf16_f32 v109, v90, v91
    v_exp_f32 v94, v94
    v_exp_f32 v95, v95
    v_cvt_pk_bf16_f32 v110, v92, v93
    v_mfma_f32_32x32x16_bf16 v[176:191], v[128:131], v[100:103], v[176:191]
    v_cvt_pk_bf16_f32 v111, v94, v95
    v_exp_f32 v64, v64
    v_exp_f32 v65, v65
    v_exp_f32 v66, v66
    v_mfma_f32_32x32x16_bf16 v[80:95], v[116:119], v[166:169], 0
    ds_read_b128 v[112:115], v10 offset:18432
    ds_read_b128 v[144:147], v10 offset:20480
    s_add_u32 s88, s88, s90
    v_exp_f32 v67, v67
    v_cvt_pk_bf16_f32 v96, v64, v65
    v_exp_f32 v68, v68
    v_mfma_f32_32x32x8_bf16 v[80:95], v[142:143], v[170:171], v[80:95]
    v_exp_f32 v69, v69
    v_cvt_pk_bf16_f32 v97, v66, v67
    v_exp_f32 v70, v70
    v_exp_f32 v71, v71
    v_cvt_pk_bf16_f32 v98, v68, v69
    v_exp_f32 v72, v72
    v_exp_f32 v73, v73
    v_cvt_pk_bf16_f32 v99, v70, v71
    v_exp_f32 v74, v74
    v_mfma_f32_32x32x16_bf16 v[192:207], v[124:127], v[104:107], v[192:207]
    s_addc_u32 s89, s89, s91
    v_exp_f32 v75, v75
    v_cvt_pk_bf16_f32 v100, v72, v73
    v_exp_f32 v76, v76
    v_exp_f32 v77, v77
    v_cvt_pk_bf16_f32 v101, v74, v75
    v_exp_f32 v78, v78
    v_exp_f32 v79, v79
    v_cvt_pk_bf16_f32 v102, v76, v77
    v_mfma_f32_32x32x16_bf16 v[192:207], v[128:131], v[108:111], v[192:207]
    s_waitcnt lgkmcnt(0)
    v_cvt_pk_bf16_f32 v103, v78, v79
    v_exp_f32 v80, v80
    v_exp_f32 v81, v81
    v_exp_f32 v82, v82
    v_mfma_f32_32x32x16_bf16 v[64:79], v[112:115], v[160:163], 0
    ds_read_b128 v[124:127], v11 offset:21504
    ds_read_b128 v[128:131], v11 offset:22272
    v_exp_f32 v83, v83
    v_cvt_pk_bf16_f32 v104, v80, v81
    v_exp_f32 v84, v84
    v_mfma_f32_32x32x8_bf16 v[64:79], v[144:145], v[164:165], v[64:79]
    v_exp_f32 v85, v85
    v_cvt_pk_bf16_f32 v105, v82, v83
    v_exp_f32 v86, v86
    v_exp_f32 v87, v87
    v_cvt_pk_bf16_f32 v106, v84, v85
    v_exp_f32 v88, v88
    v_exp_f32 v89, v89
    v_cvt_pk_bf16_f32 v107, v86, v87
    v_exp_f32 v90, v90
    v_mfma_f32_32x32x16_bf16 v[176:191], v[132:135], v[96:99], v[176:191]
    v_exp_f32 v91, v91
    v_cvt_pk_bf16_f32 v108, v88, v89
    v_exp_f32 v92, v92
    v_exp_f32 v93, v93
    v_cvt_pk_bf16_f32 v109, v90, v91
    v_exp_f32 v94, v94
    v_exp_f32 v95, v95
    v_cvt_pk_bf16_f32 v110, v92, v93
    v_mfma_f32_32x32x16_bf16 v[176:191], v[136:139], v[100:103], v[176:191]
    v_cvt_pk_bf16_f32 v111, v94, v95
    v_exp_f32 v64, v64
    v_exp_f32 v65, v65
    v_exp_f32 v66, v66
    v_mfma_f32_32x32x16_bf16 v[80:95], v[112:115], v[166:169], 0
    ds_read_b128 v[116:119], v10 offset:19456
    v_exp_f32 v67, v67
    v_cvt_pk_bf16_f32 v96, v64, v65
    v_exp_f32 v68, v68
    v_mfma_f32_32x32x8_bf16 v[80:95], v[144:145], v[170:171], v[80:95]
    v_exp_f32 v69, v69
    v_cvt_pk_bf16_f32 v97, v66, v67
    v_exp_f32 v70, v70
    v_exp_f32 v71, v71
    v_cvt_pk_bf16_f32 v98, v68, v69
    v_exp_f32 v72, v72
    v_exp_f32 v73, v73
    v_cvt_pk_bf16_f32 v99, v70, v71
    v_exp_f32 v74, v74
    v_mfma_f32_32x32x16_bf16 v[192:207], v[132:135], v[104:107], v[192:207]
    v_exp_f32 v75, v75
    v_cvt_pk_bf16_f32 v100, v72, v73
    v_exp_f32 v76, v76
    v_exp_f32 v77, v77
    v_cvt_pk_bf16_f32 v101, v74, v75
    v_exp_f32 v78, v78
    v_exp_f32 v79, v79
    v_cvt_pk_bf16_f32 v102, v76, v77
    v_mfma_f32_32x32x16_bf16 v[192:207], v[136:139], v[108:111], v[192:207]
    s_waitcnt lgkmcnt(0)
    v_cvt_pk_bf16_f32 v103, v78, v79
    v_exp_f32 v80, v80
    v_exp_f32 v81, v81
    v_exp_f32 v82, v82
    v_mfma_f32_32x32x16_bf16 v[64:79], v[116:119], v[160:163], 0
    ds_read_b128 v[132:135], v11 offset:23040
    ds_read_b128 v[136:139], v11 offset:23808
    v_exp_f32 v83, v83
    v_cvt_pk_bf16_f32 v104, v80, v81
    v_exp_f32 v84, v84
    v_mfma_f32_32x32x8_bf16 v[64:79], v[146:147], v[164:165], v[64:79]
    v_exp_f32 v85, v85
    v_cvt_pk_bf16_f32 v105, v82, v83
    v_exp_f32 v86, v86
    v_exp_f32 v87, v87
    v_cvt_pk_bf16_f32 v106, v84, v85
    v_exp_f32 v88, v88
    v_exp_f32 v89, v89
    v_cvt_pk_bf16_f32 v107, v86, v87
    v_exp_f32 v90, v90
    v_mfma_f32_32x32x16_bf16 v[176:191], v[124:127], v[96:99], v[176:191]
    v_exp_f32 v91, v91
    v_cvt_pk_bf16_f32 v108, v88, v89
    v_exp_f32 v92, v92
    v_exp_f32 v93, v93
    v_cvt_pk_bf16_f32 v109, v90, v91
    v_exp_f32 v94, v94
    v_exp_f32 v95, v95
    v_cvt_pk_bf16_f32 v110, v92, v93
    v_mfma_f32_32x32x16_bf16 v[176:191], v[128:131], v[100:103], v[176:191]
    v_cvt_pk_bf16_f32 v111, v94, v95
    s_waitcnt vmcnt(0) lgkmcnt(0)
    s_barrier
    v_exp_f32 v64, v64
    v_exp_f32 v65, v65
    v_exp_f32 v66, v66
    v_mfma_f32_32x32x16_bf16 v[80:95], v[116:119], v[166:169], 0
    ds_read_b128 v[112:115], v10 offset:24576
    ds_read_b128 v[140:143], v10 offset:26624
    v_exp_f32 v67, v67
    v_cvt_pk_bf16_f32 v96, v64, v65
    v_exp_f32 v68, v68
    v_mfma_f32_32x32x8_bf16 v[80:95], v[146:147], v[170:171], v[80:95]
    v_exp_f32 v69, v69
    v_cvt_pk_bf16_f32 v97, v66, v67
    v_exp_f32 v70, v70
    v_exp_f32 v71, v71
    v_cvt_pk_bf16_f32 v98, v68, v69
    v_exp_f32 v72, v72
    v_exp_f32 v73, v73
    v_cvt_pk_bf16_f32 v99, v70, v71
    v_exp_f32 v74, v74
    v_mfma_f32_32x32x16_bf16 v[192:207], v[124:127], v[104:107], v[192:207]
    v_exp_f32 v75, v75
    v_cvt_pk_bf16_f32 v100, v72, v73
    v_exp_f32 v76, v76
    v_exp_f32 v77, v77
    v_cvt_pk_bf16_f32 v101, v74, v75
    v_exp_f32 v78, v78
    v_exp_f32 v79, v79
    v_cvt_pk_bf16_f32 v102, v76, v77
    v_mfma_f32_32x32x16_bf16 v[192:207], v[128:131], v[108:111], v[192:207]
    s_waitcnt lgkmcnt(0)
    v_cvt_pk_bf16_f32 v103, v78, v79
    v_exp_f32 v80, v80
    v_exp_f32 v81, v81
    v_exp_f32 v82, v82
    v_mfma_f32_32x32x16_bf16 v[64:79], v[112:115], v[160:163], 0
    ds_read_b128 v[124:127], v11 offset:27648
    ds_read_b128 v[128:131], v11 offset:28416
    s_add_u32 m0, s80, 0
    v_exp_f32 v83, v83
    v_cvt_pk_bf16_f32 v104, v80, v81
    v_exp_f32 v84, v84
    v_mfma_f32_32x32x8_bf16 v[64:79], v[140:141], v[164:165], v[64:79]
    v_exp_f32 v85, v85
    v_cvt_pk_bf16_f32 v105, v82, v83
    v_exp_f32 v86, v86
    v_exp_f32 v87, v87
    v_cvt_pk_bf16_f32 v106, v84, v85
    v_exp_f32 v88, v88
    v_exp_f32 v89, v89
    v_cvt_pk_bf16_f32 v107, v86, v87
    v_exp_f32 v90, v90
    v_mfma_f32_32x32x16_bf16 v[176:191], v[132:135], v[96:99], v[176:191]
    global_load_lds_dwordx4 v10, s[88:89] offset:0 sc1
    v_exp_f32 v91, v91
    v_cvt_pk_bf16_f32 v108, v88, v89
    v_exp_f32 v92, v92
    v_exp_f32 v93, v93
    v_cvt_pk_bf16_f32 v109, v90, v91
    v_exp_f32 v94, v94
    v_exp_f32 v95, v95
    v_cvt_pk_bf16_f32 v110, v92, v93
    v_mfma_f32_32x32x16_bf16 v[176:191], v[136:139], v[100:103], v[176:191]
    v_cvt_pk_bf16_f32 v111, v94, v95
    v_exp_f32 v64, v64
    v_exp_f32 v65, v65
    v_exp_f32 v66, v66
    v_mfma_f32_32x32x16_bf16 v[80:95], v[112:115], v[166:169], 0
    ds_read_b128 v[116:119], v10 offset:25600
    v_exp_f32 v67, v67
    v_cvt_pk_bf16_f32 v96, v64, v65
    v_exp_f32 v68, v68
    v_mfma_f32_32x32x8_bf16 v[80:95], v[140:141], v[170:171], v[80:95]
    v_exp_f32 v69, v69
    v_cvt_pk_bf16_f32 v97, v66, v67
    v_exp_f32 v70, v70
    v_exp_f32 v71, v71
    v_cvt_pk_bf16_f32 v98, v68, v69
    v_exp_f32 v72, v72
    v_exp_f32 v73, v73
    v_cvt_pk_bf16_f32 v99, v70, v71
    v_exp_f32 v74, v74
    v_mfma_f32_32x32x16_bf16 v[192:207], v[132:135], v[104:107], v[192:207]
    v_exp_f32 v75, v75
    v_cvt_pk_bf16_f32 v100, v72, v73
    v_exp_f32 v76, v76
    v_exp_f32 v77, v77
    v_cvt_pk_bf16_f32 v101, v74, v75
    v_exp_f32 v78, v78
    v_exp_f32 v79, v79
    v_cvt_pk_bf16_f32 v102, v76, v77
    v_mfma_f32_32x32x16_bf16 v[192:207], v[136:139], v[108:111], v[192:207]
    s_waitcnt lgkmcnt(0)
    v_cvt_pk_bf16_f32 v103, v78, v79
    v_exp_f32 v80, v80
    v_exp_f32 v81, v81
    v_exp_f32 v82, v82
    v_mfma_f32_32x32x16_bf16 v[64:79], v[116:119], v[160:163], 0
    ds_read_b128 v[132:135], v11 offset:29184
    ds_read_b128 v[136:139], v11 offset:29952
    s_add_u32 m0, s80, 0
    v_exp_f32 v83, v83
    v_cvt_pk_bf16_f32 v104, v80, v81
    v_exp_f32 v84, v84
    v_mfma_f32_32x32x8_bf16 v[64:79], v[142:143], v[164:165], v[64:79]
    v_exp_f32 v85, v85
    v_cvt_pk_bf16_f32 v105, v82, v83
    v_exp_f32 v86, v86
    v_exp_f32 v87, v87
    v_cvt_pk_bf16_f32 v106, v84, v85
    v_exp_f32 v88, v88
    v_exp_f32 v89, v89
    v_cvt_pk_bf16_f32 v107, v86, v87
    v_exp_f32 v90, v90
    v_mfma_f32_32x32x16_bf16 v[176:191], v[124:127], v[96:99], v[176:191]
    global_load_lds_dwordx4 v10, s[88:89] offset:1024 sc1
    v_exp_f32 v91, v91
    v_cvt_pk_bf16_f32 v108, v88, v89
    v_exp_f32 v92, v92
    v_exp_f32 v93, v93
    v_cvt_pk_bf16_f32 v109, v90, v91
    v_exp_f32 v94, v94
    v_exp_f32 v95, v95
    v_cvt_pk_bf16_f32 v110, v92, v93
    v_mfma_f32_32x32x16_bf16 v[176:191], v[128:131], v[100:103], v[176:191]
    v_cvt_pk_bf16_f32 v111, v94, v95
    v_exp_f32 v64, v64
    v_exp_f32 v65, v65
    v_exp_f32 v66, v66
    v_mfma_f32_32x32x16_bf16 v[80:95], v[116:119], v[166:169], 0
    ds_read_b128 v[112:115], v10 offset:30720
    ds_read_b128 v[144:147], v10 offset:32768
    v_exp_f32 v67, v67
    v_cvt_pk_bf16_f32 v96, v64, v65
    v_exp_f32 v68, v68
    v_mfma_f32_32x32x8_bf16 v[80:95], v[142:143], v[170:171], v[80:95]
    v_exp_f32 v69, v69
    v_cvt_pk_bf16_f32 v97, v66, v67
    v_exp_f32 v70, v70
    v_exp_f32 v71, v71
    v_cvt_pk_bf16_f32 v98, v68, v69
    v_exp_f32 v72, v72
    v_exp_f32 v73, v73
    v_cvt_pk_bf16_f32 v99, v70, v71
    v_exp_f32 v74, v74
    v_mfma_f32_32x32x16_bf16 v[192:207], v[124:127], v[104:107], v[192:207]
    v_exp_f32 v75, v75
    v_cvt_pk_bf16_f32 v100, v72, v73
    v_exp_f32 v76, v76
    v_exp_f32 v77, v77
    v_cvt_pk_bf16_f32 v101, v74, v75
    v_exp_f32 v78, v78
    v_exp_f32 v79, v79
    v_cvt_pk_bf16_f32 v102, v76, v77
    v_mfma_f32_32x32x16_bf16 v[192:207], v[128:131], v[108:111], v[192:207]
    s_waitcnt lgkmcnt(0)
    v_cvt_pk_bf16_f32 v103, v78, v79
    v_exp_f32 v80, v80
    v_exp_f32 v81, v81
    v_exp_f32 v82, v82
    v_mfma_f32_32x32x16_bf16 v[64:79], v[112:115], v[160:163], 0
    ds_read_b128 v[124:127], v11 offset:33792
    ds_read_b128 v[128:131], v11 offset:34560
    s_add_u32 m0, s80, 0
    v_exp_f32 v83, v83
    v_cvt_pk_bf16_f32 v104, v80, v81
    v_exp_f32 v84, v84
    v_mfma_f32_32x32x8_bf16 v[64:79], v[144:145], v[164:165], v[64:79]
    v_exp_f32 v85, v85
    v_cvt_pk_bf16_f32 v105, v82, v83
    v_exp_f32 v86, v86
    v_exp_f32 v87, v87
    v_cvt_pk_bf16_f32 v106, v84, v85
    v_exp_f32 v88, v88
    v_exp_f32 v89, v89
    v_cvt_pk_bf16_f32 v107, v86, v87
    v_exp_f32 v90, v90
    v_mfma_f32_32x32x16_bf16 v[176:191], v[132:135], v[96:99], v[176:191]
    global_load_lds_dwordx4 v10, s[88:89] offset:2048 sc1
    v_exp_f32 v91, v91
    v_cvt_pk_bf16_f32 v108, v88, v89
    v_exp_f32 v92, v92
    v_exp_f32 v93, v93
    v_cvt_pk_bf16_f32 v109, v90, v91
    v_exp_f32 v94, v94
    v_exp_f32 v95, v95
    v_cvt_pk_bf16_f32 v110, v92, v93
    v_mfma_f32_32x32x16_bf16 v[176:191], v[136:139], v[100:103], v[176:191]
    v_cvt_pk_bf16_f32 v111, v94, v95
    v_exp_f32 v64, v64
    v_exp_f32 v65, v65
    v_exp_f32 v66, v66
    v_mfma_f32_32x32x16_bf16 v[80:95], v[112:115], v[166:169], 0
    ds_read_b128 v[116:119], v10 offset:31744
    v_exp_f32 v67, v67
    v_cvt_pk_bf16_f32 v96, v64, v65
    v_exp_f32 v68, v68
    v_mfma_f32_32x32x8_bf16 v[80:95], v[144:145], v[170:171], v[80:95]
    v_exp_f32 v69, v69
    v_cvt_pk_bf16_f32 v97, v66, v67
    v_exp_f32 v70, v70
    v_exp_f32 v71, v71
    v_cvt_pk_bf16_f32 v98, v68, v69
    v_exp_f32 v72, v72
    v_exp_f32 v73, v73
    v_cvt_pk_bf16_f32 v99, v70, v71
    v_exp_f32 v74, v74
    v_mfma_f32_32x32x16_bf16 v[192:207], v[132:135], v[104:107], v[192:207]
    v_exp_f32 v75, v75
    v_cvt_pk_bf16_f32 v100, v72, v73
    v_exp_f32 v76, v76
    v_exp_f32 v77, v77
    v_cvt_pk_bf16_f32 v101, v74, v75
    v_exp_f32 v78, v78
    v_exp_f32 v79, v79
    v_cvt_pk_bf16_f32 v102, v76, v77
    v_mfma_f32_32x32x16_bf16 v[192:207], v[136:139], v[108:111], v[192:207]
    s_waitcnt lgkmcnt(0)
    v_cvt_pk_bf16_f32 v103, v78, v79
    v_exp_f32 v80, v80
    v_exp_f32 v81, v81
    v_exp_f32 v82, v82
    v_mfma_f32_32x32x16_bf16 v[64:79], v[116:119], v[160:163], 0
    ds_read_b128 v[132:135], v11 offset:35328
    ds_read_b128 v[136:139], v11 offset:36096
    s_add_u32 m0, s80, 0
    v_exp_f32 v83, v83
    v_cvt_pk_bf16_f32 v104, v80, v81
    v_exp_f32 v84, v84
    v_mfma_f32_32x32x8_bf16 v[64:79], v[146:147], v[164:165], v[64:79]
    v_exp_f32 v85, v85
    v_cvt_pk_bf16_f32 v105, v82, v83
    v_exp_f32 v86, v86
    v_exp_f32 v87, v87
    v_cvt_pk_bf16_f32 v106, v84, v85
    v_exp_f32 v88, v88
    v_exp_f32 v89, v89
    v_cvt_pk_bf16_f32 v107, v86, v87
    v_exp_f32 v90, v90
    v_mfma_f32_32x32x16_bf16 v[176:191], v[124:127], v[96:99], v[176:191]
    global_load_lds_dwordx4 v10, s[88:89] offset:3072 sc1
    v_exp_f32 v91, v91
    v_cvt_pk_bf16_f32 v108, v88, v89
    v_exp_f32 v92, v92
    v_exp_f32 v93, v93
    v_cvt_pk_bf16_f32 v109, v90, v91
    v_exp_f32 v94, v94
    v_exp_f32 v95, v95
    v_cvt_pk_bf16_f32 v110, v92, v93
    v_mfma_f32_32x32x16_bf16 v[176:191], v[128:131], v[100:103], v[176:191]
    v_cvt_pk_bf16_f32 v111, v94, v95
    v_exp_f32 v64, v64
    v_exp_f32 v65, v65
    v_exp_f32 v66, v66
    v_mfma_f32_32x32x16_bf16 v[80:95], v[116:119], v[166:169], 0
    ds_read_b128 v[112:115], v10 offset:36864
    ds_read_b128 v[140:143], v10 offset:38912
    s_add_u32 s88, s88, 4096
    v_exp_f32 v67, v67
    v_cvt_pk_bf16_f32 v96, v64, v65
    v_exp_f32 v68, v68
    v_mfma_f32_32x32x8_bf16 v[80:95], v[146:147], v[170:171], v[80:95]
    v_exp_f32 v69, v69
    v_cvt_pk_bf16_f32 v97, v66, v67
    v_exp_f32 v70, v70
    v_exp_f32 v71, v71
    v_cvt_pk_bf16_f32 v98, v68, v69
    v_exp_f32 v72, v72
    v_exp_f32 v73, v73
    v_cvt_pk_bf16_f32 v99, v70, v71
    v_exp_f32 v74, v74
    v_mfma_f32_32x32x16_bf16 v[192:207], v[124:127], v[104:107], v[192:207]
    s_addc_u32 s89, s89, 0
    v_exp_f32 v75, v75
    v_cvt_pk_bf16_f32 v100, v72, v73
    v_exp_f32 v76, v76
    v_exp_f32 v77, v77
    v_cvt_pk_bf16_f32 v101, v74, v75
    v_exp_f32 v78, v78
    v_exp_f32 v79, v79
    v_cvt_pk_bf16_f32 v102, v76, v77
    v_mfma_f32_32x32x16_bf16 v[192:207], v[128:131], v[108:111], v[192:207]
    s_waitcnt lgkmcnt(0)
    v_cvt_pk_bf16_f32 v103, v78, v79
    v_exp_f32 v80, v80
    v_exp_f32 v81, v81
    v_exp_f32 v82, v82
    v_mfma_f32_32x32x16_bf16 v[64:79], v[112:115], v[160:163], 0
    ds_read_b128 v[124:127], v11 offset:39936
    ds_read_b128 v[128:131], v11 offset:40704
    s_add_u32 m0, s80, 4096
    v_exp_f32 v83, v83
    v_cvt_pk_bf16_f32 v104, v80, v81
    v_exp_f32 v84, v84
    v_mfma_f32_32x32x8_bf16 v[64:79], v[140:141], v[164:165], v[64:79]
    v_exp_f32 v85, v85
    v_cvt_pk_bf16_f32 v105, v82, v83
    v_exp_f32 v86, v86
    v_exp_f32 v87, v87
    v_cvt_pk_bf16_f32 v106, v84, v85
    v_exp_f32 v88, v88
    v_exp_f32 v89, v89
    v_cvt_pk_bf16_f32 v107, v86, v87
    v_exp_f32 v90, v90
    v_mfma_f32_32x32x16_bf16 v[176:191], v[132:135], v[96:99], v[176:191]
    global_load_lds_dwordx4 v10, s[88:89] offset:0 sc1
    v_exp_f32 v91, v91
    v_cvt_pk_bf16_f32 v108, v88, v89
    v_exp_f32 v92, v92
    v_exp_f32 v93, v93
    v_cvt_pk_bf16_f32 v109, v90, v91
    v_exp_f32 v94, v94
    v_exp_f32 v95, v95
    v_cvt_pk_bf16_f32 v110, v92, v93
    v_mfma_f32_32x32x16_bf16 v[176:191], v[136:139], v[100:103], v[176:191]
    v_cvt_pk_bf16_f32 v111, v94, v95
    v_exp_f32 v64, v64
    v_exp_f32 v65, v65
    v_exp_f32 v66, v66
    v_mfma_f32_32x32x16_bf16 v[80:95], v[112:115], v[166:169], 0
    ds_read_b128 v[116:119], v10 offset:37888
    v_exp_f32 v67, v67
    v_cvt_pk_bf16_f32 v96, v64, v65
    v_exp_f32 v68, v68
    v_mfma_f32_32x32x8_bf16 v[80:95], v[140:141], v[170:171], v[80:95]
    v_exp_f32 v69, v69
    v_cvt_pk_bf16_f32 v97, v66, v67
    v_exp_f32 v70, v70
    v_exp_f32 v71, v71
    v_cvt_pk_bf16_f32 v98, v68, v69
    v_exp_f32 v72, v72
    v_exp_f32 v73, v73
    v_cvt_pk_bf16_f32 v99, v70, v71
    v_exp_f32 v74, v74
    v_mfma_f32_32x32x16_bf16 v[192:207], v[132:135], v[104:107], v[192:207]
    v_exp_f32 v75, v75
    v_cvt_pk_bf16_f32 v100, v72, v73
    v_exp_f32 v76, v76
    v_exp_f32 v77, v77
    v_cvt_pk_bf16_f32 v101, v74, v75
    v_exp_f32 v78, v78
    v_exp_f32 v79, v79
    v_cvt_pk_bf16_f32 v102, v76, v77
    v_mfma_f32_32x32x16_bf16 v[192:207], v[136:139], v[108:111], v[192:207]
    s_waitcnt lgkmcnt(0)
    v_cvt_pk_bf16_f32 v103, v78, v79
    v_exp_f32 v80, v80
    v_exp_f32 v81, v81
    v_exp_f32 v82, v82
    v_mfma_f32_32x32x16_bf16 v[64:79], v[116:119], v[160:163], 0
    ds_read_b128 v[132:135], v11 offset:41472
    ds_read_b128 v[136:139], v11 offset:42240
    s_add_u32 m0, s80, 4096
    v_exp_f32 v83, v83
    v_cvt_pk_bf16_f32 v104, v80, v81
    v_exp_f32 v84, v84
    v_mfma_f32_32x32x8_bf16 v[64:79], v[142:143], v[164:165], v[64:79]
    v_exp_f32 v85, v85
    v_cvt_pk_bf16_f32 v105, v82, v83
    v_exp_f32 v86, v86
    v_exp_f32 v87, v87
    v_cvt_pk_bf16_f32 v106, v84, v85
    v_exp_f32 v88, v88
    v_exp_f32 v89, v89
    v_cvt_pk_bf16_f32 v107, v86, v87
    v_exp_f32 v90, v90
    v_mfma_f32_32x32x16_bf16 v[176:191], v[124:127], v[96:99], v[176:191]
    global_load_lds_dwordx4 v10, s[88:89] offset:1024 sc1
    v_exp_f32 v91, v91
    v_cvt_pk_bf16_f32 v108, v88, v89
    v_exp_f32 v92, v92
    v_exp_f32 v93, v93
    v_cvt_pk_bf16_f32 v109, v90, v91
    v_exp_f32 v94, v94
    v_exp_f32 v95, v95
    v_cvt_pk_bf16_f32 v110, v92, v93
    v_mfma_f32_32x32x16_bf16 v[176:191], v[128:131], v[100:103], v[176:191]
    v_cvt_pk_bf16_f32 v111, v94, v95
    v_exp_f32 v64, v64
    v_exp_f32 v65, v65
    v_exp_f32 v66, v66
    v_mfma_f32_32x32x16_bf16 v[80:95], v[116:119], v[166:169], 0
    ds_read_b128 v[112:115], v10 offset:43008
    ds_read_b128 v[144:147], v10 offset:45056
    s_add_u32 s88, s88, s90
    v_exp_f32 v67, v67
    v_cvt_pk_bf16_f32 v96, v64, v65
    v_exp_f32 v68, v68
    v_mfma_f32_32x32x8_bf16 v[80:95], v[142:143], v[170:171], v[80:95]
    v_exp_f32 v69, v69
    v_cvt_pk_bf16_f32 v97, v66, v67
    v_exp_f32 v70, v70
    v_exp_f32 v71, v71
    v_cvt_pk_bf16_f32 v98, v68, v69
    v_exp_f32 v72, v72
    v_exp_f32 v73, v73
    v_cvt_pk_bf16_f32 v99, v70, v71
    v_exp_f32 v74, v74
    v_mfma_f32_32x32x16_bf16 v[192:207], v[124:127], v[104:107], v[192:207]
    s_addc_u32 s89, s89, s91
    v_exp_f32 v75, v75
    v_cvt_pk_bf16_f32 v100, v72, v73
    v_exp_f32 v76, v76
    v_exp_f32 v77, v77
    v_cvt_pk_bf16_f32 v101, v74, v75
    v_exp_f32 v78, v78
    v_exp_f32 v79, v79
    v_cvt_pk_bf16_f32 v102, v76, v77
    v_mfma_f32_32x32x16_bf16 v[192:207], v[128:131], v[108:111], v[192:207]
    s_waitcnt lgkmcnt(0)
    v_cvt_pk_bf16_f32 v103, v78, v79
    v_exp_f32 v80, v80
    v_exp_f32 v81, v81
    v_exp_f32 v82, v82
    v_mfma_f32_32x32x16_bf16 v[64:79], v[112:115], v[160:163], 0
    ds_read_b128 v[124:127], v11 offset:46080
    ds_read_b128 v[128:131], v11 offset:46848
    v_exp_f32 v83, v83
    v_cvt_pk_bf16_f32 v104, v80, v81
    v_exp_f32 v84, v84
    v_mfma_f32_32x32x8_bf16 v[64:79], v[144:145], v[164:165], v[64:79]
    v_exp_f32 v85, v85
    v_cvt_pk_bf16_f32 v105, v82, v83
    v_exp_f32 v86, v86
    v_exp_f32 v87, v87
    v_cvt_pk_bf16_f32 v106, v84, v85
    v_exp_f32 v88, v88
    v_exp_f32 v89, v89
    v_cvt_pk_bf16_f32 v107, v86, v87
    v_exp_f32 v90, v90
    v_mfma_f32_32x32x16_bf16 v[176:191], v[132:135], v[96:99], v[176:191]
    v_exp_f32 v91, v91
    v_cvt_pk_bf16_f32 v108, v88, v89
    v_exp_f32 v92, v92
    v_exp_f32 v93, v93
    v_cvt_pk_bf16_f32 v109, v90, v91
    v_exp_f32 v94, v94
    v_exp_f32 v95, v95
    v_cvt_pk_bf16_f32 v110, v92, v93
    v_mfma_f32_32x32x16_bf16 v[176:191], v[136:139], v[100:103], v[176:191]
    v_cvt_pk_bf16_f32 v111, v94, v95
    v_exp_f32 v64, v64
    v_exp_f32 v65, v65
    v_exp_f32 v66, v66
    v_mfma_f32_32x32x16_bf16 v[80:95], v[112:115], v[166:169], 0
    ds_read_b128 v[116:119], v10 offset:44032
    v_exp_f32 v67, v67
    v_cvt_pk_bf16_f32 v96, v64, v65
    v_exp_f32 v68, v68
    v_mfma_f32_32x32x8_bf16 v[80:95], v[144:145], v[170:171], v[80:95]
    v_exp_f32 v69, v69
    v_cvt_pk_bf16_f32 v97, v66, v67
    v_exp_f32 v70, v70
    v_exp_f32 v71, v71
    v_cvt_pk_bf16_f32 v98, v68, v69
    v_exp_f32 v72, v72
    v_exp_f32 v73, v73
    v_cvt_pk_bf16_f32 v99, v70, v71
    v_exp_f32 v74, v74
    v_mfma_f32_32x32x16_bf16 v[192:207], v[132:135], v[104:107], v[192:207]
    v_exp_f32 v75, v75
    v_cvt_pk_bf16_f32 v100, v72, v73
    v_exp_f32 v76, v76
    v_exp_f32 v77, v77
    v_cvt_pk_bf16_f32 v101, v74, v75
    v_exp_f32 v78, v78
    v_exp_f32 v79, v79
    v_cvt_pk_bf16_f32 v102, v76, v77
    v_mfma_f32_32x32x16_bf16 v[192:207], v[136:139], v[108:111], v[192:207]
    s_waitcnt lgkmcnt(0)
    v_cvt_pk_bf16_f32 v103, v78, v79
    v_exp_f32 v80, v80
    v_exp_f32 v81, v81
    v_exp_f32 v82, v82
    v_mfma_f32_32x32x16_bf16 v[64:79], v[116:119], v[160:163], 0
    ds_read_b128 v[132:135], v11 offset:47616
    ds_read_b128 v[136:139], v11 offset:48384
    v_exp_f32 v83, v83
    v_cvt_pk_bf16_f32 v104, v80, v81
    v_exp_f32 v84, v84
    v_mfma_f32_32x32x8_bf16 v[64:79], v[146:147], v[164:165], v[64:79]
    v_exp_f32 v85, v85
    v_cvt_pk_bf16_f32 v105, v82, v83
    v_exp_f32 v86, v86
    v_exp_f32 v87, v87
    v_cvt_pk_bf16_f32 v106, v84, v85
    v_exp_f32 v88, v88
    v_exp_f32 v89, v89
    v_cvt_pk_bf16_f32 v107, v86, v87
    v_exp_f32 v90, v90
    v_mfma_f32_32x32x16_bf16 v[176:191], v[124:127], v[96:99], v[176:191]
    v_exp_f32 v91, v91
    v_cvt_pk_bf16_f32 v108, v88, v89
    v_exp_f32 v92, v92
    v_exp_f32 v93, v93
    v_cvt_pk_bf16_f32 v109, v90, v91
    v_exp_f32 v94, v94
    v_exp_f32 v95, v95
    v_cvt_pk_bf16_f32 v110, v92, v93
    v_mfma_f32_32x32x16_bf16 v[176:191], v[128:131], v[100:103], v[176:191]
    v_cvt_pk_bf16_f32 v111, v94, v95
    s_waitcnt vmcnt(0) lgkmcnt(0)
    s_barrier
    v_exp_f32 v64, v64
    v_exp_f32 v65, v65
    v_exp_f32 v66, v66
    v_mfma_f32_32x32x16_bf16 v[80:95], v[116:119], v[166:169], 0
    ds_read_b128 v[112:115], v10 offset:0
    ds_read_b128 v[140:143], v10 offset:2048
    v_exp_f32 v67, v67
    v_cvt_pk_bf16_f32 v96, v64, v65
    v_exp_f32 v68, v68
    v_mfma_f32_32x32x8_bf16 v[80:95], v[146:147], v[170:171], v[80:95]
    v_exp_f32 v69, v69
    v_cvt_pk_bf16_f32 v97, v66, v67
    v_exp_f32 v70, v70
    v_exp_f32 v71, v71
    v_cvt_pk_bf16_f32 v98, v68, v69
    v_exp_f32 v72, v72
    v_exp_f32 v73, v73
    v_cvt_pk_bf16_f32 v99, v70, v71
    v_exp_f32 v74, v74
    v_mfma_f32_32x32x16_bf16 v[192:207], v[124:127], v[104:107], v[192:207]
    v_exp_f32 v75, v75
    v_cvt_pk_bf16_f32 v100, v72, v73
    v_exp_f32 v76, v76
    v_exp_f32 v77, v77
    v_cvt_pk_bf16_f32 v101, v74, v75
    v_exp_f32 v78, v78
    v_exp_f32 v79, v79
    v_cvt_pk_bf16_f32 v102, v76, v77
    v_mfma_f32_32x32x16_bf16 v[192:207], v[128:131], v[108:111], v[192:207]
    s_waitcnt lgkmcnt(0)
    v_cvt_pk_bf16_f32 v103, v78, v79
    v_exp_f32 v80, v80
    v_exp_f32 v81, v81
    v_exp_f32 v82, v82
    v_mfma_f32_32x32x16_bf16 v[64:79], v[112:115], v[160:163], 0
    ds_read_b128 v[124:127], v11 offset:3072
    ds_read_b128 v[128:131], v11 offset:3840
    s_add_u32 m0, s80, 24576
    v_exp_f32 v83, v83
    v_cvt_pk_bf16_f32 v104, v80, v81
    v_exp_f32 v84, v84
    v_mfma_f32_32x32x8_bf16 v[64:79], v[140:141], v[164:165], v[64:79]
    v_exp_f32 v85, v85
    v_cvt_pk_bf16_f32 v105, v82, v83
    v_exp_f32 v86, v86
    v_exp_f32 v87, v87
    v_cvt_pk_bf16_f32 v106, v84, v85
    v_exp_f32 v88, v88
    v_exp_f32 v89, v89
    v_cvt_pk_bf16_f32 v107, v86, v87
    v_exp_f32 v90, v90
    v_mfma_f32_32x32x16_bf16 v[176:191], v[132:135], v[96:99], v[176:191]
    global_load_lds_dwordx4 v10, s[88:89] offset:0 sc1
    v_exp_f32 v91, v91
    v_cvt_pk_bf16_f32 v108, v88, v89
    v_exp_f32 v92, v92
    v_exp_f32 v93, v93
    v_cvt_pk_bf16_f32 v109, v90, v91
    v_exp_f32 v94, v94
    v_exp_f32 v95, v95
    v_cvt_pk_bf16_f32 v110, v92, v93
    v_mfma_f32_32x32x16_bf16 v[176:191], v[136:139], v[100:103], v[176:191]
    v_cvt_pk_bf16_f32 v111, v94, v95
    s_sub_u32 s86, s86, 1
    s_cmp_lg_u32 s86, 0
    s_cbranch_scc1 L_a_loop
    v_mfma_f32_32x32x16_bf16 v[192:207], v[132:135], v[104:107], v[192:207]
    v_mfma_f32_32x32x16_bf16 v[192:207], v[136:139], v[108:111], v[192:207]
L_a_out:
    s_lshl_b32 s4, s76, 1
    s_mul_i32 s4, s4, 40960
    s_mul_i32 s5, s79, 5120
    s_add_u32 s4, s4, s5
    s_add_u32 s4, s4, 0x100000
    s_lshl_b32 s5, s3, 10
    s_add_u32 s5, s5, s4
    s_and_b32 s6, s3, 1
    s_lshl_b32 s6, s6, 9
    s_lshr_b32 s7, s3, 1
    s_lshl_b32 s7, s7, 3
    s_add_u32 s6, s6, s7
    s_add_u32 s6, s6, s4
    s_add_u32 s6, s6, 4096
    s_mov_b32 s8, 0x7f000000
    s_mov_b32 s87, 0x8800000
    v_mov_b32 v2, v184
    v_mov_b32 v3, v184
    v_add_f32 v5, abs(v176), abs(v184)
    s_nop 0
    v_permlane32_swap_b32 v2, v3
    v_rcp_f32 v3, v3
    v_add_f32 v5, v5, abs(v177)
    v_add_f32 v5, v5, abs(v178)
    v_add_f32 v5, v5, abs(v179)
    v_mov_b32 v2, v3
    v_pk_mul_f32 v[32:33], v[176:177], v[2:3]
    v_pk_mul_f32 v[34:35], v[178:179], v[2:3]
    v_pk_mul_f32 v[36:37], v[180:181], v[2:3]
    v_pk_mul_f32 v[38:39], v[182:183], v[2:3]
    v_pk_mul_f32 v[40:41], v[184:185], v[2:3]
    v_pk_mul_f32 v[42:43], v[186:187], v[2:3]
    v_cvt_pk_bf16_f32 v64, v32, v33
    v_cvt_pk_bf16_f32 v65, v34, v35
    v_cvt_pk_bf16_f32 v66, v36, v37
    v_cvt_pk_bf16_f32 v67, v38, v39
    v_cvt_pk_bf16_f32 v68, v40, v41
    v_cvt_pk_bf16_f32 v69, v42, v43
    buffer_store_dwordx4 v[64:67], v10, s[48:51], s5 offen sc1
    s_mov_b64 exec, s[84:85]
    buffer_store_dwordx2 v[68:69], v10, s[48:51], s6 offen sc1
    s_mov_b64 exec, -1
    s_add_u32 s5, s5, 40960
    s_add_u32 s6, s6, 40960
    v_mov_b32 v2, v200
    v_mov_b32 v3, v200
    v_add_f32 v6, abs(v192), abs(v200)
    s_nop 0
    v_permlane32_swap_b32 v2, v3
    v_rcp_f32 v3, v3
    v_add_f32 v6, v6, abs(v193)
    v_add_f32 v6, v6, abs(v194)
    v_add_f32 v6, v6, abs(v195)
    v_mov_b32 v2, v3
    v_pk_mul_f32 v[48:49], v[192:193], v[2:3]
    v_pk_mul_f32 v[50:51], v[194:195], v[2:3]
    v_pk_mul_f32 v[52:53], v[196:197], v[2:3]
    v_pk_mul_f32 v[54:55], v[198:199], v[2:3]
    v_pk_mul_f32 v[56:57], v[200:201], v[2:3]
    v_pk_mul_f32 v[58:59], v[202:203], v[2:3]
    v_cvt_pk_bf16_f32 v72, v48, v49
    v_cvt_pk_bf16_f32 v73, v50, v51
    v_cvt_pk_bf16_f32 v74, v52, v53
    v_cvt_pk_bf16_f32 v75, v54, v55
    v_cvt_pk_bf16_f32 v76, v56, v57
    v_cvt_pk_bf16_f32 v77, v58, v59
    buffer_store_dwordx4 v[72:75], v10, s[48:51], s5 offen sc1
    s_mov_b64 exec, s[84:85]
    buffer_store_dwordx2 v[76:77], v10, s[48:51], s6 offen sc1
    s_mov_b64 exec, -1
    v_add_f32 v5, v5, abs(v180)
    v_add_f32 v5, v5, abs(v181)
    v_add_f32 v5, v5, abs(v182)
    v_add_f32 v5, v5, abs(v183)
    v_add_f32 v5, v5, abs(v185)
    v_add_f32 v5, v5, abs(v186)
    v_add_f32 v5, v5, abs(v187)
    v_add_f32 v6, v6, abs(v196)
    v_add_f32 v6, v6, abs(v197)
    v_add_f32 v6, v6, abs(v198)
    v_add_f32 v6, v6, abs(v199)
    v_add_f32 v6, v6, abs(v201)
    v_add_f32 v6, v6, abs(v202)
    v_add_f32 v6, v6, abs(v203)
    v_min_f32 v7, v5, v6
    v_cmp_gt_f32 vcc, s8, v5
    v_cmp_gt_f32 s[10:11], s8, v6
    v_cmp_lt_f32 s[12:13], s87, v7
    s_lshl_b32 s4, s76, 5
    s_lshl_b32 s7, s79, 2
    s_add_u32 s4, s4, s7
    s_add_u32 s4, s4, s3
    s_lshl_b32 s4, s4, 7
    s_add_u32 s98, s4, 0xc0000
    v_mov_b32 v2, s64
    s_and_b64 s[10:11], s[10:11], vcc
    s_and_b64 s[10:11], s[10:11], s[12:13]
    s_cmp_eq_u64 s[10:11], -1
    s_cselect_b32 s4, 1, s83
    s_cmp_eq_u32 s4, 0
    s_cbranch_scc1 L_a_fallback
    s_sub_u32 s5, s5, 40960
    v_lshrrev_b32 v4, 3, v0
    v_mul_u32_u24 v4, 39936, v4
    v_add_u32 v4, v4, v14
    s_waitcnt vmcnt(0)
    s_mov_b64 exec, 1
    buffer_store_dword v2, off, s[48:51], s98 sc1
    s_branch L_fin
L_a_fallback:
    s_mov_b32 s83, 1
    v_mov_b32 v12, 0xff800000
    v_cndmask_b32 v164, 0, v164, s[84:85]
    v_cndmask_b32 v165, 0, v165, s[84:85]
    v_mov_b32 v13, 0xff800000
    v_cndmask_b32 v170, 0, v170, s[84:85]
    v_cndmask_b32 v171, 0, v171, s[84:85]
    s_mov_b32 s87, 0
L_a_fb1:
    buffer_load_dwordx4 v[112:115], v10, s[72:75], s87 offen sc1
    buffer_load_dwordx4 v[116:119], v10, s[72:75], s87 offen offset:1024 sc1
    buffer_load_dwordx4 v[140:143], v10, s[72:75], s87 offen offset:2048 sc1
    s_waitcnt vmcnt(0)
    v_mfma_f32_32x32x16_bf16 v[64:79], v[112:115], v[160:163], 0
    v_mfma_f32_32x32x8_bf16 v[64:79], v[140:141], v[164:165], v[64:79]
    v_mfma_f32_32x32x16_bf16 v[80:95], v[112:115], v[166:169], 0
    v_mfma_f32_32x32x8_bf16 v[80:95], v[140:141], v[170:171], v[80:95]
    s_nop 9
    v_max3_f32 v12, v12, v64, v65
    v_max3_f32 v12, v12, v66, v67
    v_max3_f32 v12, v12, v68, v69
    v_max3_f32 v12, v12, v70, v71
    v_max3_f32 v12, v12, v72, v73
    v_max3_f32 v12, v12, v74, v75
    v_max3_f32 v12, v12, v76, v77
    v_max3_f32 v12, v12, v78, v79
    v_max3_f32 v13, v13, v80, v81
    v_max3_f32 v13, v13, v82, v83
    v_max3_f32 v13, v13, v84, v85
    v_max3_f32 v13, v13, v86, v87
    v_max3_f32 v13, v13, v88, v89
    v_max3_f32 v13, v13, v90, v91
    v_max3_f32 v13, v13, v92, v93
    v_max3_f32 v13, v13, v94, v95
    v_mfma_f32_32x32x16_bf16 v[64:79], v[116:119], v[160:163], 0
    v_mfma_f32_32x32x8_bf16 v[64:79], v[142:143], v[164:165], v[64:79]
    v_mfma_f32_32x32x16_bf16 v[80:95], v[116:119], v[166:169], 0
    v_mfma_f32_32x32x8_bf16 v[80:95], v[142:143], v[170:171], v[80:95]
    s_nop 9
    v_max3_f32 v12, v12, v64, v65
    v_max3_f32 v12, v12, v66, v67
    v_max3_f32 v12, v12, v68, v69
    v_max3_f32 v12, v12, v70, v71
    v_max3_f32 v12, v12, v72, v73
    v_max3_f32 v12, v12, v74, v75
    v_max3_f32 v12, v12, v76, v77
    v_max3_f32 v12, v12, v78, v79
    v_max3_f32 v13, v13, v80, v81
    v_max3_f32 v13, v13, v82, v83
    v_max3_f32 v13, v13, v84, v85
    v_max3_f32 v13, v13, v86, v87
    v_max3_f32 v13, v13, v88, v89
    v_max3_f32 v13, v13, v90, v91
    v_max3_f32 v13, v13, v92, v93
    v_max3_f32 v13, v13, v94, v95
    s_add_u32 s87, s87, 6144
    s_cmp_lt_u32 s87, 196608
    s_cbranch_scc1 L_a_fb1
    s_mov_b32 s4, 0xffff0000
    v_mov_b32 v2, v12
    s_nop 1
    v_permlane32_swap_b32 v12, v2
    v_max_f32 v12, v12, v2
    v_sub_f32 v2, 0x80000000, v12
    v_and_b32 v3, s4, v2
    v_sub_f32 v2, v2, v3
    v_and_b32 v4, s4, v2
    v_sub_f32 v2, v2, v4
    v_lshrrev_b32 v3, 16, v3
    v_or_b32 v3, v3, v4
    v_lshrrev_b32 v2, 16, v2
    v_cndmask_b32 v164, v3, v164, s[84:85]
    v_cndmask_b32 v165, v2, v165, s[84:85]
    v_mov_b32 v2, v13
    s_nop 1
    v_permlane32_swap_b32 v13, v2
    v_max_f32 v13, v13, v2
    v_sub_f32 v2, 0x80000000, v13
    v_and_b32 v3, s4, v2
    v_sub_f32 v2, v2, v3
    v_and_b32 v4, s4, v2
    v_sub_f32 v2, v2, v4
    v_lshrrev_b32 v3, 16, v3
    v_or_b32 v3, v3, v4
    v_lshrrev_b32 v2, 16, v2
    v_cndmask_b32 v170, v3, v170, s[84:85]
    v_cndmask_b32 v171, v2, v171, s[84:85]
    v_mov_b32 v176, 0
    v_mov_b32 v177, 0
    v_mov_b32 v178, 0
    v_mov_b32 v179, 0
    v_mov_b32 v180, 0
    v_mov_b32 v181, 0
    v_mov_b32 v182, 0
    v_mov_b32 v183, 0
    v_mov_b32 v184, 0
    v_mov_b32 v185, 0
    v_mov_b32 v186, 0
    v_mov_b32 v187, 0
    v_mov_b32 v188, 0
    v_mov_b32 v189, 0
    v_mov_b32 v190, 0
    v_mov_b32 v191, 0
    v_mov_b32 v192, 0
    v_mov_b32 v193, 0
    v_mov_b32 v194, 0
    v_mov_b32 v195, 0
    v_mov_b32 v196, 0
    v_mov_b32 v197, 0
    v_mov_b32 v198, 0
    v_mov_b32 v199, 0
    v_mov_b32 v200, 0
    v_mov_b32 v201, 0
    v_mov_b32 v202, 0
    v_mov_b32 v203, 0
    v_mov_b32 v204, 0
    v_mov_b32 v205, 0
    v_mov_b32 v206, 0
    v_mov_b32 v207, 0
    s_mov_b32 s87, 0
L_a_fb2:
    buffer_load_dwordx4 v[112:115], v10, s[72:75], s87 offen sc1
    buffer_load_dwordx4 v[116:119], v10, s[72:75], s87 offen offset:1024 sc1
    buffer_load_dwordx4 v[140:143], v10, s[72:75], s87 offen offset:2048 sc1
    s_add_u32 s86, s87, 3072
    buffer_load_dwordx4 v[124:127], v11, s[72:75], s86 offen offset:0 sc1
    buffer_load_dwordx4 v[128:131], v11, s[72:75], s86 offen offset:768 sc1
    buffer_load_dwordx4 v[132:135], v11, s[72:75], s86 offen offset:1536 sc1
    buffer_load_dwordx4 v[136:139], v11, s[72:75], s86 offen offset:2304 sc1
    s_waitcnt vmcnt(0)
    v_mfma_f32_32x32x16_bf16 v[64:79], v[112:115], v[160:163], 0
    v_mfma_f32_32x32x8_bf16 v[64:79], v[140:141], v[164:165], v[64:79]
    v_mfma_f32_32x32x16_bf16 v[80:95], v[112:115], v[166:169], 0
    v_mfma_f32_32x32x8_bf16 v[80:95], v[140:141], v[170:171], v[80:95]
    s_nop 9
    v_exp_f32 v64, v64
    v_exp_f32 v65, v65
    v_exp_f32 v66, v66
    v_exp_f32 v67, v67
    v_exp_f32 v68, v68
    v_exp_f32 v69, v69
    v_exp_f32 v70, v70
    v_exp_f32 v71, v71
    v_exp_f32 v72, v72
    v_exp_f32 v73, v73
    v_exp_f32 v74, v74
    v_exp_f32 v75, v75
    v_exp_f32 v76, v76
    v_exp_f32 v77, v77
    v_exp_f32 v78, v78
    v_exp_f32 v79, v79
    v_cvt_pk_bf16_f32 v96, v64, v65
    v_cvt_pk_bf16_f32 v97, v66, v67
    v_cvt_pk_bf16_f32 v98, v68, v69
    v_cvt_pk_bf16_f32 v99, v70, v71
    v_cvt_pk_bf16_f32 v100, v72, v73
    v_cvt_pk_bf16_f32 v101, v74, v75
    v_cvt_pk_bf16_f32 v102, v76, v77
    v_cvt_pk_bf16_f32 v103, v78, v79
    v_mfma_f32_32x32x16_bf16 v[176:191], v[124:127], v[96:99], v[176:191]
    s_nop 0
    v_mfma_f32_32x32x16_bf16 v[176:191], v[128:131], v[100:103], v[176:191]
    v_exp_f32 v80, v80
    v_exp_f32 v81, v81
    v_exp_f32 v82, v82
    v_exp_f32 v83, v83
    v_exp_f32 v84, v84
    v_exp_f32 v85, v85
    v_exp_f32 v86, v86
    v_exp_f32 v87, v87
    v_exp_f32 v88, v88
    v_exp_f32 v89, v89
    v_exp_f32 v90, v90
    v_exp_f32 v91, v91
    v_exp_f32 v92, v92
    v_exp_f32 v93, v93
    v_exp_f32 v94, v94
    v_exp_f32 v95, v95
    v_cvt_pk_bf16_f32 v104, v80, v81
    v_cvt_pk_bf16_f32 v105, v82, v83
    v_cvt_pk_bf16_f32 v106, v84, v85
    v_cvt_pk_bf16_f32 v107, v86, v87
    v_cvt_pk_bf16_f32 v108, v88, v89
    v_cvt_pk_bf16_f32 v109, v90, v91
    v_cvt_pk_bf16_f32 v110, v92, v93
    v_cvt_pk_bf16_f32 v111, v94, v95
    v_mfma_f32_32x32x16_bf16 v[192:207], v[124:127], v[104:107], v[192:207]
    s_nop 0
    v_mfma_f32_32x32x16_bf16 v[192:207], v[128:131], v[108:111], v[192:207]
    v_mfma_f32_32x32x16_bf16 v[64:79], v[116:119], v[160:163], 0
    v_mfma_f32_32x32x8_bf16 v[64:79], v[142:143], v[164:165], v[64:79]
    v_mfma_f32_32x32x16_bf16 v[80:95], v[116:119], v[166:169], 0
    v_mfma_f32_32x32x8_bf16 v[80:95], v[142:143], v[170:171], v[80:95]
    s_nop 9
    v_exp_f32 v64, v64
    v_exp_f32 v65, v65
    v_exp_f32 v66, v66
    v_exp_f32 v67, v67
    v_exp_f32 v68, v68
    v_exp_f32 v69, v69
    v_exp_f32 v70, v70
    v_exp_f32 v71, v71
    v_exp_f32 v72, v72
    v_exp_f32 v73, v73
    v_exp_f32 v74, v74
    v_exp_f32 v75, v75
    v_exp_f32 v76, v76
    v_exp_f32 v77, v77
    v_exp_f32 v78, v78
    v_exp_f32 v79, v79
    v_cvt_pk_bf16_f32 v96, v64, v65
    v_cvt_pk_bf16_f32 v97, v66, v67
    v_cvt_pk_bf16_f32 v98, v68, v69
    v_cvt_pk_bf16_f32 v99, v70, v71
    v_cvt_pk_bf16_f32 v100, v72, v73
    v_cvt_pk_bf16_f32 v101, v74, v75
    v_cvt_pk_bf16_f32 v102, v76, v77
    v_cvt_pk_bf16_f32 v103, v78, v79
    v_mfma_f32_32x32x16_bf16 v[176:191], v[132:135], v[96:99], v[176:191]
    s_nop 0
    v_mfma_f32_32x32x16_bf16 v[176:191], v[136:139], v[100:103], v[176:191]
    v_exp_f32 v80, v80
    v_exp_f32 v81, v81
    v_exp_f32 v82, v82
    v_exp_f32 v83, v83
    v_exp_f32 v84, v84
    v_exp_f32 v85, v85
    v_exp_f32 v86, v86
    v_exp_f32 v87, v87
    v_exp_f32 v88, v88
    v_exp_f32 v89, v89
    v_exp_f32 v90, v90
    v_exp_f32 v91, v91
    v_exp_f32 v92, v92
    v_exp_f32 v93, v93
    v_exp_f32 v94, v94
    v_exp_f32 v95, v95
    v_cvt_pk_bf16_f32 v104, v80, v81
    v_cvt_pk_bf16_f32 v105, v82, v83
    v_cvt_pk_bf16_f32 v106, v84, v85
    v_cvt_pk_bf16_f32 v107, v86, v87
    v_cvt_pk_bf16_f32 v108, v88, v89
    v_cvt_pk_bf16_f32 v109, v90, v91
    v_cvt_pk_bf16_f32 v110, v92, v93
    v_cvt_pk_bf16_f32 v111, v94, v95
    v_mfma_f32_32x32x16_bf16 v[192:207], v[132:135], v[104:107], v[192:207]
    s_nop 0
    v_mfma_f32_32x32x16_bf16 v[192:207], v[136:139], v[108:111], v[192:207]
    s_add_u32 s87, s87, 6144
    s_cmp_lt_u32 s87, 196608
    s_cbranch_scc1 L_a_fb2
    s_branch L_a_out
L_roleG1:
    s_and_b32 s4, s2, 7
    s_lshr_b32 s5, s2, 3
    s_and_b32 s6, s4, 3
    s_mul_i32 s6, s6, 27
    s_add_u32 s6, s6, s5
    s_lshr_b32 s79, s6, 2
    s_and_b32 s6, s6, 3
    s_and_b32 s4, s4, 4
    s_add_u32 s76, s4, s6
    s_lshr_b32 s78, s3, 1
    s_cmp_eq_u32 s78, 0
    s_cselect_b32 s44, s28, s30
    s_cselect_b32 s45, s29, s31
    s_mov_b32 s46, 2211840
    s_lshl_b32 s4, s76, 8
    s_lshl_b32 s5, s3, 6
    s_add_u32 s77, s4, s5
    v_lshrrev_b32 v2, 3, v0
    v_add_u32 v2, s77, v2
    v_mul_u32_u24 v2, 1280, v2
    v_lshrrev_b32 v3, 4, v0
    v_xor_b32 v3, v0, v3
    v_and_b32 v3, 7, v3
    v_lshl_add_u32 v24, v3, 4, v2
    v_xor_b32 v3, 4, v3
    v_lshl_add_u32 v25, v3, 4, v2
    v_lshrrev_b32 v2, 3, v0
    v_mul_u32_u24 v2, 3456, v2
    v_bfe_u32 v3, v0, 4, 1
    s_lshl_b32 s4, s78, 1
    v_or_b32 v3, s4, v3
    v_lshlrev_b32 v3, 1, v3
    v_and_b32 v4, 7, v0
    v_xor_b32 v3, v3, v4
    v_lshl_add_u32 v2, v3, 4, v2
    s_and_b32 s4, s3, 1
    s_mul_i32 s5, s4, 110592
    s_lshl_b32 s6, s79, 7
    s_add_u32 s5, s5, s6
    v_add_u32 v26, s5, v2
    s_lshl_b32 s81, s78, 13
    s_lshl_b32 s4, s4, 12
    s_add_u32 s81, s81, s4
    s_mul_i32 s80, s3, 12288
    s_add_u32 s80, s80, 32768
    s_and_b32 s6, s76, 3
    s_mul_i32 s6, s6, 5
    s_lshr_b32 s6, s6, 1
    s_mul_i32 s7, s79, 3
    s_add_u32 s6, s6, s7
    s_mul_i32 s7, s6, 6554
    s_lshr_b32 s7, s7, 16
    s_mul_i32 s7, s7, 10
    s_sub_u32 s6, s6, s7
    s_mov_b32 s6, 0
    s_mul_i32 s88, s6, 128
    s_mul_i32 s89, s6, 221184
    v_and_b32 v2, 31, v0
    v_lshrrev_b32 v3, 5, v0
    v_bfe_u32 v20, v0, 1, 3
    v_xor_b32 v3, v3, v20
    v_lshlrev_b32 v2, 7, v2
    v_add_u32 v2, s80, v2
    v_xor_b32 v20, 0, v3
    v_lshl_add_u32 v20, v20, 4, v2
    v_xor_b32 v21, 2, v3
    v_lshl_add_u32 v21, v21, 4, v2
    v_xor_b32 v22, 4, v3
    v_lshl_add_u32 v22, v22, 4, v2
    v_xor_b32 v23, 6, v3
    v_lshl_add_u32 v23, v23, 4, v2
    v_bfe_u32 v2, v0, 2, 2
    v_lshrrev_b32 v3, 5, v0
    v_mul_u32_u24 v3, 8, v3
    v_add_u32 v2, v2, v3
    v_and_b32 v3, 3, v0
    v_lshlrev_b32 v3, 3, v3
    v_lshlrev_b32 v2, 7, v2
    v_add_u32 v2, v2, v3
    v_bfe_u32 v3, v0, 4, 1
    v_lshl_add_u32 v2, v3, 13, v2
    v_lshlrev_b32 v3, 1, v3
    v_bfe_u32 v4, v0, 3, 1
    v_or_b32 v3, v3, v4
    v_xor_b32 v3, s3, v3
    v_xor_b32 v4, 0, v3
    v_lshl_add_u32 v16, v4, 5, v2
    v_xor_b32 v4, 1, v3
    v_lshl_add_u32 v17, v4, 5, v2
    v_xor_b32 v4, 2, v3
    v_lshl_add_u32 v18, v4, 5, v2
    v_xor_b32 v4, 3, v3
    v_lshl_add_u32 v19, v4, 5, v2
    v_and_b32 v2, 15, v0
    v_bfe_u32 v3, v0, 4, 1
    v_cmp_eq_u32 vcc, v2, v3
    v_mov_b32 v2, 0x3f803f80
    s_nop 0
    v_cndmask_b32 v4, 0, v2, vcc
    v_cndmask_b32 v5, 0, v2, vcc
    v_cndmask_b32 v6, 0, v2, vcc
    v_cndmask_b32 v7, 0, v2, vcc
    v_and_b32 v27, 31, v0
    v_lshlrev_b32 v27, 4, v27
    s_lshl_b32 s14, s77, 4
    s_add_u32 s14, s14, 0x40000
    s_mul_i32 s4, s3, 27
    s_lshr_b32 s4, s4, 2
    s_mul_i32 s5, s3, 10
    s_add_u32 s5, s5, 76
    s_lshr_b32 s5, s5, 2
    v_mov_b32 v2, s4
    v_mov_b32 v3, s5
    v_cmp_gt_u32 vcc, 8, v0
    s_nop 1
    v_cndmask_b32 v2, v3, v2, vcc
    v_add_lshl_u32 v14, v2, v0, 7
    s_add_u32 m0, s80, 0
    s_add_u32 s4, s88, 0
    buffer_load_dwordx4 v24, s[40:43], s4 offen lds
    s_add_u32 m0, s80, 1024
    s_add_u32 s4, s88, 10240
    buffer_load_dwordx4 v25, s[40:43], s4 offen lds
    s_add_u32 m0, s80, 2048
    s_add_u32 s4, s88, 20480
    buffer_load_dwordx4 v24, s[40:43], s4 offen lds
    s_add_u32 m0, s80, 3072
    s_add_u32 s4, s88, 30720
    buffer_load_dwordx4 v25, s[40:43], s4 offen lds
    s_add_u32 m0, s81, 0
    s_add_u32 s4, s89, 0
    buffer_load_dwordx4 v26, s[44:47], s4 offen lds
    s_add_u32 m0, s81, 1024
    s_add_u32 s4, s89, 27648
    buffer_load_dwordx4 v26, s[44:47], s4 offen lds
    s_add_u32 m0, s81, 2048
    s_add_u32 s4, s89, 55296
    buffer_load_dwordx4 v26, s[44:47], s4 offen lds
    s_add_u32 m0, s81, 3072
    s_add_u32 s4, s89, 82944
    buffer_load_dwordx4 v26, s[44:47], s4 offen lds
    s_add_u32 s89, s89, 221184
    s_cmp_eq_u32 s89, 2211840
    s_cselect_b32 s89, 0, s89
    s_add_u32 m0, s80, 4096
    s_add_u32 s4, s88, 40960
    buffer_load_dwordx4 v24, s[40:43], s4 offen lds
    s_add_u32 m0, s80, 5120
    s_add_u32 s4, s88, 51200
    buffer_load_dwordx4 v25, s[40:43], s4 offen lds
    s_add_u32 m0, s80, 6144
    s_add_u32 s4, s88, 61440
    buffer_load_dwordx4 v24, s[40:43], s4 offen lds
    s_add_u32 m0, s80, 7168
    s_add_u32 s4, s88, 71680
    buffer_load_dwordx4 v25, s[40:43], s4 offen lds
    s_add_u32 s88, s88, 128
    s_cmp_eq_u32 s88, 1280
    s_cselect_b32 s88, 0, s88
    s_waitcnt vmcnt(4)
    s_barrier
    s_setprio 3
    ds_read_b128 v[32:35], v20 offset:0
    ds_read_b128 v[36:39], v21 offset:0
    ds_read_b128 v[40:43], v22 offset:0
    ds_read_b128 v[44:47], v23 offset:0
    ds_read_b64_tr_b16 v[64:65], v16 offset:0
    ds_read_b64_tr_b16 v[66:67], v16 offset:512
    ds_read_b64_tr_b16 v[68:69], v17 offset:0
    ds_read_b64_tr_b16 v[70:71], v17 offset:512
    ds_read_b64_tr_b16 v[72:73], v18 offset:0
    ds_read_b64_tr_b16 v[74:75], v18 offset:512
    ds_read_b64_tr_b16 v[76:77], v19 offset:0
    ds_read_b64_tr_b16 v[78:79], v19 offset:512
    ds_read_b64_tr_b16 v[80:81], v16 offset:2048
    ds_read_b64_tr_b16 v[82:83], v16 offset:2560
    ds_read_b64_tr_b16 v[84:85], v17 offset:2048
    ds_read_b64_tr_b16 v[86:87], v17 offset:2560
    ds_read_b64_tr_b16 v[88:89], v18 offset:2048
    ds_read_b64_tr_b16 v[90:91], v18 offset:2560
    ds_read_b64_tr_b16 v[92:93], v19 offset:2048
    ds_read_b64_tr_b16 v[94:95], v19 offset:2560
    ds_read_b64_tr_b16 v[96:97], v16 offset:4096
    ds_read_b64_tr_b16 v[98:99], v16 offset:4608
    ds_read_b64_tr_b16 v[100:101], v17 offset:4096
    ds_read_b64_tr_b16 v[102:103], v17 offset:4608
    ds_read_b64_tr_b16 v[104:105], v18 offset:4096
    ds_read_b64_tr_b16 v[106:107], v18 offset:4608
    ds_read_b64_tr_b16 v[108:109], v19 offset:4096
    ds_read_b64_tr_b16 v[110:111], v19 offset:4608
    ds_read_b64_tr_b16 v[112:113], v16 offset:6144
    ds_read_b64_tr_b16 v[114:115], v16 offset:6656
    ds_read_b64_tr_b16 v[116:117], v17 offset:6144
    ds_read_b64_tr_b16 v[118:119], v17 offset:6656
    ds_read_b64_tr_b16 v[120:121], v18 offset:6144
    ds_read_b64_tr_b16 v[122:123], v18 offset:6656
    ds_read_b64_tr_b16 v[124:125], v19 offset:6144
    ds_read_b64_tr_b16 v[126:127], v19 offset:6656
    s_waitcnt vmcnt(0) lgkmcnt(12)
    v_mfma_f32_32x32x16_bf16 v[128:143], v[64:67], v[32:35], 0
    s_add_u32 m0, s81, 16384
    s_add_u32 s4, s89, 0
    buffer_load_dwordx4 v26, s[44:47], s4 offen lds
    ds_read_b128 v[48:51], v20 offset:4096
    v_mfma_f32_32x32x16_bf16 v[144:159], v[68:71], v[32:35], 0
    s_add_u32 m0, s81, 17408
    s_add_u32 s4, s89, 27648
    buffer_load_dwordx4 v26, s[44:47], s4 offen lds
    ds_read_b128 v[52:55], v21 offset:4096
    v_mfma_f32_16x16x32_bf16 v[8:11], v[64:67], v[4:7], 0
    v_mfma_f32_32x32x16_bf16 v[160:175], v[72:75], v[32:35], 0
    s_add_u32 m0, s81, 18432
    s_add_u32 s4, s89, 55296
    buffer_load_dwordx4 v26, s[44:47], s4 offen lds
    ds_read_b128 v[56:59], v22 offset:4096
    v_mfma_f32_32x32x16_bf16 v[176:191], v[76:79], v[32:35], 0
    s_add_u32 m0, s81, 19456
    s_add_u32 s4, s89, 82944
    buffer_load_dwordx4 v26, s[44:47], s4 offen lds
    s_add_u32 s89, s89, 221184
    s_cmp_eq_u32 s89, 2211840
    s_cselect_b32 s89, 0, s89
    ds_read_b128 v[60:63], v23 offset:4096
    v_mfma_f32_32x32x16_bf16 v[128:143], v[80:83], v[36:39], v[128:143]
    s_add_u32 m0, s80, 8192
    s_add_u32 s4, s88, 0
    buffer_load_dwordx4 v24, s[40:43], s4 offen lds
    v_mfma_f32_32x32x16_bf16 v[144:159], v[84:87], v[36:39], v[144:159]
    s_add_u32 m0, s80, 9216
    s_add_u32 s4, s88, 10240
    buffer_load_dwordx4 v25, s[40:43], s4 offen lds
    v_mfma_f32_16x16x32_bf16 v[8:11], v[80:83], v[4:7], v[8:11]
    v_mfma_f32_32x32x16_bf16 v[160:175], v[88:91], v[36:39], v[160:175]
    s_add_u32 m0, s80, 10240
    s_add_u32 s4, s88, 20480
    buffer_load_dwordx4 v24, s[40:43], s4 offen lds
    v_mfma_f32_32x32x16_bf16 v[176:191], v[92:95], v[36:39], v[176:191]
    s_add_u32 m0, s80, 11264
    s_add_u32 s4, s88, 30720
    buffer_load_dwordx4 v25, s[40:43], s4 offen lds
    s_waitcnt lgkmcnt(4)
    v_mfma_f32_32x32x16_bf16 v[128:143], v[96:99], v[40:43], v[128:143]
    s_add_u32 m0, s80, 0
    s_add_u32 s4, s88, 40960
    buffer_load_dwordx4 v24, s[40:43], s4 offen lds
    v_mfma_f32_32x32x16_bf16 v[144:159], v[100:103], v[40:43], v[144:159]
    s_add_u32 m0, s80, 1024
    s_add_u32 s4, s88, 51200
    buffer_load_dwordx4 v25, s[40:43], s4 offen lds
    v_mfma_f32_16x16x32_bf16 v[8:11], v[96:99], v[4:7], v[8:11]
    v_mfma_f32_32x32x16_bf16 v[160:175], v[104:107], v[40:43], v[160:175]
    s_add_u32 m0, s80, 2048
    s_add_u32 s4, s88, 61440
    buffer_load_dwordx4 v24, s[40:43], s4 offen lds
    v_mfma_f32_32x32x16_bf16 v[176:191], v[108:111], v[40:43], v[176:191]
    s_waitcnt lgkmcnt(0)
    s_add_u32 m0, s80, 3072
    s_add_u32 s4, s88, 71680
    buffer_load_dwordx4 v25, s[40:43], s4 offen lds
    s_add_u32 s88, s88, 128
    s_cmp_eq_u32 s88, 1280
    s_cselect_b32 s88, 0, s88
    v_mfma_f32_32x32x16_bf16 v[128:143], v[112:115], v[44:47], v[128:143]
    s_add_u32 m0, s80, 4096
    s_add_u32 s4, s88, 0
    buffer_load_dwordx4 v24, s[40:43], s4 offen lds
    v_mfma_f32_32x32x16_bf16 v[144:159], v[116:119], v[44:47], v[144:159]
    v_mfma_f32_16x16x32_bf16 v[8:11], v[112:115], v[4:7], v[8:11]
    v_mfma_f32_32x32x16_bf16 v[160:175], v[120:123], v[44:47], v[160:175]
    s_add_u32 m0, s80, 5120
    s_add_u32 s4, s88, 10240
    buffer_load_dwordx4 v25, s[40:43], s4 offen lds
    v_mfma_f32_32x32x16_bf16 v[176:191], v[124:127], v[44:47], v[176:191]
    s_waitcnt vmcnt(6)
    s_barrier
    v_mfma_f32_32x32x16_bf16 v[192:207], v[64:67], v[48:51], 0
    ds_read_b128 v[32:35], v20 offset:8192
    ds_read_b64_tr_b16 v[64:65], v16 offset:16384
    ds_read_b64_tr_b16 v[66:67], v16 offset:16896
    v_mfma_f32_32x32x16_bf16 v[208:223], v[68:71], v[48:51], 0
    s_add_u32 m0, s81, 0
    s_add_u32 s4, s89, 0
    buffer_load_dwordx4 v26, s[44:47], s4 offen lds
    ds_read_b128 v[36:39], v21 offset:8192
    ds_read_b64_tr_b16 v[68:69], v17 offset:16384
    ds_read_b64_tr_b16 v[70:71], v17 offset:16896
    v_mfma_f32_32x32x16_bf16 v[224:239], v[72:75], v[48:51], 0
    ds_read_b128 v[40:43], v22 offset:8192
    ds_read_b64_tr_b16 v[72:73], v18 offset:16384
    ds_read_b64_tr_b16 v[74:75], v18 offset:16896
    v_mfma_f32_32x32x16_bf16 v[240:255], v[76:79], v[48:51], 0
    s_add_u32 m0, s81, 1024
    s_add_u32 s4, s89, 27648
    buffer_load_dwordx4 v26, s[44:47], s4 offen lds
    ds_read_b128 v[44:47], v23 offset:8192
    ds_read_b64_tr_b16 v[76:77], v19 offset:16384
    ds_read_b64_tr_b16 v[78:79], v19 offset:16896
    v_mfma_f32_32x32x16_bf16 v[192:207], v[80:83], v[52:55], v[192:207]
    ds_read_b64_tr_b16 v[80:81], v16 offset:18432
    ds_read_b64_tr_b16 v[82:83], v16 offset:18944
    v_mfma_f32_32x32x16_bf16 v[208:223], v[84:87], v[52:55], v[208:223]
    ds_read_b64_tr_b16 v[84:85], v17 offset:18432
    ds_read_b64_tr_b16 v[86:87], v17 offset:18944
    v_mfma_f32_32x32x16_bf16 v[224:239], v[88:91], v[52:55], v[224:239]
    s_add_u32 m0, s81, 2048
    s_add_u32 s4, s89, 55296
    buffer_load_dwordx4 v26, s[44:47], s4 offen lds
    ds_read_b64_tr_b16 v[88:89], v18 offset:18432
    ds_read_b64_tr_b16 v[90:91], v18 offset:18944
    v_mfma_f32_32x32x16_bf16 v[240:255], v[92:95], v[52:55], v[240:255]
    ds_read_b64_tr_b16 v[92:93], v19 offset:18432
    ds_read_b64_tr_b16 v[94:95], v19 offset:18944
    v_mfma_f32_32x32x16_bf16 v[192:207], v[96:99], v[56:59], v[192:207]
    ds_read_b64_tr_b16 v[96:97], v16 offset:20480
    ds_read_b64_tr_b16 v[98:99], v16 offset:20992
    v_mfma_f32_32x32x16_bf16 v[208:223], v[100:103], v[56:59], v[208:223]
    s_add_u32 m0, s81, 3072
    s_add_u32 s4, s89, 82944
    buffer_load_dwordx4 v26, s[44:47], s4 offen lds
    s_add_u32 s89, s89, 221184
    s_cmp_eq_u32 s89, 2211840
    s_cselect_b32 s89, 0, s89
    ds_read_b64_tr_b16 v[100:101], v17 offset:20480
    ds_read_b64_tr_b16 v[102:103], v17 offset:20992
    v_mfma_f32_32x32x16_bf16 v[224:239], v[104:107], v[56:59], v[224:239]
    ds_read_b64_tr_b16 v[104:105], v18 offset:20480
    ds_read_b64_tr_b16 v[106:107], v18 offset:20992
    v_mfma_f32_32x32x16_bf16 v[240:255], v[108:111], v[56:59], v[240:255]
    s_add_u32 m0, s80, 6144
    s_add_u32 s4, s88, 20480
    buffer_load_dwordx4 v24, s[40:43], s4 offen lds
    ds_read_b64_tr_b16 v[108:109], v19 offset:20480
    ds_read_b64_tr_b16 v[110:111], v19 offset:20992
    v_mfma_f32_32x32x16_bf16 v[192:207], v[112:115], v[60:63], v[192:207]
    ds_read_b64_tr_b16 v[112:113], v16 offset:22528
    ds_read_b64_tr_b16 v[114:115], v16 offset:23040
    v_mfma_f32_32x32x16_bf16 v[208:223], v[116:119], v[60:63], v[208:223]
    ds_read_b64_tr_b16 v[116:117], v17 offset:22528
    ds_read_b64_tr_b16 v[118:119], v17 offset:23040
    v_mfma_f32_32x32x16_bf16 v[224:239], v[120:123], v[60:63], v[224:239]
    s_add_u32 m0, s80, 7168
    s_add_u32 s4, s88, 30720
    buffer_load_dwordx4 v25, s[40:43], s4 offen lds
    ds_read_b64_tr_b16 v[120:121], v18 offset:22528
    ds_read_b64_tr_b16 v[122:123], v18 offset:23040
    v_mfma_f32_32x32x16_bf16 v[240:255], v[124:127], v[60:63], v[240:255]
    ds_read_b64_tr_b16 v[124:125], v19 offset:22528
    ds_read_b64_tr_b16 v[126:127], v19 offset:23040
    s_waitcnt vmcnt(8) lgkmcnt(12)
    v_mfma_f32_32x32x16_bf16 v[128:143], v[64:67], v[32:35], v[128:143]
    ds_read_b128 v[48:51], v20 offset:0
    v_mfma_f32_32x32x16_bf16 v[144:159], v[68:71], v[32:35], v[144:159]
    s_add_u32 m0, s80, 8192
    s_add_u32 s4, s88, 40960
    buffer_load_dwordx4 v24, s[40:43], s4 offen lds
    ds_read_b128 v[52:55], v21 offset:0
    v_mfma_f32_16x16x32_bf16 v[8:11], v[64:67], v[4:7], v[8:11]
    v_mfma_f32_32x32x16_bf16 v[160:175], v[72:75], v[32:35], v[160:175]
    ds_read_b128 v[56:59], v22 offset:0
    v_mfma_f32_32x32x16_bf16 v[176:191], v[76:79], v[32:35], v[176:191]
    ds_read_b128 v[60:63], v23 offset:0
    v_mfma_f32_32x32x16_bf16 v[128:143], v[80:83], v[36:39], v[128:143]
    s_add_u32 m0, s80, 9216
    s_add_u32 s4, s88, 51200
    buffer_load_dwordx4 v25, s[40:43], s4 offen lds
    v_mfma_f32_32x32x16_bf16 v[144:159], v[84:87], v[36:39], v[144:159]
    v_mfma_f32_16x16x32_bf16 v[8:11], v[80:83], v[4:7], v[8:11]
    v_mfma_f32_32x32x16_bf16 v[160:175], v[88:91], v[36:39], v[160:175]
    v_mfma_f32_32x32x16_bf16 v[176:191], v[92:95], v[36:39], v[176:191]
    s_add_u32 m0, s80, 10240
    s_add_u32 s4, s88, 61440
    buffer_load_dwordx4 v24, s[40:43], s4 offen lds
    s_waitcnt lgkmcnt(4)
    v_mfma_f32_32x32x16_bf16 v[128:143], v[96:99], v[40:43], v[128:143]
    v_mfma_f32_32x32x16_bf16 v[144:159], v[100:103], v[40:43], v[144:159]
    v_mfma_f32_16x16x32_bf16 v[8:11], v[96:99], v[4:7], v[8:11]
    v_mfma_f32_32x32x16_bf16 v[160:175], v[104:107], v[40:43], v[160:175]
    s_add_u32 m0, s80, 11264
    s_add_u32 s4, s88, 71680
    buffer_load_dwordx4 v25, s[40:43], s4 offen lds
    s_add_u32 s88, s88, 128
    s_cmp_eq_u32 s88, 1280
    s_cselect_b32 s88, 0, s88
    v_mfma_f32_32x32x16_bf16 v[176:191], v[108:111], v[40:43], v[176:191]
    s_waitcnt lgkmcnt(0)
    v_mfma_f32_32x32x16_bf16 v[128:143], v[112:115], v[44:47], v[128:143]
    s_add_u32 m0, s80, 0
    s_add_u32 s4, s88, 0
    buffer_load_dwordx4 v24, s[40:43], s4 offen lds
    v_mfma_f32_32x32x16_bf16 v[144:159], v[116:119], v[44:47], v[144:159]
    v_mfma_f32_16x16x32_bf16 v[8:11], v[112:115], v[4:7], v[8:11]
    v_mfma_f32_32x32x16_bf16 v[160:175], v[120:123], v[44:47], v[160:175]
    s_add_u32 m0, s80, 1024
    s_add_u32 s4, s88, 10240
    buffer_load_dwordx4 v25, s[40:43], s4 offen lds
    v_mfma_f32_32x32x16_bf16 v[176:191], v[124:127], v[44:47], v[176:191]
    s_waitcnt vmcnt(6)
    s_barrier
    v_mfma_f32_32x32x16_bf16 v[192:207], v[64:67], v[48:51], v[192:207]
    ds_read_b128 v[32:35], v20 offset:4096
    ds_read_b64_tr_b16 v[64:65], v16 offset:0
    ds_read_b64_tr_b16 v[66:67], v16 offset:512
    v_mfma_f32_32x32x16_bf16 v[208:223], v[68:71], v[48:51], v[208:223]
    s_add_u32 m0, s81, 16384
    s_add_u32 s4, s89, 0
    buffer_load_dwordx4 v26, s[44:47], s4 offen lds
    ds_read_b128 v[36:39], v21 offset:4096
    ds_read_b64_tr_b16 v[68:69], v17 offset:0
    ds_read_b64_tr_b16 v[70:71], v17 offset:512
    v_mfma_f32_32x32x16_bf16 v[224:239], v[72:75], v[48:51], v[224:239]
    ds_read_b128 v[40:43], v22 offset:4096
    ds_read_b64_tr_b16 v[72:73], v18 offset:0
    ds_read_b64_tr_b16 v[74:75], v18 offset:512
    v_mfma_f32_32x32x16_bf16 v[240:255], v[76:79], v[48:51], v[240:255]
    s_add_u32 m0, s81, 17408
    s_add_u32 s4, s89, 27648
    buffer_load_dwordx4 v26, s[44:47], s4 offen lds
    ds_read_b128 v[44:47], v23 offset:4096
    ds_read_b64_tr_b16 v[76:77], v19 offset:0
    ds_read_b64_tr_b16 v[78:79], v19 offset:512
    v_mfma_f32_32x32x16_bf16 v[192:207], v[80:83], v[52:55], v[192:207]
    ds_read_b64_tr_b16 v[80:81], v16 offset:2048
    ds_read_b64_tr_b16 v[82:83], v16 offset:2560
    v_mfma_f32_32x32x16_bf16 v[208:223], v[84:87], v[52:55], v[208:223]
    ds_read_b64_tr_b16 v[84:85], v17 offset:2048
    ds_read_b64_tr_b16 v[86:87], v17 offset:2560
    v_mfma_f32_32x32x16_bf16 v[224:239], v[88:91], v[52:55], v[224:239]
    s_add_u32 m0, s81, 18432
    s_add_u32 s4, s89, 55296
    buffer_load_dwordx4 v26, s[44:47], s4 offen lds
    ds_read_b64_tr_b16 v[88:89], v18 offset:2048
    ds_read_b64_tr_b16 v[90:91], v18 offset:2560
    v_mfma_f32_32x32x16_bf16 v[240:255], v[92:95], v[52:55], v[240:255]
    ds_read_b64_tr_b16 v[92:93], v19 offset:2048
    ds_read_b64_tr_b16 v[94:95], v19 offset:2560
    v_mfma_f32_32x32x16_bf16 v[192:207], v[96:99], v[56:59], v[192:207]
    ds_read_b64_tr_b16 v[96:97], v16 offset:4096
    ds_read_b64_tr_b16 v[98:99], v16 offset:4608
    v_mfma_f32_32x32x16_bf16 v[208:223], v[100:103], v[56:59], v[208:223]
    s_add_u32 m0, s81, 19456
    s_add_u32 s4, s89, 82944
    buffer_load_dwordx4 v26, s[44:47], s4 offen lds
    s_add_u32 s89, s89, 221184
    s_cmp_eq_u32 s89, 2211840
    s_cselect_b32 s89, 0, s89
    ds_read_b64_tr_b16 v[100:101], v17 offset:4096
    ds_read_b64_tr_b16 v[102:103], v17 offset:4608
    v_mfma_f32_32x32x16_bf16 v[224:239], v[104:107], v[56:59], v[224:239]
    ds_read_b64_tr_b16 v[104:105], v18 offset:4096
    ds_read_b64_tr_b16 v[106:107], v18 offset:4608
    v_mfma_f32_32x32x16_bf16 v[240:255], v[108:111], v[56:59], v[240:255]
    s_add_u32 m0, s80, 2048
    s_add_u32 s4, s88, 20480
    buffer_load_dwordx4 v24, s[40:43], s4 offen lds
    ds_read_b64_tr_b16 v[108:109], v19 offset:4096
    ds_read_b64_tr_b16 v[110:111], v19 offset:4608
    v_mfma_f32_32x32x16_bf16 v[192:207], v[112:115], v[60:63], v[192:207]
    ds_read_b64_tr_b16 v[112:113], v16 offset:6144
    ds_read_b64_tr_b16 v[114:115], v16 offset:6656
    v_mfma_f32_32x32x16_bf16 v[208:223], v[116:119], v[60:63], v[208:223]
    ds_read_b64_tr_b16 v[116:117], v17 offset:6144
    ds_read_b64_tr_b16 v[118:119], v17 offset:6656
    v_mfma_f32_32x32x16_bf16 v[224:239], v[120:123], v[60:63], v[224:239]
    s_add_u32 m0, s80, 3072
    s_add_u32 s4, s88, 30720
    buffer_load_dwordx4 v25, s[40:43], s4 offen lds
    ds_read_b64_tr_b16 v[120:121], v18 offset:6144
    ds_read_b64_tr_b16 v[122:123], v18 offset:6656
    v_mfma_f32_32x32x16_bf16 v[240:255], v[124:127], v[60:63], v[240:255]
    ds_read_b64_tr_b16 v[124:125], v19 offset:6144
    ds_read_b64_tr_b16 v[126:127], v19 offset:6656
    s_setprio 0
    s_waitcnt vmcnt(8) lgkmcnt(12)
    v_mfma_f32_32x32x16_bf16 v[128:143], v[64:67], v[32:35], v[128:143]
    ds_read_b128 v[48:51], v20 offset:8192
    v_mfma_f32_32x32x16_bf16 v[144:159], v[68:71], v[32:35], v[144:159]
    s_add_u32 m0, s80, 4096
    s_add_u32 s4, s88, 40960
    buffer_load_dwordx4 v24, s[40:43], s4 offen lds
    ds_read_b128 v[52:55], v21 offset:8192
    v_mfma_f32_16x16x32_bf16 v[8:11], v[64:67], v[4:7], v[8:11]
    v_mfma_f32_32x32x16_bf16 v[160:175], v[72:75], v[32:35], v[160:175]
    ds_read_b128 v[56:59], v22 offset:8192
    v_mfma_f32_32x32x16_bf16 v[176:191], v[76:79], v[32:35], v[176:191]
    ds_read_b128 v[60:63], v23 offset:8192
    v_mfma_f32_32x32x16_bf16 v[128:143], v[80:83], v[36:39], v[128:143]
    s_add_u32 m0, s80, 5120
    s_add_u32 s4, s88, 51200
    buffer_load_dwordx4 v25, s[40:43], s4 offen lds
    v_mfma_f32_32x32x16_bf16 v[144:159], v[84:87], v[36:39], v[144:159]
    v_mfma_f32_16x16x32_bf16 v[8:11], v[80:83], v[4:7], v[8:11]
    v_mfma_f32_32x32x16_bf16 v[160:175], v[88:91], v[36:39], v[160:175]
    v_mfma_f32_32x32x16_bf16 v[176:191], v[92:95], v[36:39], v[176:191]
    s_add_u32 m0, s80, 6144
    s_add_u32 s4, s88, 61440
    buffer_load_dwordx4 v24, s[40:43], s4 offen lds
    s_waitcnt lgkmcnt(4)
    v_mfma_f32_32x32x16_bf16 v[128:143], v[96:99], v[40:43], v[128:143]
    v_mfma_f32_32x32x16_bf16 v[144:159], v[100:103], v[40:43], v[144:159]
    v_mfma_f32_16x16x32_bf16 v[8:11], v[96:99], v[4:7], v[8:11]
    v_mfma_f32_32x32x16_bf16 v[160:175], v[104:107], v[40:43], v[160:175]
    s_add_u32 m0, s80, 7168
    s_add_u32 s4, s88, 71680
    buffer_load_dwordx4 v25, s[40:43], s4 offen lds
    s_add_u32 s88, s88, 128
    s_cmp_eq_u32 s88, 1280
    s_cselect_b32 s88, 0, s88
    v_mfma_f32_32x32x16_bf16 v[176:191], v[108:111], v[40:43], v[176:191]
    s_waitcnt lgkmcnt(0)
    v_mfma_f32_32x32x16_bf16 v[128:143], v[112:115], v[44:47], v[128:143]
    s_add_u32 m0, s80, 8192
    s_add_u32 s4, s88, 0
    buffer_load_dwordx4 v24, s[40:43], s4 offen lds
    v_mfma_f32_32x32x16_bf16 v[144:159], v[116:119], v[44:47], v[144:159]
    v_mfma_f32_16x16x32_bf16 v[8:11], v[112:115], v[4:7], v[8:11]
    v_mfma_f32_32x32x16_bf16 v[160:175], v[120:123], v[44:47], v[160:175]
    s_add_u32 m0, s80, 9216
    s_add_u32 s4, s88, 10240
    buffer_load_dwordx4 v25, s[40:43], s4 offen lds
    v_mfma_f32_32x32x16_bf16 v[176:191], v[124:127], v[44:47], v[176:191]
    s_waitcnt vmcnt(6)
    s_barrier
    v_mfma_f32_32x32x16_bf16 v[192:207], v[64:67], v[48:51], v[192:207]
    ds_read_b128 v[32:35], v20 offset:0
    ds_read_b64_tr_b16 v[64:65], v16 offset:16384
    ds_read_b64_tr_b16 v[66:67], v16 offset:16896
    v_mfma_f32_32x32x16_bf16 v[208:223], v[68:71], v[48:51], v[208:223]
    s_add_u32 m0, s81, 0
    s_add_u32 s4, s89, 0
    buffer_load_dwordx4 v26, s[44:47], s4 offen lds
    ds_read_b128 v[36:39], v21 offset:0
    ds_read_b64_tr_b16 v[68:69], v17 offset:16384
    ds_read_b64_tr_b16 v[70:71], v17 offset:16896
    v_mfma_f32_32x32x16_bf16 v[224:239], v[72:75], v[48:51], v[224:239]
    ds_read_b128 v[40:43], v22 offset:0
    ds_read_b64_tr_b16 v[72:73], v18 offset:16384
    ds_read_b64_tr_b16 v[74:75], v18 offset:16896
    v_mfma_f32_32x32x16_bf16 v[240:255], v[76:79], v[48:51], v[240:255]
    s_add_u32 m0, s81, 1024
    s_add_u32 s4, s89, 27648
    buffer_load_dwordx4 v26, s[44:47], s4 offen lds
    ds_read_b128 v[44:47], v23 offset:0
    ds_read_b64_tr_b16 v[76:77], v19 offset:16384
    ds_read_b64_tr_b16 v[78:79], v19 offset:16896
    v_mfma_f32_32x32x16_bf16 v[192:207], v[80:83], v[52:55], v[192:207]
    ds_read_b64_tr_b16 v[80:81], v16 offset:18432
    ds_read_b64_tr_b16 v[82:83], v16 offset:18944
    v_mfma_f32_32x32x16_bf16 v[208:223], v[84:87], v[52:55], v[208:223]
    ds_read_b64_tr_b16 v[84:85], v17 offset:18432
    ds_read_b64_tr_b16 v[86:87], v17 offset:18944
    v_mfma_f32_32x32x16_bf16 v[224:239], v[88:91], v[52:55], v[224:239]
    s_add_u32 m0, s81, 2048
    s_add_u32 s4, s89, 55296
    buffer_load_dwordx4 v26, s[44:47], s4 offen lds
    ds_read_b64_tr_b16 v[88:89], v18 offset:18432
    ds_read_b64_tr_b16 v[90:91], v18 offset:18944
    v_mfma_f32_32x32x16_bf16 v[240:255], v[92:95], v[52:55], v[240:255]
    ds_read_b64_tr_b16 v[92:93], v19 offset:18432
    ds_read_b64_tr_b16 v[94:95], v19 offset:18944
    v_mfma_f32_32x32x16_bf16 v[192:207], v[96:99], v[56:59], v[192:207]
    ds_read_b64_tr_b16 v[96:97], v16 offset:20480
    ds_read_b64_tr_b16 v[98:99], v16 offset:20992
    v_mfma_f32_32x32x16_bf16 v[208:223], v[100:103], v[56:59], v[208:223]
    s_add_u32 m0, s81, 3072
    s_add_u32 s4, s89, 82944
    buffer_load_dwordx4 v26, s[44:47], s4 offen lds
    s_add_u32 s89, s89, 221184
    s_cmp_eq_u32 s89, 2211840
    s_cselect_b32 s89, 0, s89
    ds_read_b64_tr_b16 v[100:101], v17 offset:20480
    ds_read_b64_tr_b16 v[102:103], v17 offset:20992
    v_mfma_f32_32x32x16_bf16 v[224:239], v[104:107], v[56:59], v[224:239]
    ds_read_b64_tr_b16 v[104:105], v18 offset:20480
    ds_read_b64_tr_b16 v[106:107], v18 offset:20992
    v_mfma_f32_32x32x16_bf16 v[240:255], v[108:111], v[56:59], v[240:255]
    s_add_u32 m0, s80, 10240
    s_add_u32 s4, s88, 20480
    buffer_load_dwordx4 v24, s[40:43], s4 offen lds
    ds_read_b64_tr_b16 v[108:109], v19 offset:20480
    ds_read_b64_tr_b16 v[110:111], v19 offset:20992
    v_mfma_f32_32x32x16_bf16 v[192:207], v[112:115], v[60:63], v[192:207]
    ds_read_b64_tr_b16 v[112:113], v16 offset:22528
    ds_read_b64_tr_b16 v[114:115], v16 offset:23040
    v_mfma_f32_32x32x16_bf16 v[208:223], v[116:119], v[60:63], v[208:223]
    ds_read_b64_tr_b16 v[116:117], v17 offset:22528
    ds_read_b64_tr_b16 v[118:119], v17 offset:23040
    v_mfma_f32_32x32x16_bf16 v[224:239], v[120:123], v[60:63], v[224:239]
    s_add_u32 m0, s80, 11264
    s_add_u32 s4, s88, 30720
    buffer_load_dwordx4 v25, s[40:43], s4 offen lds
    ds_read_b64_tr_b16 v[120:121], v18 offset:22528
    ds_read_b64_tr_b16 v[122:123], v18 offset:23040
    v_mfma_f32_32x32x16_bf16 v[240:255], v[124:127], v[60:63], v[240:255]
    ds_read_b64_tr_b16 v[124:125], v19 offset:22528
    ds_read_b64_tr_b16 v[126:127], v19 offset:23040
    s_waitcnt vmcnt(8) lgkmcnt(12)
    v_mfma_f32_32x32x16_bf16 v[128:143], v[64:67], v[32:35], v[128:143]
    ds_read_b128 v[48:51], v20 offset:4096
    v_mfma_f32_32x32x16_bf16 v[144:159], v[68:71], v[32:35], v[144:159]
    s_add_u32 m0, s80, 0
    s_add_u32 s4, s88, 40960
    buffer_load_dwordx4 v24, s[40:43], s4 offen lds
    ds_read_b128 v[52:55], v21 offset:4096
    v_mfma_f32_16x16x32_bf16 v[8:11], v[64:67], v[4:7], v[8:11]
    v_mfma_f32_32x32x16_bf16 v[160:175], v[72:75], v[32:35], v[160:175]
    ds_read_b128 v[56:59], v22 offset:4096
    v_mfma_f32_32x32x16_bf16 v[176:191], v[76:79], v[32:35], v[176:191]
    ds_read_b128 v[60:63], v23 offset:4096
    v_mfma_f32_32x32x16_bf16 v[128:143], v[80:83], v[36:39], v[128:143]
    s_add_u32 m0, s80, 1024
    s_add_u32 s4, s88, 51200
    buffer_load_dwordx4 v25, s[40:43], s4 offen lds
    v_mfma_f32_32x32x16_bf16 v[144:159], v[84:87], v[36:39], v[144:159]
    v_mfma_f32_16x16x32_bf16 v[8:11], v[80:83], v[4:7], v[8:11]
    v_mfma_f32_32x32x16_bf16 v[160:175], v[88:91], v[36:39], v[160:175]
    v_mfma_f32_32x32x16_bf16 v[176:191], v[92:95], v[36:39], v[176:191]
    s_add_u32 m0, s80, 2048
    s_add_u32 s4, s88, 61440
    buffer_load_dwordx4 v24, s[40:43], s4 offen lds
    s_waitcnt lgkmcnt(4)
    v_mfma_f32_32x32x16_bf16 v[128:143], v[96:99], v[40:43], v[128:143]
    v_mfma_f32_32x32x16_bf16 v[144:159], v[100:103], v[40:43], v[144:159]
    v_mfma_f32_16x16x32_bf16 v[8:11], v[96:99], v[4:7], v[8:11]
    v_mfma_f32_32x32x16_bf16 v[160:175], v[104:107], v[40:43], v[160:175]
    s_add_u32 m0, s80, 3072
    s_add_u32 s4, s88, 71680
    buffer_load_dwordx4 v25, s[40:43], s4 offen lds
    s_add_u32 s88, s88, 128
    s_cmp_eq_u32 s88, 1280
    s_cselect_b32 s88, 0, s88
    v_mfma_f32_32x32x16_bf16 v[176:191], v[108:111], v[40:43], v[176:191]
    s_waitcnt lgkmcnt(0)
    v_mfma_f32_32x32x16_bf16 v[128:143], v[112:115], v[44:47], v[128:143]
    s_add_u32 m0, s80, 4096
    s_add_u32 s4, s88, 0
    buffer_load_dwordx4 v24, s[40:43], s4 offen lds
    v_mfma_f32_32x32x16_bf16 v[144:159], v[116:119], v[44:47], v[144:159]
    v_mfma_f32_16x16x32_bf16 v[8:11], v[112:115], v[4:7], v[8:11]
    v_mfma_f32_32x32x16_bf16 v[160:175], v[120:123], v[44:47], v[160:175]
    s_add_u32 m0, s80, 5120
    s_add_u32 s4, s88, 10240
    buffer_load_dwordx4 v25, s[40:43], s4 offen lds
    v_mfma_f32_32x32x16_bf16 v[176:191], v[124:127], v[44:47], v[176:191]
    s_waitcnt vmcnt(6)
    s_barrier
    v_mfma_f32_32x32x16_bf16 v[192:207], v[64:67], v[48:51], v[192:207]
    ds_read_b128 v[32:35], v20 offset:8192
    ds_read_b64_tr_b16 v[64:65], v16 offset:0
    ds_read_b64_tr_b16 v[66:67], v16 offset:512
    v_mfma_f32_32x32x16_bf16 v[208:223], v[68:71], v[48:51], v[208:223]
    s_add_u32 m0, s81, 16384
    s_add_u32 s4, s89, 0
    buffer_load_dwordx4 v26, s[44:47], s4 offen lds
    ds_read_b128 v[36:39], v21 offset:8192
    ds_read_b64_tr_b16 v[68:69], v17 offset:0
    ds_read_b64_tr_b16 v[70:71], v17 offset:512
    v_mfma_f32_32x32x16_bf16 v[224:239], v[72:75], v[48:51], v[224:239]
    ds_read_b128 v[40:43], v22 offset:8192
    ds_read_b64_tr_b16 v[72:73], v18 offset:0
    ds_read_b64_tr_b16 v[74:75], v18 offset:512
    v_mfma_f32_32x32x16_bf16 v[240:255], v[76:79], v[48:51], v[240:255]
    s_add_u32 m0, s81, 17408
    s_add_u32 s4, s89, 27648
    buffer_load_dwordx4 v26, s[44:47], s4 offen lds
    ds_read_b128 v[44:47], v23 offset:8192
    ds_read_b64_tr_b16 v[76:77], v19 offset:0
    ds_read_b64_tr_b16 v[78:79], v19 offset:512
    v_mfma_f32_32x32x16_bf16 v[192:207], v[80:83], v[52:55], v[192:207]
    ds_read_b64_tr_b16 v[80:81], v16 offset:2048
    ds_read_b64_tr_b16 v[82:83], v16 offset:2560
    v_mfma_f32_32x32x16_bf16 v[208:223], v[84:87], v[52:55], v[208:223]
    ds_read_b64_tr_b16 v[84:85], v17 offset:2048
    ds_read_b64_tr_b16 v[86:87], v17 offset:2560
    v_mfma_f32_32x32x16_bf16 v[224:239], v[88:91], v[52:55], v[224:239]
    s_add_u32 m0, s81, 18432
    s_add_u32 s4, s89, 55296
    buffer_load_dwordx4 v26, s[44:47], s4 offen lds
    ds_read_b64_tr_b16 v[88:89], v18 offset:2048
    ds_read_b64_tr_b16 v[90:91], v18 offset:2560
    v_mfma_f32_32x32x16_bf16 v[240:255], v[92:95], v[52:55], v[240:255]
    ds_read_b64_tr_b16 v[92:93], v19 offset:2048
    ds_read_b64_tr_b16 v[94:95], v19 offset:2560
    v_mfma_f32_32x32x16_bf16 v[192:207], v[96:99], v[56:59], v[192:207]
    ds_read_b64_tr_b16 v[96:97], v16 offset:4096
    ds_read_b64_tr_b16 v[98:99], v16 offset:4608
    v_mfma_f32_32x32x16_bf16 v[208:223], v[100:103], v[56:59], v[208:223]
    s_add_u32 m0, s81, 19456
    s_add_u32 s4, s89, 82944
    buffer_load_dwordx4 v26, s[44:47], s4 offen lds
    s_add_u32 s89, s89, 221184
    s_cmp_eq_u32 s89, 2211840
    s_cselect_b32 s89, 0, s89
    ds_read_b64_tr_b16 v[100:101], v17 offset:4096
    ds_read_b64_tr_b16 v[102:103], v17 offset:4608
    v_mfma_f32_32x32x16_bf16 v[224:239], v[104:107], v[56:59], v[224:239]
    ds_read_b64_tr_b16 v[104:105], v18 offset:4096
    ds_read_b64_tr_b16 v[106:107], v18 offset:4608
    v_mfma_f32_32x32x16_bf16 v[240:255], v[108:111], v[56:59], v[240:255]
    s_add_u32 m0, s80, 6144
    s_add_u32 s4, s88, 20480
    buffer_load_dwordx4 v24, s[40:43], s4 offen lds
    ds_read_b64_tr_b16 v[108:109], v19 offset:4096
    ds_read_b64_tr_b16 v[110:111], v19 offset:4608
    v_mfma_f32_32x32x16_bf16 v[192:207], v[112:115], v[60:63], v[192:207]
    ds_read_b64_tr_b16 v[112:113], v16 offset:6144
    ds_read_b64_tr_b16 v[114:115], v16 offset:6656
    v_mfma_f32_32x32x16_bf16 v[208:223], v[116:119], v[60:63], v[208:223]
    ds_read_b64_tr_b16 v[116:117], v17 offset:6144
    ds_read_b64_tr_b16 v[118:119], v17 offset:6656
    v_mfma_f32_32x32x16_bf16 v[224:239], v[120:123], v[60:63], v[224:239]
    s_add_u32 m0, s80, 7168
    s_add_u32 s4, s88, 30720
    buffer_load_dwordx4 v25, s[40:43], s4 offen lds
    ds_read_b64_tr_b16 v[120:121], v18 offset:6144
    ds_read_b64_tr_b16 v[122:123], v18 offset:6656
    v_mfma_f32_32x32x16_bf16 v[240:255], v[124:127], v[60:63], v[240:255]
    ds_read_b64_tr_b16 v[124:125], v19 offset:6144
    ds_read_b64_tr_b16 v[126:127], v19 offset:6656
    s_waitcnt vmcnt(8) lgkmcnt(12)
    v_mfma_f32_32x32x16_bf16 v[128:143], v[64:67], v[32:35], v[128:143]
    ds_read_b128 v[48:51], v20 offset:0
    v_mfma_f32_32x32x16_bf16 v[144:159], v[68:71], v[32:35], v[144:159]
    s_add_u32 m0, s80, 8192
    s_add_u32 s4, s88, 40960
    buffer_load_dwordx4 v24, s[40:43], s4 offen lds
    ds_read_b128 v[52:55], v21 offset:0
    v_mfma_f32_16x16x32_bf16 v[8:11], v[64:67], v[4:7], v[8:11]
    v_mfma_f32_32x32x16_bf16 v[160:175], v[72:75], v[32:35], v[160:175]
    ds_read_b128 v[56:59], v22 offset:0
    v_mfma_f32_32x32x16_bf16 v[176:191], v[76:79], v[32:35], v[176:191]
    ds_read_b128 v[60:63], v23 offset:0
    v_mfma_f32_32x32x16_bf16 v[128:143], v[80:83], v[36:39], v[128:143]
    s_add_u32 m0, s80, 9216
    s_add_u32 s4, s88, 51200
    buffer_load_dwordx4 v25, s[40:43], s4 offen lds
    v_mfma_f32_32x32x16_bf16 v[144:159], v[84:87], v[36:39], v[144:159]
    v_mfma_f32_16x16x32_bf16 v[8:11], v[80:83], v[4:7], v[8:11]
    v_mfma_f32_32x32x16_bf16 v[160:175], v[88:91], v[36:39], v[160:175]
    v_mfma_f32_32x32x16_bf16 v[176:191], v[92:95], v[36:39], v[176:191]
    s_add_u32 m0, s80, 10240
    s_add_u32 s4, s88, 61440
    buffer_load_dwordx4 v24, s[40:43], s4 offen lds
    s_waitcnt lgkmcnt(4)
    v_mfma_f32_32x32x16_bf16 v[128:143], v[96:99], v[40:43], v[128:143]
    v_mfma_f32_32x32x16_bf16 v[144:159], v[100:103], v[40:43], v[144:159]
    v_mfma_f32_16x16x32_bf16 v[8:11], v[96:99], v[4:7], v[8:11]
    v_mfma_f32_32x32x16_bf16 v[160:175], v[104:107], v[40:43], v[160:175]
    s_add_u32 m0, s80, 11264
    s_add_u32 s4, s88, 71680
    buffer_load_dwordx4 v25, s[40:43], s4 offen lds
    s_add_u32 s88, s88, 128
    s_cmp_eq_u32 s88, 1280
    s_cselect_b32 s88, 0, s88
    v_mfma_f32_32x32x16_bf16 v[176:191], v[108:111], v[40:43], v[176:191]
    s_waitcnt lgkmcnt(0)
    v_mfma_f32_32x32x16_bf16 v[128:143], v[112:115], v[44:47], v[128:143]
    s_add_u32 m0, s80, 0
    s_add_u32 s4, s88, 0
    buffer_load_dwordx4 v24, s[40:43], s4 offen lds
    v_mfma_f32_32x32x16_bf16 v[144:159], v[116:119], v[44:47], v[144:159]
    v_mfma_f32_16x16x32_bf16 v[8:11], v[112:115], v[4:7], v[8:11]
    v_mfma_f32_32x32x16_bf16 v[160:175], v[120:123], v[44:47], v[160:175]
    s_add_u32 m0, s80, 1024
    s_add_u32 s4, s88, 10240
    buffer_load_dwordx4 v25, s[40:43], s4 offen lds
    v_mfma_f32_32x32x16_bf16 v[176:191], v[124:127], v[44:47], v[176:191]
    s_waitcnt vmcnt(6)
    s_barrier
    v_mfma_f32_32x32x16_bf16 v[192:207], v[64:67], v[48:51], v[192:207]
    ds_read_b128 v[32:35], v20 offset:4096
    ds_read_b64_tr_b16 v[64:65], v16 offset:16384
    ds_read_b64_tr_b16 v[66:67], v16 offset:16896
    v_mfma_f32_32x32x16_bf16 v[208:223], v[68:71], v[48:51], v[208:223]
    s_add_u32 m0, s81, 0
    s_add_u32 s4, s89, 0
    buffer_load_dwordx4 v26, s[44:47], s4 offen lds
    ds_read_b128 v[36:39], v21 offset:4096
    ds_read_b64_tr_b16 v[68:69], v17 offset:16384
    ds_read_b64_tr_b16 v[70:71], v17 offset:16896
    v_mfma_f32_32x32x16_bf16 v[224:239], v[72:75], v[48:51], v[224:239]
    ds_read_b128 v[40:43], v22 offset:4096
    ds_read_b64_tr_b16 v[72:73], v18 offset:16384
    ds_read_b64_tr_b16 v[74:75], v18 offset:16896
    v_mfma_f32_32x32x16_bf16 v[240:255], v[76:79], v[48:51], v[240:255]
    s_add_u32 m0, s81, 1024
    s_add_u32 s4, s89, 27648
    buffer_load_dwordx4 v26, s[44:47], s4 offen lds
    ds_read_b128 v[44:47], v23 offset:4096
    ds_read_b64_tr_b16 v[76:77], v19 offset:16384
    ds_read_b64_tr_b16 v[78:79], v19 offset:16896
    v_mfma_f32_32x32x16_bf16 v[192:207], v[80:83], v[52:55], v[192:207]
    ds_read_b64_tr_b16 v[80:81], v16 offset:18432
    ds_read_b64_tr_b16 v[82:83], v16 offset:18944
    v_mfma_f32_32x32x16_bf16 v[208:223], v[84:87], v[52:55], v[208:223]
    ds_read_b64_tr_b16 v[84:85], v17 offset:18432
    ds_read_b64_tr_b16 v[86:87], v17 offset:18944
    v_mfma_f32_32x32x16_bf16 v[224:239], v[88:91], v[52:55], v[224:239]
    s_add_u32 m0, s81, 2048
    s_add_u32 s4, s89, 55296
    buffer_load_dwordx4 v26, s[44:47], s4 offen lds
    ds_read_b64_tr_b16 v[88:89], v18 offset:18432
    ds_read_b64_tr_b16 v[90:91], v18 offset:18944
    v_mfma_f32_32x32x16_bf16 v[240:255], v[92:95], v[52:55], v[240:255]
    ds_read_b64_tr_b16 v[92:93], v19 offset:18432
    ds_read_b64_tr_b16 v[94:95], v19 offset:18944
    v_mfma_f32_32x32x16_bf16 v[192:207], v[96:99], v[56:59], v[192:207]
    ds_read_b64_tr_b16 v[96:97], v16 offset:20480
    ds_read_b64_tr_b16 v[98:99], v16 offset:20992
    v_mfma_f32_32x32x16_bf16 v[208:223], v[100:103], v[56:59], v[208:223]
    s_add_u32 m0, s81, 3072
    s_add_u32 s4, s89, 82944
    buffer_load_dwordx4 v26, s[44:47], s4 offen lds
    s_add_u32 s89, s89, 221184
    s_cmp_eq_u32 s89, 2211840
    s_cselect_b32 s89, 0, s89
    ds_read_b64_tr_b16 v[100:101], v17 offset:20480
    ds_read_b64_tr_b16 v[102:103], v17 offset:20992
    v_mfma_f32_32x32x16_bf16 v[224:239], v[104:107], v[56:59], v[224:239]
    ds_read_b64_tr_b16 v[104:105], v18 offset:20480
    ds_read_b64_tr_b16 v[106:107], v18 offset:20992
    v_mfma_f32_32x32x16_bf16 v[240:255], v[108:111], v[56:59], v[240:255]
    s_add_u32 m0, s80, 2048
    s_add_u32 s4, s88, 20480
    buffer_load_dwordx4 v24, s[40:43], s4 offen lds
    ds_read_b64_tr_b16 v[108:109], v19 offset:20480
    ds_read_b64_tr_b16 v[110:111], v19 offset:20992
    v_mfma_f32_32x32x16_bf16 v[192:207], v[112:115], v[60:63], v[192:207]
    ds_read_b64_tr_b16 v[112:113], v16 offset:22528
    ds_read_b64_tr_b16 v[114:115], v16 offset:23040
    v_mfma_f32_32x32x16_bf16 v[208:223], v[116:119], v[60:63], v[208:223]
    ds_read_b64_tr_b16 v[116:117], v17 offset:22528
    ds_read_b64_tr_b16 v[118:119], v17 offset:23040
    v_mfma_f32_32x32x16_bf16 v[224:239], v[120:123], v[60:63], v[224:239]
    s_add_u32 m0, s80, 3072
    s_add_u32 s4, s88, 30720
    buffer_load_dwordx4 v25, s[40:43], s4 offen lds
    ds_read_b64_tr_b16 v[120:121], v18 offset:22528
    ds_read_b64_tr_b16 v[122:123], v18 offset:23040
    v_mfma_f32_32x32x16_bf16 v[240:255], v[124:127], v[60:63], v[240:255]
    ds_read_b64_tr_b16 v[124:125], v19 offset:22528
    ds_read_b64_tr_b16 v[126:127], v19 offset:23040
    s_waitcnt vmcnt(8) lgkmcnt(12)
    v_mfma_f32_32x32x16_bf16 v[128:143], v[64:67], v[32:35], v[128:143]
    ds_read_b128 v[48:51], v20 offset:8192
    v_mfma_f32_32x32x16_bf16 v[144:159], v[68:71], v[32:35], v[144:159]
    s_add_u32 m0, s80, 4096
    s_add_u32 s4, s88, 40960
    buffer_load_dwordx4 v24, s[40:43], s4 offen lds
    ds_read_b128 v[52:55], v21 offset:8192
    v_mfma_f32_16x16x32_bf16 v[8:11], v[64:67], v[4:7], v[8:11]
    v_mfma_f32_32x32x16_bf16 v[160:175], v[72:75], v[32:35], v[160:175]
    ds_read_b128 v[56:59], v22 offset:8192
    v_mfma_f32_32x32x16_bf16 v[176:191], v[76:79], v[32:35], v[176:191]
    ds_read_b128 v[60:63], v23 offset:8192
    v_mfma_f32_32x32x16_bf16 v[128:143], v[80:83], v[36:39], v[128:143]
    s_add_u32 m0, s80, 5120
    s_add_u32 s4, s88, 51200
    buffer_load_dwordx4 v25, s[40:43], s4 offen lds
    v_mfma_f32_32x32x16_bf16 v[144:159], v[84:87], v[36:39], v[144:159]
    v_mfma_f32_16x16x32_bf16 v[8:11], v[80:83], v[4:7], v[8:11]
    v_mfma_f32_32x32x16_bf16 v[160:175], v[88:91], v[36:39], v[160:175]
    v_mfma_f32_32x32x16_bf16 v[176:191], v[92:95], v[36:39], v[176:191]
    s_add_u32 m0, s80, 6144
    s_add_u32 s4, s88, 61440
    buffer_load_dwordx4 v24, s[40:43], s4 offen lds
    s_waitcnt lgkmcnt(4)
    v_mfma_f32_32x32x16_bf16 v[128:143], v[96:99], v[40:43], v[128:143]
    v_mfma_f32_32x32x16_bf16 v[144:159], v[100:103], v[40:43], v[144:159]
    v_mfma_f32_16x16x32_bf16 v[8:11], v[96:99], v[4:7], v[8:11]
    v_mfma_f32_32x32x16_bf16 v[160:175], v[104:107], v[40:43], v[160:175]
    s_add_u32 m0, s80, 7168
    s_add_u32 s4, s88, 71680
    buffer_load_dwordx4 v25, s[40:43], s4 offen lds
    s_add_u32 s88, s88, 128
    s_cmp_eq_u32 s88, 1280
    s_cselect_b32 s88, 0, s88
    v_mfma_f32_32x32x16_bf16 v[176:191], v[108:111], v[40:43], v[176:191]
    s_waitcnt lgkmcnt(0)
    v_mfma_f32_32x32x16_bf16 v[128:143], v[112:115], v[44:47], v[128:143]
    s_add_u32 m0, s80, 8192
    s_add_u32 s4, s88, 0
    buffer_load_dwordx4 v24, s[40:43], s4 offen lds
    v_mfma_f32_32x32x16_bf16 v[144:159], v[116:119], v[44:47], v[144:159]
    v_mfma_f32_16x16x32_bf16 v[8:11], v[112:115], v[4:7], v[8:11]
    v_mfma_f32_32x32x16_bf16 v[160:175], v[120:123], v[44:47], v[160:175]
    s_add_u32 m0, s80, 9216
    s_add_u32 s4, s88, 10240
    buffer_load_dwordx4 v25, s[40:43], s4 offen lds
    v_mfma_f32_32x32x16_bf16 v[176:191], v[124:127], v[44:47], v[176:191]
    s_waitcnt vmcnt(6)
    s_barrier
    v_mfma_f32_32x32x16_bf16 v[192:207], v[64:67], v[48:51], v[192:207]
    ds_read_b128 v[32:35], v20 offset:0
    ds_read_b64_tr_b16 v[64:65], v16 offset:0
    ds_read_b64_tr_b16 v[66:67], v16 offset:512
    v_mfma_f32_32x32x16_bf16 v[208:223], v[68:71], v[48:51], v[208:223]
    s_add_u32 m0, s81, 16384
    s_add_u32 s4, s89, 0
    buffer_load_dwordx4 v26, s[44:47], s4 offen lds
    ds_read_b128 v[36:39], v21 offset:0
    ds_read_b64_tr_b16 v[68:69], v17 offset:0
    ds_read_b64_tr_b16 v[70:71], v17 offset:512
    v_mfma_f32_32x32x16_bf16 v[224:239], v[72:75], v[48:51], v[224:239]
    ds_read_b128 v[40:43], v22 offset:0
    ds_read_b64_tr_b16 v[72:73], v18 offset:0
    ds_read_b64_tr_b16 v[74:75], v18 offset:512
    v_mfma_f32_32x32x16_bf16 v[240:255], v[76:79], v[48:51], v[240:255]
    s_add_u32 m0, s81, 17408
    s_add_u32 s4, s89, 27648
    buffer_load_dwordx4 v26, s[44:47], s4 offen lds
    ds_read_b128 v[44:47], v23 offset:0
    ds_read_b64_tr_b16 v[76:77], v19 offset:0
    ds_read_b64_tr_b16 v[78:79], v19 offset:512
    v_mfma_f32_32x32x16_bf16 v[192:207], v[80:83], v[52:55], v[192:207]
    ds_read_b64_tr_b16 v[80:81], v16 offset:2048
    ds_read_b64_tr_b16 v[82:83], v16 offset:2560
    v_mfma_f32_32x32x16_bf16 v[208:223], v[84:87], v[52:55], v[208:223]
    ds_read_b64_tr_b16 v[84:85], v17 offset:2048
    ds_read_b64_tr_b16 v[86:87], v17 offset:2560
    v_mfma_f32_32x32x16_bf16 v[224:239], v[88:91], v[52:55], v[224:239]
    s_add_u32 m0, s81, 18432
    s_add_u32 s4, s89, 55296
    buffer_load_dwordx4 v26, s[44:47], s4 offen lds
    ds_read_b64_tr_b16 v[88:89], v18 offset:2048
    ds_read_b64_tr_b16 v[90:91], v18 offset:2560
    v_mfma_f32_32x32x16_bf16 v[240:255], v[92:95], v[52:55], v[240:255]
    ds_read_b64_tr_b16 v[92:93], v19 offset:2048
    ds_read_b64_tr_b16 v[94:95], v19 offset:2560
    v_mfma_f32_32x32x16_bf16 v[192:207], v[96:99], v[56:59], v[192:207]
    ds_read_b64_tr_b16 v[96:97], v16 offset:4096
    ds_read_b64_tr_b16 v[98:99], v16 offset:4608
    v_mfma_f32_32x32x16_bf16 v[208:223], v[100:103], v[56:59], v[208:223]
    s_add_u32 m0, s81, 19456
    s_add_u32 s4, s89, 82944
    buffer_load_dwordx4 v26, s[44:47], s4 offen lds
    s_add_u32 s89, s89, 221184
    s_cmp_eq_u32 s89, 2211840
    s_cselect_b32 s89, 0, s89
    ds_read_b64_tr_b16 v[100:101], v17 offset:4096
    ds_read_b64_tr_b16 v[102:103], v17 offset:4608
    v_mfma_f32_32x32x16_bf16 v[224:239], v[104:107], v[56:59], v[224:239]
    ds_read_b64_tr_b16 v[104:105], v18 offset:4096
    ds_read_b64_tr_b16 v[106:107], v18 offset:4608
    v_mfma_f32_32x32x16_bf16 v[240:255], v[108:111], v[56:59], v[240:255]
    s_add_u32 m0, s80, 10240
    s_add_u32 s4, s88, 20480
    buffer_load_dwordx4 v24, s[40:43], s4 offen lds
    ds_read_b64_tr_b16 v[108:109], v19 offset:4096
    ds_read_b64_tr_b16 v[110:111], v19 offset:4608
    v_mfma_f32_32x32x16_bf16 v[192:207], v[112:115], v[60:63], v[192:207]
    ds_read_b64_tr_b16 v[112:113], v16 offset:6144
    ds_read_b64_tr_b16 v[114:115], v16 offset:6656
    v_mfma_f32_32x32x16_bf16 v[208:223], v[116:119], v[60:63], v[208:223]
    ds_read_b64_tr_b16 v[116:117], v17 offset:6144
    ds_read_b64_tr_b16 v[118:119], v17 offset:6656
    v_mfma_f32_32x32x16_bf16 v[224:239], v[120:123], v[60:63], v[224:239]
    s_add_u32 m0, s80, 11264
    s_add_u32 s4, s88, 30720
    buffer_load_dwordx4 v25, s[40:43], s4 offen lds
    ds_read_b64_tr_b16 v[120:121], v18 offset:6144
    ds_read_b64_tr_b16 v[122:123], v18 offset:6656
    v_mfma_f32_32x32x16_bf16 v[240:255], v[124:127], v[60:63], v[240:255]
    ds_read_b64_tr_b16 v[124:125], v19 offset:6144
    ds_read_b64_tr_b16 v[126:127], v19 offset:6656
    s_waitcnt vmcnt(8) lgkmcnt(12)
    v_mfma_f32_32x32x16_bf16 v[128:143], v[64:67], v[32:35], v[128:143]
    ds_read_b128 v[48:51], v20 offset:4096
    v_mfma_f32_32x32x16_bf16 v[144:159], v[68:71], v[32:35], v[144:159]
    s_add_u32 m0, s80, 0
    s_add_u32 s4, s88, 40960
    buffer_load_dwordx4 v24, s[40:43], s4 offen lds
    ds_read_b128 v[52:55], v21 offset:4096
    v_mfma_f32_16x16x32_bf16 v[8:11], v[64:67], v[4:7], v[8:11]
    v_mfma_f32_32x32x16_bf16 v[160:175], v[72:75], v[32:35], v[160:175]
    ds_read_b128 v[56:59], v22 offset:4096
    v_mfma_f32_32x32x16_bf16 v[176:191], v[76:79], v[32:35], v[176:191]
    ds_read_b128 v[60:63], v23 offset:4096
    v_mfma_f32_32x32x16_bf16 v[128:143], v[80:83], v[36:39], v[128:143]
    s_add_u32 m0, s80, 1024
    s_add_u32 s4, s88, 51200
    buffer_load_dwordx4 v25, s[40:43], s4 offen lds
    v_mfma_f32_32x32x16_bf16 v[144:159], v[84:87], v[36:39], v[144:159]
    v_mfma_f32_16x16x32_bf16 v[8:11], v[80:83], v[4:7], v[8:11]
    v_mfma_f32_32x32x16_bf16 v[160:175], v[88:91], v[36:39], v[160:175]
    v_mfma_f32_32x32x16_bf16 v[176:191], v[92:95], v[36:39], v[176:191]
    s_add_u32 m0, s80, 2048
    s_add_u32 s4, s88, 61440
    buffer_load_dwordx4 v24, s[40:43], s4 offen lds
    s_waitcnt lgkmcnt(4)
    v_mfma_f32_32x32x16_bf16 v[128:143], v[96:99], v[40:43], v[128:143]
    v_mfma_f32_32x32x16_bf16 v[144:159], v[100:103], v[40:43], v[144:159]
    v_mfma_f32_16x16x32_bf16 v[8:11], v[96:99], v[4:7], v[8:11]
    v_mfma_f32_32x32x16_bf16 v[160:175], v[104:107], v[40:43], v[160:175]
    s_add_u32 m0, s80, 3072
    s_add_u32 s4, s88, 71680
    buffer_load_dwordx4 v25, s[40:43], s4 offen lds
    s_add_u32 s88, s88, 128
    s_cmp_eq_u32 s88, 1280
    s_cselect_b32 s88, 0, s88
    v_mfma_f32_32x32x16_bf16 v[176:191], v[108:111], v[40:43], v[176:191]
    s_waitcnt lgkmcnt(0)
    v_mfma_f32_32x32x16_bf16 v[128:143], v[112:115], v[44:47], v[128:143]
    s_add_u32 m0, s80, 4096
    s_add_u32 s4, s88, 0
    buffer_load_dwordx4 v24, s[40:43], s4 offen lds
    v_mfma_f32_32x32x16_bf16 v[144:159], v[116:119], v[44:47], v[144:159]
    v_mfma_f32_16x16x32_bf16 v[8:11], v[112:115], v[4:7], v[8:11]
    v_mfma_f32_32x32x16_bf16 v[160:175], v[120:123], v[44:47], v[160:175]
    s_add_u32 m0, s80, 5120
    s_add_u32 s4, s88, 10240
    buffer_load_dwordx4 v25, s[40:43], s4 offen lds
    v_mfma_f32_32x32x16_bf16 v[176:191], v[124:127], v[44:47], v[176:191]
    s_waitcnt vmcnt(6)
    s_barrier
    v_mfma_f32_32x32x16_bf16 v[192:207], v[64:67], v[48:51], v[192:207]
    ds_read_b128 v[32:35], v20 offset:8192
    ds_read_b64_tr_b16 v[64:65], v16 offset:16384
    ds_read_b64_tr_b16 v[66:67], v16 offset:16896
    v_mfma_f32_32x32x16_bf16 v[208:223], v[68:71], v[48:51], v[208:223]
    s_add_u32 m0, s81, 0
    s_add_u32 s4, s89, 0
    buffer_load_dwordx4 v26, s[44:47], s4 offen lds
    ds_read_b128 v[36:39], v21 offset:8192
    ds_read_b64_tr_b16 v[68:69], v17 offset:16384
    ds_read_b64_tr_b16 v[70:71], v17 offset:16896
    v_mfma_f32_32x32x16_bf16 v[224:239], v[72:75], v[48:51], v[224:239]
    ds_read_b128 v[40:43], v22 offset:8192
    ds_read_b64_tr_b16 v[72:73], v18 offset:16384
    ds_read_b64_tr_b16 v[74:75], v18 offset:16896
    v_mfma_f32_32x32x16_bf16 v[240:255], v[76:79], v[48:51], v[240:255]
    s_add_u32 m0, s81, 1024
    s_add_u32 s4, s89, 27648
    buffer_load_dwordx4 v26, s[44:47], s4 offen lds
    ds_read_b128 v[44:47], v23 offset:8192
    ds_read_b64_tr_b16 v[76:77], v19 offset:16384
    ds_read_b64_tr_b16 v[78:79], v19 offset:16896
    v_mfma_f32_32x32x16_bf16 v[192:207], v[80:83], v[52:55], v[192:207]
    ds_read_b64_tr_b16 v[80:81], v16 offset:18432
    ds_read_b64_tr_b16 v[82:83], v16 offset:18944
    v_mfma_f32_32x32x16_bf16 v[208:223], v[84:87], v[52:55], v[208:223]
    ds_read_b64_tr_b16 v[84:85], v17 offset:18432
    ds_read_b64_tr_b16 v[86:87], v17 offset:18944
    v_mfma_f32_32x32x16_bf16 v[224:239], v[88:91], v[52:55], v[224:239]
    s_add_u32 m0, s81, 2048
    s_add_u32 s4, s89, 55296
    buffer_load_dwordx4 v26, s[44:47], s4 offen lds
    ds_read_b64_tr_b16 v[88:89], v18 offset:18432
    ds_read_b64_tr_b16 v[90:91], v18 offset:18944
    v_mfma_f32_32x32x16_bf16 v[240:255], v[92:95], v[52:55], v[240:255]
    ds_read_b64_tr_b16 v[92:93], v19 offset:18432
    ds_read_b64_tr_b16 v[94:95], v19 offset:18944
    v_mfma_f32_32x32x16_bf16 v[192:207], v[96:99], v[56:59], v[192:207]
    ds_read_b64_tr_b16 v[96:97], v16 offset:20480
    ds_read_b64_tr_b16 v[98:99], v16 offset:20992
    v_mfma_f32_32x32x16_bf16 v[208:223], v[100:103], v[56:59], v[208:223]
    s_add_u32 m0, s81, 3072
    s_add_u32 s4, s89, 82944
    buffer_load_dwordx4 v26, s[44:47], s4 offen lds
    s_add_u32 s89, s89, 221184
    s_cmp_eq_u32 s89, 2211840
    s_cselect_b32 s89, 0, s89
    ds_read_b64_tr_b16 v[100:101], v17 offset:20480
    ds_read_b64_tr_b16 v[102:103], v17 offset:20992
    v_mfma_f32_32x32x16_bf16 v[224:239], v[104:107], v[56:59], v[224:239]
    ds_read_b64_tr_b16 v[104:105], v18 offset:20480
    ds_read_b64_tr_b16 v[106:107], v18 offset:20992
    v_mfma_f32_32x32x16_bf16 v[240:255], v[108:111], v[56:59], v[240:255]
    s_add_u32 m0, s80, 6144
    s_add_u32 s4, s88, 20480
    buffer_load_dwordx4 v24, s[40:43], s4 offen lds
    ds_read_b64_tr_b16 v[108:109], v19 offset:20480
    ds_read_b64_tr_b16 v[110:111], v19 offset:20992
    v_mfma_f32_32x32x16_bf16 v[192:207], v[112:115], v[60:63], v[192:207]
    ds_read_b64_tr_b16 v[112:113], v16 offset:22528
    ds_read_b64_tr_b16 v[114:115], v16 offset:23040
    v_mfma_f32_32x32x16_bf16 v[208:223], v[116:119], v[60:63], v[208:223]
    ds_read_b64_tr_b16 v[116:117], v17 offset:22528
    ds_read_b64_tr_b16 v[118:119], v17 offset:23040
    v_mfma_f32_32x32x16_bf16 v[224:239], v[120:123], v[60:63], v[224:239]
    s_add_u32 m0, s80, 7168
    s_add_u32 s4, s88, 30720
    buffer_load_dwordx4 v25, s[40:43], s4 offen lds
    ds_read_b64_tr_b16 v[120:121], v18 offset:22528
    ds_read_b64_tr_b16 v[122:123], v18 offset:23040
    v_mfma_f32_32x32x16_bf16 v[240:255], v[124:127], v[60:63], v[240:255]
    ds_read_b64_tr_b16 v[124:125], v19 offset:22528
    ds_read_b64_tr_b16 v[126:127], v19 offset:23040
    s_waitcnt vmcnt(8) lgkmcnt(12)
    v_mfma_f32_32x32x16_bf16 v[128:143], v[64:67], v[32:35], v[128:143]
    ds_read_b128 v[48:51], v20 offset:0
    v_mfma_f32_32x32x16_bf16 v[144:159], v[68:71], v[32:35], v[144:159]
    s_add_u32 m0, s80, 8192
    s_add_u32 s4, s88, 40960
    buffer_load_dwordx4 v24, s[40:43], s4 offen lds
    ds_read_b128 v[52:55], v21 offset:0
    v_mfma_f32_16x16x32_bf16 v[8:11], v[64:67], v[4:7], v[8:11]
    v_mfma_f32_32x32x16_bf16 v[160:175], v[72:75], v[32:35], v[160:175]
    ds_read_b128 v[56:59], v22 offset:0
    v_mfma_f32_32x32x16_bf16 v[176:191], v[76:79], v[32:35], v[176:191]
    ds_read_b128 v[60:63], v23 offset:0
    v_mfma_f32_32x32x16_bf16 v[128:143], v[80:83], v[36:39], v[128:143]
    s_add_u32 m0, s80, 9216
    s_add_u32 s4, s88, 51200
    buffer_load_dwordx4 v25, s[40:43], s4 offen lds
    v_mfma_f32_32x32x16_bf16 v[144:159], v[84:87], v[36:39], v[144:159]
    v_mfma_f32_16x16x32_bf16 v[8:11], v[80:83], v[4:7], v[8:11]
    v_mfma_f32_32x32x16_bf16 v[160:175], v[88:91], v[36:39], v[160:175]
    v_mfma_f32_32x32x16_bf16 v[176:191], v[92:95], v[36:39], v[176:191]
    s_add_u32 m0, s80, 10240
    s_add_u32 s4, s88, 61440
    buffer_load_dwordx4 v24, s[40:43], s4 offen lds
    s_waitcnt lgkmcnt(4)
    v_mfma_f32_32x32x16_bf16 v[128:143], v[96:99], v[40:43], v[128:143]
    v_mfma_f32_32x32x16_bf16 v[144:159], v[100:103], v[40:43], v[144:159]
    v_mfma_f32_16x16x32_bf16 v[8:11], v[96:99], v[4:7], v[8:11]
    v_mfma_f32_32x32x16_bf16 v[160:175], v[104:107], v[40:43], v[160:175]
    s_add_u32 m0, s80, 11264
    s_add_u32 s4, s88, 71680
    buffer_load_dwordx4 v25, s[40:43], s4 offen lds
    s_add_u32 s88, s88, 128
    s_cmp_eq_u32 s88, 1280
    s_cselect_b32 s88, 0, s88
    v_mfma_f32_32x32x16_bf16 v[176:191], v[108:111], v[40:43], v[176:191]
    s_waitcnt lgkmcnt(0)
    v_mfma_f32_32x32x16_bf16 v[128:143], v[112:115], v[44:47], v[128:143]
    s_add_u32 m0, s80, 0
    s_add_u32 s4, s88, 0
    buffer_load_dwordx4 v24, s[40:43], s4 offen lds
    v_mfma_f32_32x32x16_bf16 v[144:159], v[116:119], v[44:47], v[144:159]
    v_mfma_f32_16x16x32_bf16 v[8:11], v[112:115], v[4:7], v[8:11]
    v_mfma_f32_32x32x16_bf16 v[160:175], v[120:123], v[44:47], v[160:175]
    s_add_u32 m0, s80, 1024
    s_add_u32 s4, s88, 10240
    buffer_load_dwordx4 v25, s[40:43], s4 offen lds
    v_mfma_f32_32x32x16_bf16 v[176:191], v[124:127], v[44:47], v[176:191]
    s_waitcnt vmcnt(6)
    s_barrier
    v_mfma_f32_32x32x16_bf16 v[192:207], v[64:67], v[48:51], v[192:207]
    ds_read_b128 v[32:35], v20 offset:4096
    ds_read_b64_tr_b16 v[64:65], v16 offset:0
    ds_read_b64_tr_b16 v[66:67], v16 offset:512
    v_mfma_f32_32x32x16_bf16 v[208:223], v[68:71], v[48:51], v[208:223]
    s_add_u32 m0, s81, 16384
    s_add_u32 s4, s89, 0
    buffer_load_dwordx4 v26, s[44:47], s4 offen lds
    ds_read_b128 v[36:39], v21 offset:4096
    ds_read_b64_tr_b16 v[68:69], v17 offset:0
    ds_read_b64_tr_b16 v[70:71], v17 offset:512
    v_mfma_f32_32x32x16_bf16 v[224:239], v[72:75], v[48:51], v[224:239]
    ds_read_b128 v[40:43], v22 offset:4096
    ds_read_b64_tr_b16 v[72:73], v18 offset:0
    ds_read_b64_tr_b16 v[74:75], v18 offset:512
    v_mfma_f32_32x32x16_bf16 v[240:255], v[76:79], v[48:51], v[240:255]
    s_add_u32 m0, s81, 17408
    s_add_u32 s4, s89, 27648
    buffer_load_dwordx4 v26, s[44:47], s4 offen lds
    ds_read_b128 v[44:47], v23 offset:4096
    ds_read_b64_tr_b16 v[76:77], v19 offset:0
    ds_read_b64_tr_b16 v[78:79], v19 offset:512
    v_mfma_f32_32x32x16_bf16 v[192:207], v[80:83], v[52:55], v[192:207]
    ds_read_b64_tr_b16 v[80:81], v16 offset:2048
    ds_read_b64_tr_b16 v[82:83], v16 offset:2560
    v_mfma_f32_32x32x16_bf16 v[208:223], v[84:87], v[52:55], v[208:223]
    buffer_load_dword v13, off, s[52:55], 0 offset:128 sc1
    ds_read_b64_tr_b16 v[84:85], v17 offset:2048
    ds_read_b64_tr_b16 v[86:87], v17 offset:2560
    v_mfma_f32_32x32x16_bf16 v[224:239], v[88:91], v[52:55], v[224:239]
    s_add_u32 m0, s81, 18432
    s_add_u32 s4, s89, 55296
    buffer_load_dwordx4 v26, s[44:47], s4 offen lds
    ds_read_b64_tr_b16 v[88:89], v18 offset:2048
    ds_read_b64_tr_b16 v[90:91], v18 offset:2560
    v_mfma_f32_32x32x16_bf16 v[240:255], v[92:95], v[52:55], v[240:255]
    ds_read_b64_tr_b16 v[92:93], v19 offset:2048
    ds_read_b64_tr_b16 v[94:95], v19 offset:2560
    v_mfma_f32_32x32x16_bf16 v[192:207], v[96:99], v[56:59], v[192:207]
    ds_read_b64_tr_b16 v[96:97], v16 offset:4096
    ds_read_b64_tr_b16 v[98:99], v16 offset:4608
    v_mfma_f32_32x32x16_bf16 v[208:223], v[100:103], v[56:59], v[208:223]
    s_add_u32 m0, s81, 19456
    s_add_u32 s4, s89, 82944
    buffer_load_dwordx4 v26, s[44:47], s4 offen lds
    s_add_u32 s89, s89, 221184
    s_cmp_eq_u32 s89, 2211840
    s_cselect_b32 s89, 0, s89
    ds_read_b64_tr_b16 v[100:101], v17 offset:4096
    ds_read_b64_tr_b16 v[102:103], v17 offset:4608
    v_mfma_f32_32x32x16_bf16 v[224:239], v[104:107], v[56:59], v[224:239]
    ds_read_b64_tr_b16 v[104:105], v18 offset:4096
    ds_read_b64_tr_b16 v[106:107], v18 offset:4608
    v_mfma_f32_32x32x16_bf16 v[240:255], v[108:111], v[56:59], v[240:255]
    s_add_u32 m0, s80, 2048
    s_add_u32 s4, s88, 20480
    buffer_load_dwordx4 v24, s[40:43], s4 offen lds
    ds_read_b64_tr_b16 v[108:109], v19 offset:4096
    ds_read_b64_tr_b16 v[110:111], v19 offset:4608
    v_mfma_f32_32x32x16_bf16 v[192:207], v[112:115], v[60:63], v[192:207]
    ds_read_b64_tr_b16 v[112:113], v16 offset:6144
    ds_read_b64_tr_b16 v[114:115], v16 offset:6656
    v_mfma_f32_32x32x16_bf16 v[208:223], v[116:119], v[60:63], v[208:223]
    ds_read_b64_tr_b16 v[116:117], v17 offset:6144
    ds_read_b64_tr_b16 v[118:119], v17 offset:6656
    v_mfma_f32_32x32x16_bf16 v[224:239], v[120:123], v[60:63], v[224:239]
    s_add_u32 m0, s80, 3072
    s_add_u32 s4, s88, 30720
    buffer_load_dwordx4 v25, s[40:43], s4 offen lds
    ds_read_b64_tr_b16 v[120:121], v18 offset:6144
    ds_read_b64_tr_b16 v[122:123], v18 offset:6656
    v_mfma_f32_32x32x16_bf16 v[240:255], v[124:127], v[60:63], v[240:255]
    ds_read_b64_tr_b16 v[124:125], v19 offset:6144
    ds_read_b64_tr_b16 v[126:127], v19 offset:6656
    s_waitcnt vmcnt(9) lgkmcnt(12)
    v_mfma_f32_32x32x16_bf16 v[128:143], v[64:67], v[32:35], v[128:143]
    ds_read_b128 v[48:51], v20 offset:8192
    v_mfma_f32_32x32x16_bf16 v[144:159], v[68:71], v[32:35], v[144:159]
    s_add_u32 m0, s80, 4096
    s_add_u32 s4, s88, 40960
    buffer_load_dwordx4 v24, s[40:43], s4 offen lds
    ds_read_b128 v[52:55], v21 offset:8192
    v_mfma_f32_16x16x32_bf16 v[8:11], v[64:67], v[4:7], v[8:11]
    v_mfma_f32_32x32x16_bf16 v[160:175], v[72:75], v[32:35], v[160:175]
    ds_read_b128 v[56:59], v22 offset:8192
    v_mfma_f32_32x32x16_bf16 v[176:191], v[76:79], v[32:35], v[176:191]
    ds_read_b128 v[60:63], v23 offset:8192
    v_mfma_f32_32x32x16_bf16 v[128:143], v[80:83], v[36:39], v[128:143]
    s_add_u32 m0, s80, 5120
    s_add_u32 s4, s88, 51200
    buffer_load_dwordx4 v25, s[40:43], s4 offen lds
    v_mfma_f32_32x32x16_bf16 v[144:159], v[84:87], v[36:39], v[144:159]
    v_mfma_f32_16x16x32_bf16 v[8:11], v[80:83], v[4:7], v[8:11]
    v_mfma_f32_32x32x16_bf16 v[160:175], v[88:91], v[36:39], v[160:175]
    v_mfma_f32_32x32x16_bf16 v[176:191], v[92:95], v[36:39], v[176:191]
    s_add_u32 m0, s80, 6144
    s_add_u32 s4, s88, 61440
    buffer_load_dwordx4 v24, s[40:43], s4 offen lds
    s_waitcnt lgkmcnt(4)
    v_mfma_f32_32x32x16_bf16 v[128:143], v[96:99], v[40:43], v[128:143]
    v_mfma_f32_32x32x16_bf16 v[144:159], v[100:103], v[40:43], v[144:159]
    v_mfma_f32_16x16x32_bf16 v[8:11], v[96:99], v[4:7], v[8:11]
    v_mfma_f32_32x32x16_bf16 v[160:175], v[104:107], v[40:43], v[160:175]
    s_add_u32 m0, s80, 7168
    s_add_u32 s4, s88, 71680
    buffer_load_dwordx4 v25, s[40:43], s4 offen lds
    s_add_u32 s88, s88, 128
    s_cmp_eq_u32 s88, 1280
    s_cselect_b32 s88, 0, s88
    v_mfma_f32_32x32x16_bf16 v[176:191], v[108:111], v[40:43], v[176:191]
    s_waitcnt lgkmcnt(0)
    v_mfma_f32_32x32x16_bf16 v[128:143], v[112:115], v[44:47], v[128:143]
    v_mfma_f32_32x32x16_bf16 v[144:159], v[116:119], v[44:47], v[144:159]
    v_mfma_f32_16x16x32_bf16 v[8:11], v[112:115], v[4:7], v[8:11]
    v_mfma_f32_32x32x16_bf16 v[160:175], v[120:123], v[44:47], v[160:175]
    v_mfma_f32_32x32x16_bf16 v[176:191], v[124:127], v[44:47], v[176:191]
    s_waitcnt vmcnt(4)
    s_barrier
    v_mfma_f32_32x32x16_bf16 v[192:207], v[64:67], v[48:51], v[192:207]
    ds_read_b128 v[32:35], v20 offset:0
    ds_read_b64_tr_b16 v[64:65], v16 offset:16384
    ds_read_b64_tr_b16 v[66:67], v16 offset:16896
    v_mfma_f32_32x32x16_bf16 v[208:223], v[68:71], v[48:51], v[208:223]
    ds_read_b128 v[36:39], v21 offset:0
    ds_read_b64_tr_b16 v[68:69], v17 offset:16384
    ds_read_b64_tr_b16 v[70:71], v17 offset:16896
    v_mfma_f32_32x32x16_bf16 v[224:239], v[72:75], v[48:51], v[224:239]
    ds_read_b128 v[40:43], v22 offset:0
    ds_read_b64_tr_b16 v[72:73], v18 offset:16384
    ds_read_b64_tr_b16 v[74:75], v18 offset:16896
    v_mfma_f32_32x32x16_bf16 v[240:255], v[76:79], v[48:51], v[240:255]
    ds_read_b128 v[44:47], v23 offset:0
    ds_read_b64_tr_b16 v[76:77], v19 offset:16384
    ds_read_b64_tr_b16 v[78:79], v19 offset:16896
    v_mfma_f32_32x32x16_bf16 v[192:207], v[80:83], v[52:55], v[192:207]
    ds_read_b64_tr_b16 v[80:81], v16 offset:18432
    ds_read_b64_tr_b16 v[82:83], v16 offset:18944
    v_mfma_f32_32x32x16_bf16 v[208:223], v[84:87], v[52:55], v[208:223]
    buffer_load_dwordx4 v[28:31], v27, s[48:51], s14 offen sc1
    ds_read_b64_tr_b16 v[84:85], v17 offset:18432
    ds_read_b64_tr_b16 v[86:87], v17 offset:18944
    v_mfma_f32_32x32x16_bf16 v[224:239], v[88:91], v[52:55], v[224:239]
    ds_read_b64_tr_b16 v[88:89], v18 offset:18432
    ds_read_b64_tr_b16 v[90:91], v18 offset:18944
    v_mfma_f32_32x32x16_bf16 v[240:255], v[92:95], v[52:55], v[240:255]
    ds_read_b64_tr_b16 v[92:93], v19 offset:18432
    ds_read_b64_tr_b16 v[94:95], v19 offset:18944
    v_mfma_f32_32x32x16_bf16 v[192:207], v[96:99], v[56:59], v[192:207]
    ds_read_b64_tr_b16 v[96:97], v16 offset:20480
    ds_read_b64_tr_b16 v[98:99], v16 offset:20992
    v_mfma_f32_32x32x16_bf16 v[208:223], v[100:103], v[56:59], v[208:223]
    ds_read_b64_tr_b16 v[100:101], v17 offset:20480
    ds_read_b64_tr_b16 v[102:103], v17 offset:20992
    v_mfma_f32_32x32x16_bf16 v[224:239], v[104:107], v[56:59], v[224:239]
    ds_read_b64_tr_b16 v[104:105], v18 offset:20480
    ds_read_b64_tr_b16 v[106:107], v18 offset:20992
    v_mfma_f32_32x32x16_bf16 v[240:255], v[108:111], v[56:59], v[240:255]
    ds_read_b64_tr_b16 v[108:109], v19 offset:20480
    ds_read_b64_tr_b16 v[110:111], v19 offset:20992
    v_mfma_f32_32x32x16_bf16 v[192:207], v[112:115], v[60:63], v[192:207]
    ds_read_b64_tr_b16 v[112:113], v16 offset:22528
    ds_read_b64_tr_b16 v[114:115], v16 offset:23040
    v_mfma_f32_32x32x16_bf16 v[208:223], v[116:119], v[60:63], v[208:223]
    ds_read_b64_tr_b16 v[116:117], v17 offset:22528
    ds_read_b64_tr_b16 v[118:119], v17 offset:23040
    v_mfma_f32_32x32x16_bf16 v[224:239], v[120:123], v[60:63], v[224:239]
    ds_read_b64_tr_b16 v[120:121], v18 offset:22528
    ds_read_b64_tr_b16 v[122:123], v18 offset:23040
    v_mfma_f32_32x32x16_bf16 v[240:255], v[124:127], v[60:63], v[240:255]
    ds_read_b64_tr_b16 v[124:125], v19 offset:22528
    ds_read_b64_tr_b16 v[126:127], v19 offset:23040
    s_waitcnt vmcnt(1) lgkmcnt(12)
    v_mfma_f32_32x32x16_bf16 v[128:143], v[64:67], v[32:35], v[128:143]
    ds_read_b128 v[48:51], v20 offset:4096
    v_mfma_f32_32x32x16_bf16 v[144:159], v[68:71], v[32:35], v[144:159]
    ds_read_b128 v[52:55], v21 offset:4096
    v_mfma_f32_16x16x32_bf16 v[8:11], v[64:67], v[4:7], v[8:11]
    v_mfma_f32_32x32x16_bf16 v[160:175], v[72:75], v[32:35], v[160:175]
    ds_read_b128 v[56:59], v22 offset:4096
    v_mfma_f32_32x32x16_bf16 v[176:191], v[76:79], v[32:35], v[176:191]
    buffer_load_dwordx4 v[24:27], v27, s[48:51], s14 offen offset:512 sc1
    ds_read_b128 v[60:63], v23 offset:4096
    v_mfma_f32_32x32x16_bf16 v[128:143], v[80:83], v[36:39], v[128:143]
    v_mfma_f32_32x32x16_bf16 v[144:159], v[84:87], v[36:39], v[144:159]
    s_mov_b32 s98, 0x98000
    s_mov_b32 s66, 0x7ff
    s_mov_b32 s67, 0
    s_mov_b64 exec, s[66:67]
    buffer_load_dword v12, v14, s[48:51], s98 offen sc1
    s_mov_b64 exec, -1
    v_mfma_f32_16x16x32_bf16 v[8:11], v[80:83], v[4:7], v[8:11]
    v_mfma_f32_32x32x16_bf16 v[160:175], v[88:91], v[36:39], v[160:175]
    v_mfma_f32_32x32x16_bf16 v[176:191], v[92:95], v[36:39], v[176:191]
    s_waitcnt lgkmcnt(4)
    v_mfma_f32_32x32x16_bf16 v[128:143], v[96:99], v[40:43], v[128:143]
    v_mfma_f32_32x32x16_bf16 v[144:159], v[100:103], v[40:43], v[144:159]
    v_mfma_f32_16x16x32_bf16 v[8:11], v[96:99], v[4:7], v[8:11]
    v_mfma_f32_32x32x16_bf16 v[160:175], v[104:107], v[40:43], v[160:175]
    v_mfma_f32_32x32x16_bf16 v[176:191], v[108:111], v[40:43], v[176:191]
    s_waitcnt lgkmcnt(0)
    v_mfma_f32_32x32x16_bf16 v[128:143], v[112:115], v[44:47], v[128:143]
    v_mfma_f32_32x32x16_bf16 v[144:159], v[116:119], v[44:47], v[144:159]
    v_mfma_f32_16x16x32_bf16 v[8:11], v[112:115], v[4:7], v[8:11]
    v_mfma_f32_32x32x16_bf16 v[160:175], v[120:123], v[44:47], v[160:175]
    v_mfma_f32_32x32x16_bf16 v[176:191], v[124:127], v[44:47], v[176:191]
    s_setprio 3
    s_lshl_b32 s4, s3, 7
    s_add_u32 s4, s4, 0
    v_and_b32 v2, 15, v0
    v_lshrrev_b32 v3, 4, v0
    v_cmp_gt_u32 vcc, 2, v2
    v_lshl_add_u32 v2, v2, 2, v3
    v_lshlrev_b32 v2, 4, v2
    v_add_u32 v2, s4, v2
    s_mov_b64 exec, vcc
    ds_write_b128 v2, v[8:11]
    s_mov_b64 exec, -1
    s_waitcnt vmcnt(0)
    s_mov_b32 s70, 40000
    v_readfirstlane_b32 s64, v13
    s_nop 0
    s_cmp_lg_u32 s64, 0
    s_cbranch_scc1 L_poll7_done
L_poll7:
    buffer_load_dword v13, off, s[52:55], 0 offset:128 sc1
    s_waitcnt vmcnt(0)
    v_readfirstlane_b32 s64, v13
    s_nop 0
    s_cmp_lg_u32 s64, 0
    s_cbranch_scc1 L_poll7_done
    s_sleep 4
    s_sub_u32 s70, s70, 1
    s_cmp_lg_u32 s70, 0
    s_cbranch_scc1 L_poll7
L_poll7_done:
    s_mov_b32 s70, 40000
L_g1_stats:
    v_cmp_eq_u32 s[6:7], s64, v29
    v_cmp_eq_u32 s[8:9], s64, v31
    v_cmp_eq_u32 s[10:11], s64, v25
    v_cmp_eq_u32 s[12:13], s64, v27
    s_and_b64 s[6:7], s[6:7], s[8:9]
    s_and_b64 s[10:11], s[10:11], s[12:13]
    s_and_b64 s[6:7], s[6:7], s[10:11]
    s_cmp_eq_u64 s[6:7], -1
    s_cbranch_scc1 L_g1_stats_done
    v_and_b32 v2, 31, v0
    v_lshlrev_b32 v2, 4, v2
    buffer_load_dwordx4 v[28:31], v2, s[48:51], s14 offen sc1
    buffer_load_dwordx4 v[24:27], v2, s[48:51], s14 offen offset:512 sc1
    s_waitcnt vmcnt(0)
    s_sleep 4
    s_sub_u32 s70, s70, 1
    s_cmp_lg_u32 s70, 0
    s_cbranch_scc1 L_g1_stats
L_g1_stats_done:
    v_rsq_f32 v29, v30
    v_rsq_f32 v25, v26
    v_lshrrev_b32 v3, 5, v0
    s_lshl_b32 s5, s3, 7
    v_lshl_add_u32 v3, v3, 4, s5
    s_lshr_b32 s5, s77, 5
    s_mul_i32 s5, s5, 108
    s_lshl_b32 s6, s79, 2
    s_add_u32 s5, s5, s6
    s_xor_b32 s8, s3, 0
    s_add_u32 s8, s8, s5
    s_lshl_b32 s8, s8, 10
    s_add_u32 s8, s8, 0x400000
    s_xor_b32 s9, s3, 1
    s_add_u32 s9, s9, s5
    s_lshl_b32 s9, s9, 10
    s_add_u32 s9, s9, 0x400000
    s_xor_b32 s10, s3, 2
    s_add_u32 s10, s10, s5
    s_lshl_b32 s10, s10, 10
    s_add_u32 s10, s10, 0x400000
    s_xor_b32 s11, s3, 3
    s_add_u32 s11, s11, s5
    s_lshl_b32 s11, s11, 10
    s_add_u32 s11, s11, 0x400000
    v_lshlrev_b32 v13, 4, v0
    s_waitcnt lgkmcnt(0)
    s_barrier
    v_xor_b32 v2, 0, v3
    ds_read_b128 v[32:35], v2 offset:0
    ds_read_b128 v[36:39], v2 offset:32
    ds_read_b128 v[40:43], v2 offset:64
    ds_read_b128 v[44:47], v2 offset:96
    v_mul_f32 v4, 0xc0135761, v29
    v_mul_f32 v6, v29, v29
    v_mul_f32 v6, v6, v4
    v_mul_f32 v6, 0x3d372713, v6
    v_mov_b32 v8, v30
    v_mov_b32 v9, v30
    v_mov_b32 v5, v4
    v_mov_b32 v7, v6
    v_mov_b32 v10, v28
    v_mov_b32 v11, v28
    s_waitcnt lgkmcnt(0)
    v_pk_fma_f32 v[128:129], v[32:33], v[10:11], v[128:129]
    v_pk_fma_f32 v[130:131], v[34:35], v[10:11], v[130:131]
    v_pk_fma_f32 v[132:133], v[36:37], v[10:11], v[132:133]
    v_pk_fma_f32 v[134:135], v[38:39], v[10:11], v[134:135]
    v_pk_fma_f32 v[136:137], v[40:41], v[10:11], v[136:137]
    v_pk_fma_f32 v[138:139], v[42:43], v[10:11], v[138:139]
    v_pk_fma_f32 v[140:141], v[44:45], v[10:11], v[140:141]
    v_pk_fma_f32 v[142:143], v[46:47], v[10:11], v[142:143]
    v_xor_b32 v2, 128, v3
    ds_read_b128 v[32:35], v2 offset:0
    ds_read_b128 v[36:39], v2 offset:32
    ds_read_b128 v[40:43], v2 offset:64
    ds_read_b128 v[44:47], v2 offset:96
    v_pk_mul_f32 v[16:17], v[128:129], v[128:129]
    v_pk_mul_f32 v[18:19], v[130:131], v[130:131]
    v_pk_mul_f32 v[20:21], v[132:133], v[132:133]
    v_pk_mul_f32 v[22:23], v[134:135], v[134:135]
    v_pk_fma_f32 v[16:17], v[16:17], v[6:7], v[4:5]
    v_pk_fma_f32 v[18:19], v[18:19], v[6:7], v[4:5]
    v_pk_fma_f32 v[20:21], v[20:21], v[6:7], v[4:5]
    v_pk_fma_f32 v[22:23], v[22:23], v[6:7], v[4:5]
    v_pk_mul_f32 v[16:17], v[16:17], v[128:129]
    v_pk_mul_f32 v[18:19], v[18:19], v[130:131]
    v_pk_mul_f32 v[20:21], v[20:21], v[132:133]
    v_pk_mul_f32 v[22:23], v[22:23], v[134:135]
    v_pk_mul_f32 v[128:129], v[128:129], v[136:137]
    v_pk_mul_f32 v[130:131], v[130:131], v[138:139]
    v_pk_mul_f32 v[132:133], v[132:133], v[140:141]
    v_pk_mul_f32 v[134:135], v[134:135], v[142:143]
    v_mfma_f32_32x32x16_bf16 v[192:207], v[64:67], v[48:51], v[192:207]
    v_exp_f32 v16, v16
    v_exp_f32 v17, v17
    v_exp_f32 v18, v18
    v_mfma_f32_32x32x16_bf16 v[208:223], v[68:71], v[48:51], v[208:223]
    v_exp_f32 v19, v19
    v_exp_f32 v20, v20
    v_exp_f32 v21, v21
    v_exp_f32 v22, v22
    v_exp_f32 v23, v23
    v_mfma_f32_32x32x16_bf16 v[224:239], v[72:75], v[48:51], v[224:239]
    v_fma_f32 v16, v16, v8, v8
    v_fma_f32 v17, v17, v8, v8
    v_rcp_f32 v16, v16
    v_fma_f32 v18, v18, v8, v8
    v_rcp_f32 v17, v17
    v_fma_f32 v19, v19, v8, v8
    v_rcp_f32 v18, v18
    v_mfma_f32_32x32x16_bf16 v[240:255], v[76:79], v[48:51], v[240:255]
    v_fma_f32 v20, v20, v8, v8
    v_rcp_f32 v19, v19
    v_fma_f32 v21, v21, v8, v8
    v_rcp_f32 v20, v20
    v_fma_f32 v22, v22, v8, v8
    v_rcp_f32 v21, v21
    v_fma_f32 v23, v23, v8, v8
    v_rcp_f32 v22, v22
    v_rcp_f32 v23, v23
    v_pk_mul_f32 v[128:129], v[128:129], v[16:17]
    v_pk_mul_f32 v[130:131], v[130:131], v[18:19]
    v_pk_mul_f32 v[132:133], v[132:133], v[20:21]
    v_pk_mul_f32 v[134:135], v[134:135], v[22:23]
    v_cvt_pk_bf16_f32 v136, v128, v129
    v_cvt_pk_bf16_f32 v137, v130, v131
    v_cvt_pk_bf16_f32 v138, v132, v133
    v_cvt_pk_bf16_f32 v139, v134, v135
    buffer_store_dwordx4 v[136:139], v13, s[48:51], s8 offen sc1
    s_add_u32 s8, s8, 110592
    s_waitcnt lgkmcnt(0)
    v_pk_fma_f32 v[144:145], v[32:33], v[10:11], v[144:145]
    v_pk_fma_f32 v[146:147], v[34:35], v[10:11], v[146:147]
    v_pk_fma_f32 v[148:149], v[36:37], v[10:11], v[148:149]
    v_pk_fma_f32 v[150:151], v[38:39], v[10:11], v[150:151]
    v_pk_fma_f32 v[152:153], v[40:41], v[10:11], v[152:153]
    v_pk_fma_f32 v[154:155], v[42:43], v[10:11], v[154:155]
    v_pk_fma_f32 v[156:157], v[44:45], v[10:11], v[156:157]
    v_pk_fma_f32 v[158:159], v[46:47], v[10:11], v[158:159]
    v_xor_b32 v2, 256, v3
    ds_read_b128 v[32:35], v2 offset:0
    ds_read_b128 v[36:39], v2 offset:32
    ds_read_b128 v[40:43], v2 offset:64
    ds_read_b128 v[44:47], v2 offset:96
    v_pk_mul_f32 v[16:17], v[144:145], v[144:145]
    v_pk_mul_f32 v[18:19], v[146:147], v[146:147]
    v_pk_mul_f32 v[20:21], v[148:149], v[148:149]
    v_pk_mul_f32 v[22:23], v[150:151], v[150:151]
    v_pk_fma_f32 v[16:17], v[16:17], v[6:7], v[4:5]
    v_pk_fma_f32 v[18:19], v[18:19], v[6:7], v[4:5]
    v_pk_fma_f32 v[20:21], v[20:21], v[6:7], v[4:5]
    v_pk_fma_f32 v[22:23], v[22:23], v[6:7], v[4:5]
    v_pk_mul_f32 v[16:17], v[16:17], v[144:145]
    v_pk_mul_f32 v[18:19], v[18:19], v[146:147]
    v_pk_mul_f32 v[20:21], v[20:21], v[148:149]
    v_pk_mul_f32 v[22:23], v[22:23], v[150:151]
    v_pk_mul_f32 v[144:145], v[144:145], v[152:153]
    v_pk_mul_f32 v[146:147], v[146:147], v[154:155]
    v_pk_mul_f32 v[148:149], v[148:149], v[156:157]
    v_pk_mul_f32 v[150:151], v[150:151], v[158:159]
    v_mfma_f32_32x32x16_bf16 v[192:207], v[80:83], v[52:55], v[192:207]
    v_exp_f32 v16, v16
    v_exp_f32 v17, v17
    v_exp_f32 v18, v18
    v_mfma_f32_32x32x16_bf16 v[208:223], v[84:87], v[52:55], v[208:223]
    v_exp_f32 v19, v19
    v_exp_f32 v20, v20
    v_exp_f32 v21, v21
    v_exp_f32 v22, v22
    v_exp_f32 v23, v23
    v_mfma_f32_32x32x16_bf16 v[224:239], v[88:91], v[52:55], v[224:239]
    v_fma_f32 v16, v16, v8, v8
    v_fma_f32 v17, v17, v8, v8
    v_rcp_f32 v16, v16
    v_fma_f32 v18, v18, v8, v8
    v_rcp_f32 v17, v17
    v_fma_f32 v19, v19, v8, v8
    v_rcp_f32 v18, v18
    v_mfma_f32_32x32x16_bf16 v[240:255], v[92:95], v[52:55], v[240:255]
    v_fma_f32 v20, v20, v8, v8
    v_rcp_f32 v19, v19
    v_fma_f32 v21, v21, v8, v8
    v_rcp_f32 v20, v20
    v_fma_f32 v22, v22, v8, v8
    v_rcp_f32 v21, v21
    v_fma_f32 v23, v23, v8, v8
    v_rcp_f32 v22, v22
    v_rcp_f32 v23, v23
    v_pk_mul_f32 v[144:145], v[144:145], v[16:17]
    v_pk_mul_f32 v[146:147], v[146:147], v[18:19]
    v_pk_mul_f32 v[148:149], v[148:149], v[20:21]
    v_pk_mul_f32 v[150:151], v[150:151], v[22:23]
    v_cvt_pk_bf16_f32 v152, v144, v145
    v_cvt_pk_bf16_f32 v153, v146, v147
    v_cvt_pk_bf16_f32 v154, v148, v149
    v_cvt_pk_bf16_f32 v155, v150, v151
    buffer_store_dwordx4 v[152:155], v13, s[48:51], s9 offen sc1
    s_add_u32 s9, s9, 110592
    s_waitcnt lgkmcnt(0)
    v_pk_fma_f32 v[160:161], v[32:33], v[10:11], v[160:161]
    v_pk_fma_f32 v[162:163], v[34:35], v[10:11], v[162:163]
    v_pk_fma_f32 v[164:165], v[36:37], v[10:11], v[164:165]
    v_pk_fma_f32 v[166:167], v[38:39], v[10:11], v[166:167]
    v_pk_fma_f32 v[168:169], v[40:41], v[10:11], v[168:169]
    v_pk_fma_f32 v[170:171], v[42:43], v[10:11], v[170:171]
    v_pk_fma_f32 v[172:173], v[44:45], v[10:11], v[172:173]
    v_pk_fma_f32 v[174:175], v[46:47], v[10:11], v[174:175]
    v_xor_b32 v2, 384, v3
    ds_read_b128 v[32:35], v2 offset:0
    ds_read_b128 v[36:39], v2 offset:32
    ds_read_b128 v[40:43], v2 offset:64
    ds_read_b128 v[44:47], v2 offset:96
    v_pk_mul_f32 v[16:17], v[160:161], v[160:161]
    v_pk_mul_f32 v[18:19], v[162:163], v[162:163]
    v_pk_mul_f32 v[20:21], v[164:165], v[164:165]
    v_pk_mul_f32 v[22:23], v[166:167], v[166:167]
    v_pk_fma_f32 v[16:17], v[16:17], v[6:7], v[4:5]
    v_pk_fma_f32 v[18:19], v[18:19], v[6:7], v[4:5]
    v_pk_fma_f32 v[20:21], v[20:21], v[6:7], v[4:5]
    v_pk_fma_f32 v[22:23], v[22:23], v[6:7], v[4:5]
    v_pk_mul_f32 v[16:17], v[16:17], v[160:161]
    v_pk_mul_f32 v[18:19], v[18:19], v[162:163]
    v_pk_mul_f32 v[20:21], v[20:21], v[164:165]
    v_pk_mul_f32 v[22:23], v[22:23], v[166:167]
    v_pk_mul_f32 v[160:161], v[160:161], v[168:169]
    v_pk_mul_f32 v[162:163], v[162:163], v[170:171]
    v_pk_mul_f32 v[164:165], v[164:165], v[172:173]
    v_pk_mul_f32 v[166:167], v[166:167], v[174:175]
    v_mfma_f32_32x32x16_bf16 v[192:207], v[96:99], v[56:59], v[192:207]
    v_exp_f32 v16, v16
    v_exp_f32 v17, v17
    v_exp_f32 v18, v18
    v_mfma_f32_32x32x16_bf16 v[208:223], v[100:103], v[56:59], v[208:223]
    v_exp_f32 v19, v19
    v_exp_f32 v20, v20
    v_exp_f32 v21, v21
    v_exp_f32 v22, v22
    v_exp_f32 v23, v23
    v_mfma_f32_32x32x16_bf16 v[224:239], v[104:107], v[56:59], v[224:239]
    v_fma_f32 v16, v16, v8, v8
    v_fma_f32 v17, v17, v8, v8
    v_rcp_f32 v16, v16
    v_fma_f32 v18, v18, v8, v8
    v_rcp_f32 v17, v17
    v_fma_f32 v19, v19, v8, v8
    v_rcp_f32 v18, v18
    v_mfma_f32_32x32x16_bf16 v[240:255], v[108:111], v[56:59], v[240:255]
    v_fma_f32 v20, v20, v8, v8
    v_rcp_f32 v19, v19
    v_fma_f32 v21, v21, v8, v8
    v_rcp_f32 v20, v20
    v_fma_f32 v22, v22, v8, v8
    v_rcp_f32 v21, v21
    v_fma_f32 v23, v23, v8, v8
    v_rcp_f32 v22, v22
    v_rcp_f32 v23, v23
    v_pk_mul_f32 v[160:161], v[160:161], v[16:17]
    v_pk_mul_f32 v[162:163], v[162:163], v[18:19]
    v_pk_mul_f32 v[164:165], v[164:165], v[20:21]
    v_pk_mul_f32 v[166:167], v[166:167], v[22:23]
    v_cvt_pk_bf16_f32 v168, v160, v161
    v_cvt_pk_bf16_f32 v169, v162, v163
    v_cvt_pk_bf16_f32 v170, v164, v165
    v_cvt_pk_bf16_f32 v171, v166, v167
    buffer_store_dwordx4 v[168:171], v13, s[48:51], s10 offen sc1
    s_add_u32 s10, s10, 110592
    s_waitcnt lgkmcnt(0)
    v_pk_fma_f32 v[176:177], v[32:33], v[10:11], v[176:177]
    v_pk_fma_f32 v[178:179], v[34:35], v[10:11], v[178:179]
    v_pk_fma_f32 v[180:181], v[36:37], v[10:11], v[180:181]
    v_pk_fma_f32 v[182:183], v[38:39], v[10:11], v[182:183]
    v_pk_fma_f32 v[184:185], v[40:41], v[10:11], v[184:185]
    v_pk_fma_f32 v[186:187], v[42:43], v[10:11], v[186:187]
    v_pk_fma_f32 v[188:189], v[44:45], v[10:11], v[188:189]
    v_pk_fma_f32 v[190:191], v[46:47], v[10:11], v[190:191]
    v_xor_b32 v2, 0, v3
    ds_read_b128 v[32:35], v2 offset:0
    ds_read_b128 v[36:39], v2 offset:32
    ds_read_b128 v[40:43], v2 offset:64
    ds_read_b128 v[44:47], v2 offset:96
    v_pk_mul_f32 v[16:17], v[176:177], v[176:177]
    v_pk_mul_f32 v[18:19], v[178:179], v[178:179]
    v_pk_mul_f32 v[20:21], v[180:181], v[180:181]
    v_pk_mul_f32 v[22:23], v[182:183], v[182:183]
    v_pk_fma_f32 v[16:17], v[16:17], v[6:7], v[4:5]
    v_pk_fma_f32 v[18:19], v[18:19], v[6:7], v[4:5]
    v_pk_fma_f32 v[20:21], v[20:21], v[6:7], v[4:5]
    v_pk_fma_f32 v[22:23], v[22:23], v[6:7], v[4:5]
    v_pk_mul_f32 v[16:17], v[16:17], v[176:177]
    v_pk_mul_f32 v[18:19], v[18:19], v[178:179]
    v_pk_mul_f32 v[20:21], v[20:21], v[180:181]
    v_pk_mul_f32 v[22:23], v[22:23], v[182:183]
    v_pk_mul_f32 v[176:177], v[176:177], v[184:185]
    v_pk_mul_f32 v[178:179], v[178:179], v[186:187]
    v_pk_mul_f32 v[180:181], v[180:181], v[188:189]
    v_pk_mul_f32 v[182:183], v[182:183], v[190:191]
    v_mfma_f32_32x32x16_bf16 v[192:207], v[112:115], v[60:63], v[192:207]
    v_exp_f32 v16, v16
    v_exp_f32 v17, v17
    v_exp_f32 v18, v18
    v_mfma_f32_32x32x16_bf16 v[208:223], v[116:119], v[60:63], v[208:223]
    v_exp_f32 v19, v19
    v_exp_f32 v20, v20
    v_exp_f32 v21, v21
    v_exp_f32 v22, v22
    v_exp_f32 v23, v23
    v_mfma_f32_32x32x16_bf16 v[224:239], v[120:123], v[60:63], v[224:239]
    v_fma_f32 v16, v16, v8, v8
    v_fma_f32 v17, v17, v8, v8
    v_rcp_f32 v16, v16
    v_fma_f32 v18, v18, v8, v8
    v_rcp_f32 v17, v17
    v_fma_f32 v19, v19, v8, v8
    v_rcp_f32 v18, v18
    v_mfma_f32_32x32x16_bf16 v[240:255], v[124:127], v[60:63], v[240:255]
    v_fma_f32 v20, v20, v8, v8
    v_rcp_f32 v19, v19
    v_fma_f32 v21, v21, v8, v8
    v_rcp_f32 v20, v20
    v_fma_f32 v22, v22, v8, v8
    v_rcp_f32 v21, v21
    v_fma_f32 v23, v23, v8, v8
    v_rcp_f32 v22, v22
    v_rcp_f32 v23, v23
    v_pk_mul_f32 v[176:177], v[176:177], v[16:17]
    v_pk_mul_f32 v[178:179], v[178:179], v[18:19]
    v_pk_mul_f32 v[180:181], v[180:181], v[20:21]
    v_pk_mul_f32 v[182:183], v[182:183], v[22:23]
    v_cvt_pk_bf16_f32 v184, v176, v177
    v_cvt_pk_bf16_f32 v185, v178, v179
    v_cvt_pk_bf16_f32 v186, v180, v181
    v_cvt_pk_bf16_f32 v187, v182, v183
    buffer_store_dwordx4 v[184:187], v13, s[48:51], s11 offen sc1
    s_add_u32 s11, s11, 110592
    v_mul_f32 v4, 0xc0135761, v25
    v_mul_f32 v6, v25, v25
    v_mul_f32 v6, v6, v4
    v_mul_f32 v6, 0x3d372713, v6
    v_mov_b32 v8, v26
    v_mov_b32 v9, v26
    v_mov_b32 v5, v4
    v_mov_b32 v7, v6
    v_mov_b32 v10, v24
    v_mov_b32 v11, v24
    s_waitcnt lgkmcnt(0)
    v_pk_fma_f32 v[192:193], v[32:33], v[10:11], v[192:193]
    v_pk_fma_f32 v[194:195], v[34:35], v[10:11], v[194:195]
    v_pk_fma_f32 v[196:197], v[36:37], v[10:11], v[196:197]
    v_pk_fma_f32 v[198:199], v[38:39], v[10:11], v[198:199]
    v_pk_fma_f32 v[200:201], v[40:41], v[10:11], v[200:201]
    v_pk_fma_f32 v[202:203], v[42:43], v[10:11], v[202:203]
    v_pk_fma_f32 v[204:205], v[44:45], v[10:11], v[204:205]
    v_pk_fma_f32 v[206:207], v[46:47], v[10:11], v[206:207]
    v_xor_b32 v2, 128, v3
    ds_read_b128 v[32:35], v2 offset:0
    ds_read_b128 v[36:39], v2 offset:32
    ds_read_b128 v[40:43], v2 offset:64
    ds_read_b128 v[44:47], v2 offset:96
    v_pk_mul_f32 v[16:17], v[192:193], v[192:193]
    v_pk_mul_f32 v[18:19], v[194:195], v[194:195]
    v_pk_mul_f32 v[20:21], v[196:197], v[196:197]
    v_pk_mul_f32 v[22:23], v[198:199], v[198:199]
    v_pk_fma_f32 v[16:17], v[16:17], v[6:7], v[4:5]
    v_pk_fma_f32 v[18:19], v[18:19], v[6:7], v[4:5]
    v_pk_fma_f32 v[20:21], v[20:21], v[6:7], v[4:5]
    v_pk_fma_f32 v[22:23], v[22:23], v[6:7], v[4:5]
    v_pk_mul_f32 v[16:17], v[16:17], v[192:193]
    v_pk_mul_f32 v[18:19], v[18:19], v[194:195]
    v_pk_mul_f32 v[20:21], v[20:21], v[196:197]
    v_pk_mul_f32 v[22:23], v[22:23], v[198:199]
    v_pk_mul_f32 v[192:193], v[192:193], v[200:201]
    v_pk_mul_f32 v[194:195], v[194:195], v[202:203]
    v_pk_mul_f32 v[196:197], v[196:197], v[204:205]
    v_pk_mul_f32 v[198:199], v[198:199], v[206:207]
    v_exp_f32 v16, v16
    v_exp_f32 v17, v17
    v_exp_f32 v18, v18
    v_exp_f32 v19, v19
    v_exp_f32 v20, v20
    v_exp_f32 v21, v21
    v_exp_f32 v22, v22
    v_exp_f32 v23, v23
    v_fma_f32 v16, v16, v8, v8
    v_fma_f32 v17, v17, v8, v8
    v_rcp_f32 v16, v16
    v_fma_f32 v18, v18, v8, v8
    v_rcp_f32 v17, v17
    v_fma_f32 v19, v19, v8, v8
    v_rcp_f32 v18, v18
    v_fma_f32 v20, v20, v8, v8
    v_rcp_f32 v19, v19
    v_fma_f32 v21, v21, v8, v8
    v_rcp_f32 v20, v20
    v_fma_f32 v22, v22, v8, v8
    v_rcp_f32 v21, v21
    v_fma_f32 v23, v23, v8, v8
    v_rcp_f32 v22, v22
    v_rcp_f32 v23, v23
    v_pk_mul_f32 v[192:193], v[192:193], v[16:17]
    v_pk_mul_f32 v[194:195], v[194:195], v[18:19]
    v_pk_mul_f32 v[196:197], v[196:197], v[20:21]
    v_pk_mul_f32 v[198:199], v[198:199], v[22:23]
    v_cvt_pk_bf16_f32 v200, v192, v193
    v_cvt_pk_bf16_f32 v201, v194, v195
    v_cvt_pk_bf16_f32 v202, v196, v197
    v_cvt_pk_bf16_f32 v203, v198, v199
    buffer_store_dwordx4 v[200:203], v13, s[48:51], s8 offen sc1
    s_waitcnt lgkmcnt(0)
    v_pk_fma_f32 v[208:209], v[32:33], v[10:11], v[208:209]
    v_pk_fma_f32 v[210:211], v[34:35], v[10:11], v[210:211]
    v_pk_fma_f32 v[212:213], v[36:37], v[10:11], v[212:213]
    v_pk_fma_f32 v[214:215], v[38:39], v[10:11], v[214:215]
    v_pk_fma_f32 v[216:217], v[40:41], v[10:11], v[216:217]
    v_pk_fma_f32 v[218:219], v[42:43], v[10:11], v[218:219]
    v_pk_fma_f32 v[220:221], v[44:45], v[10:11], v[220:221]
    v_pk_fma_f32 v[222:223], v[46:47], v[10:11], v[222:223]
    v_xor_b32 v2, 256, v3
    ds_read_b128 v[32:35], v2 offset:0
    ds_read_b128 v[36:39], v2 offset:32
    ds_read_b128 v[40:43], v2 offset:64
    ds_read_b128 v[44:47], v2 offset:96
    v_pk_mul_f32 v[16:17], v[208:209], v[208:209]
    v_pk_mul_f32 v[18:19], v[210:211], v[210:211]
    v_pk_mul_f32 v[20:21], v[212:213], v[212:213]
    v_pk_mul_f32 v[22:23], v[214:215], v[214:215]
    v_pk_fma_f32 v[16:17], v[16:17], v[6:7], v[4:5]
    v_pk_fma_f32 v[18:19], v[18:19], v[6:7], v[4:5]
    v_pk_fma_f32 v[20:21], v[20:21], v[6:7], v[4:5]
    v_pk_fma_f32 v[22:23], v[22:23], v[6:7], v[4:5]
    v_pk_mul_f32 v[16:17], v[16:17], v[208:209]
    v_pk_mul_f32 v[18:19], v[18:19], v[210:211]
    v_pk_mul_f32 v[20:21], v[20:21], v[212:213]
    v_pk_mul_f32 v[22:23], v[22:23], v[214:215]
    v_pk_mul_f32 v[208:209], v[208:209], v[216:217]
    v_pk_mul_f32 v[210:211], v[210:211], v[218:219]
    v_pk_mul_f32 v[212:213], v[212:213], v[220:221]
    v_pk_mul_f32 v[214:215], v[214:215], v[222:223]
    v_exp_f32 v16, v16
    v_exp_f32 v17, v17
    v_exp_f32 v18, v18
    v_exp_f32 v19, v19
    v_exp_f32 v20, v20
    v_exp_f32 v21, v21
    v_exp_f32 v22, v22
    v_exp_f32 v23, v23
    v_fma_f32 v16, v16, v8, v8
    v_fma_f32 v17, v17, v8, v8
    v_rcp_f32 v16, v16
    v_fma_f32 v18, v18, v8, v8
    v_rcp_f32 v17, v17
    v_fma_f32 v19, v19, v8, v8
    v_rcp_f32 v18, v18
    v_fma_f32 v20, v20, v8, v8
    v_rcp_f32 v19, v19
    v_fma_f32 v21, v21, v8, v8
    v_rcp_f32 v20, v20
    v_fma_f32 v22, v22, v8, v8
    v_rcp_f32 v21, v21
    v_fma_f32 v23, v23, v8, v8
    v_rcp_f32 v22, v22
    v_rcp_f32 v23, v23
    v_pk_mul_f32 v[208:209], v[208:209], v[16:17]
    v_pk_mul_f32 v[210:211], v[210:211], v[18:19]
    v_pk_mul_f32 v[212:213], v[212:213], v[20:21]
    v_pk_mul_f32 v[214:215], v[214:215], v[22:23]
    v_cvt_pk_bf16_f32 v216, v208, v209
    v_cvt_pk_bf16_f32 v217, v210, v211
    v_cvt_pk_bf16_f32 v218, v212, v213
    v_cvt_pk_bf16_f32 v219, v214, v215
    buffer_store_dwordx4 v[216:219], v13, s[48:51], s9 offen sc1
    s_waitcnt lgkmcnt(0)
    v_pk_fma_f32 v[224:225], v[32:33], v[10:11], v[224:225]
    v_pk_fma_f32 v[226:227], v[34:35], v[10:11], v[226:227]
    v_pk_fma_f32 v[228:229], v[36:37], v[10:11], v[228:229]
    v_pk_fma_f32 v[230:231], v[38:39], v[10:11], v[230:231]
    v_pk_fma_f32 v[232:233], v[40:41], v[10:11], v[232:233]
    v_pk_fma_f32 v[234:235], v[42:43], v[10:11], v[234:235]
    v_pk_fma_f32 v[236:237], v[44:45], v[10:11], v[236:237]
    v_pk_fma_f32 v[238:239], v[46:47], v[10:11], v[238:239]
    v_xor_b32 v2, 384, v3
    ds_read_b128 v[32:35], v2 offset:0
    ds_read_b128 v[36:39], v2 offset:32
    ds_read_b128 v[40:43], v2 offset:64
    ds_read_b128 v[44:47], v2 offset:96
    v_pk_mul_f32 v[16:17], v[224:225], v[224:225]
    v_pk_mul_f32 v[18:19], v[226:227], v[226:227]
    v_pk_mul_f32 v[20:21], v[228:229], v[228:229]
    v_pk_mul_f32 v[22:23], v[230:231], v[230:231]
    v_pk_fma_f32 v[16:17], v[16:17], v[6:7], v[4:5]
    v_pk_fma_f32 v[18:19], v[18:19], v[6:7], v[4:5]
    v_pk_fma_f32 v[20:21], v[20:21], v[6:7], v[4:5]
    v_pk_fma_f32 v[22:23], v[22:23], v[6:7], v[4:5]
    v_pk_mul_f32 v[16:17], v[16:17], v[224:225]
    v_pk_mul_f32 v[18:19], v[18:19], v[226:227]
    v_pk_mul_f32 v[20:21], v[20:21], v[228:229]
    v_pk_mul_f32 v[22:23], v[22:23], v[230:231]
    v_pk_mul_f32 v[224:225], v[224:225], v[232:233]
    v_pk_mul_f32 v[226:227], v[226:227], v[234:235]
    v_pk_mul_f32 v[228:229], v[228:229], v[236:237]
    v_pk_mul_f32 v[230:231], v[230:231], v[238:239]
    v_exp_f32 v16, v16
    v_exp_f32 v17, v17
    v_exp_f32 v18, v18
    v_exp_f32 v19, v19
    v_exp_f32 v20, v20
    v_exp_f32 v21, v21
    v_exp_f32 v22, v22
    v_exp_f32 v23, v23
    v_fma_f32 v16, v16, v8, v8
    v_fma_f32 v17, v17, v8, v8
    v_rcp_f32 v16, v16
    v_fma_f32 v18, v18, v8, v8
    v_rcp_f32 v17, v17
    v_fma_f32 v19, v19, v8, v8
    v_rcp_f32 v18, v18
    v_fma_f32 v20, v20, v8, v8
    v_rcp_f32 v19, v19
    v_fma_f32 v21, v21, v8, v8
    v_rcp_f32 v20, v20
    v_fma_f32 v22, v22, v8, v8
    v_rcp_f32 v21, v21
    v_fma_f32 v23, v23, v8, v8
    v_rcp_f32 v22, v22
    v_rcp_f32 v23, v23
    v_pk_mul_f32 v[224:225], v[224:225], v[16:17]
    v_pk_mul_f32 v[226:227], v[226:227], v[18:19]
    v_pk_mul_f32 v[228:229], v[228:229], v[20:21]
    v_pk_mul_f32 v[230:231], v[230:231], v[22:23]
    v_cvt_pk_bf16_f32 v232, v224, v225
    v_cvt_pk_bf16_f32 v233, v226, v227
    v_cvt_pk_bf16_f32 v234, v228, v229
    v_cvt_pk_bf16_f32 v235, v230, v231
    buffer_store_dwordx4 v[232:235], v13, s[48:51], s10 offen sc1
    s_waitcnt lgkmcnt(0)
    v_pk_fma_f32 v[240:241], v[32:33], v[10:11], v[240:241]
    v_pk_fma_f32 v[242:243], v[34:35], v[10:11], v[242:243]
    v_pk_fma_f32 v[244:245], v[36:37], v[10:11], v[244:245]
    v_pk_fma_f32 v[246:247], v[38:39], v[10:11], v[246:247]
    v_pk_fma_f32 v[248:249], v[40:41], v[10:11], v[248:249]
    v_pk_fma_f32 v[250:251], v[42:43], v[10:11], v[250:251]
    v_pk_fma_f32 v[252:253], v[44:45], v[10:11], v[252:253]
    v_pk_fma_f32 v[254:255], v[46:47], v[10:11], v[254:255]
    v_pk_mul_f32 v[16:17], v[240:241], v[240:241]
    v_pk_mul_f32 v[18:19], v[242:243], v[242:243]
    v_pk_mul_f32 v[20:21], v[244:245], v[244:245]
    v_pk_mul_f32 v[22:23], v[246:247], v[246:247]
    v_pk_fma_f32 v[16:17], v[16:17], v[6:7], v[4:5]
    v_pk_fma_f32 v[18:19], v[18:19], v[6:7], v[4:5]
    v_pk_fma_f32 v[20:21], v[20:21], v[6:7], v[4:5]
    v_pk_fma_f32 v[22:23], v[22:23], v[6:7], v[4:5]
    v_pk_mul_f32 v[16:17], v[16:17], v[240:241]
    v_pk_mul_f32 v[18:19], v[18:19], v[242:243]
    v_pk_mul_f32 v[20:21], v[20:21], v[244:245]
    v_pk_mul_f32 v[22:23], v[22:23], v[246:247]
    v_pk_mul_f32 v[240:241], v[240:241], v[248:249]
    v_pk_mul_f32 v[242:243], v[242:243], v[250:251]
    v_pk_mul_f32 v[244:245], v[244:245], v[252:253]
    v_pk_mul_f32 v[246:247], v[246:247], v[254:255]
    v_exp_f32 v16, v16
    v_exp_f32 v17, v17
    v_exp_f32 v18, v18
    v_exp_f32 v19, v19
    v_exp_f32 v20, v20
    v_exp_f32 v21, v21
    v_exp_f32 v22, v22
    v_exp_f32 v23, v23
    v_fma_f32 v16, v16, v8, v8
    v_fma_f32 v17, v17, v8, v8
    v_rcp_f32 v16, v16
    v_fma_f32 v18, v18, v8, v8
    v_rcp_f32 v17, v17
    v_fma_f32 v19, v19, v8, v8
    v_rcp_f32 v18, v18
    v_fma_f32 v20, v20, v8, v8
    v_rcp_f32 v19, v19
    v_fma_f32 v21, v21, v8, v8
    v_rcp_f32 v20, v20
    v_fma_f32 v22, v22, v8, v8
    v_rcp_f32 v21, v21
    v_fma_f32 v23, v23, v8, v8
    v_rcp_f32 v22, v22
    v_rcp_f32 v23, v23
    v_pk_mul_f32 v[240:241], v[240:241], v[16:17]
    v_pk_mul_f32 v[242:243], v[242:243], v[18:19]
    v_pk_mul_f32 v[244:245], v[244:245], v[20:21]
    v_pk_mul_f32 v[246:247], v[246:247], v[22:23]
    v_cvt_pk_bf16_f32 v248, v240, v241
    v_cvt_pk_bf16_f32 v249, v242, v243
    v_cvt_pk_bf16_f32 v250, v244, v245
    v_cvt_pk_bf16_f32 v251, v246, v247
    buffer_store_dwordx4 v[248:251], v13, s[48:51], s11 offen sc1
    s_lshl_b32 s4, s76, 2
    s_add_u32 s4, s4, s3
    s_lshl_b32 s4, s4, 12
    s_lshl_b32 s5, s79, 7
    s_add_u32 s4, s4, s5
    s_add_u32 s15, s4, 0xe0000
L_roleG2:
    s_and_b32 s4, s2, 7
    s_lshr_b32 s5, s2, 3
    s_and_b32 s78, s5, 1
    s_bfe_u32 s79, s5, 0x20001
    s_lshr_b32 s5, s5, 3
    s_lshl_b32 s4, s4, 2
    s_add_u32 s76, s4, s5
    s_mul_i32 s12, s3, 27
    s_lshr_b32 s13, s12, 2
    v_lshlrev_b32 v27, 4, v0
    v_lshlrev_b32 v47, 7, v0
    v_cmp_eq_u32 vcc, s64, v12
    s_nop 0
    s_and_b64 s[68:69], vcc, s[66:67]
    s_cmp_eq_u64 s[68:69], s[66:67]
    s_cbranch_scc1 L_g2_wok
    s_mov_b32 s70, 40000
    s_mov_b32 s66, 0x7ff
    s_mov_b32 s67, 0
    s_mov_b64 exec, s[66:67]
    buffer_load_dword v12, v14, s[48:51], s98 offen sc1
    s_mov_b64 exec, -1
    s_waitcnt vmcnt(0)
    v_cmp_eq_u32 vcc, s64, v12
    s_nop 0
    s_and_b64 s[68:69], vcc, s[66:67]
    s_cmp_eq_u64 s[68:69], s[66:67]
    s_cbranch_scc1 L_poll8_done
    s_mov_b64 exec, s[66:67]
    buffer_load_dword v12, v14, s[48:51], s98 offen sc1
L_poll8:
    s_sleep 2
    buffer_load_dword v13, v14, s[48:51], s98 offen sc1
    s_waitcnt vmcnt(1)
    v_cmp_eq_u32 vcc, s64, v12
    s_nop 0
    s_cmp_eq_u64 vcc, s[66:67]
    s_cbranch_scc1 L_poll8_hit
    s_sleep 2
    buffer_load_dword v12, v14, s[48:51], s98 offen sc1
    s_waitcnt vmcnt(1)
    v_cmp_eq_u32 vcc, s64, v13
    s_nop 0
    s_cmp_eq_u64 vcc, s[66:67]
    s_cbranch_scc1 L_poll8_hit
    s_sub_u32 s70, s70, 1
    s_cmp_lg_u32 s70, 0
    s_cbranch_scc1 L_poll8
L_poll8_hit:
    s_mov_b64 exec, -1
L_poll8_done:
    s_waitcnt vmcnt(0)
L_g2_wok:
    s_mul_i32 s77, s79, 5
    s_lshl_b32 s4, s78, 1
    s_add_u32 s77, s77, s4
    s_add_u32 s6, s77, s78
    s_add_u32 s7, s6, 1
    s_xor_b32 s8, s78, 1
    s_lshl_b32 s8, s8, 1
    s_add_u32 s8, s8, s77
    s_lshl_b32 s5, s76, 1
    s_add_u32 s84, s5, s78
    s_xor_b32 s85, s84, 1
    s_and_b32 s4, s76, 3
    s_mul_i32 s4, s4, 7
    s_mul_i32 s86, s4, 1024
    s_mul_i32 s87, s4, 1024
    s_bfe_u32 s4, s2, 0x30003
    s_mul_i32 s4, s4, 0
    s_lshr_b32 s4, s4, 2
    s_mul_i32 s71, s4, 1024
    s_mul_i32 s65, s4, 1024
    s_mul_i32 s4, s12, 1024
    s_add_u32 s4, s4, 0xb00000
    s_mul_i32 s5, s3, 10240
    s_add_u32 s5, s5, 0xb1b000
    s_mul_i32 s9, s6, 151552
    s_add_u32 s80, s9, s4
    s_add_u32 s83, s9, s5
    s_mul_i32 s9, s7, 151552
    s_add_u32 s81, s9, s4
    s_add_u32 s10, s9, s5
    s_mul_i32 s9, s8, 151552
    s_add_u32 s82, s9, s4
    s_add_u32 s11, s9, s5
    s_setprio 0
    s_add_u32 s4, s80, s86
    buffer_load_dwordx4 v[96:99], v27, s[48:51], s4 offen sc1
    s_add_u32 s4, s81, s86
    buffer_load_dwordx4 v[100:103], v27, s[48:51], s4 offen sc1
    s_add_u32 s4, s82, s86
    buffer_load_dwordx4 v[104:107], v27, s[48:51], s4 offen sc1
    s_add_u32 s86, s86, 1024
    s_cmp_eq_u32 s86, 27648
    s_cselect_b32 s86, 0, s86
    s_add_u32 s4, s80, s86
    buffer_load_dwordx4 v[116:119], v27, s[48:51], s4 offen sc1
    s_add_u32 s4, s81, s86
    buffer_load_dwordx4 v[120:123], v27, s[48:51], s4 offen sc1
    s_add_u32 s4, s82, s86
    buffer_load_dwordx4 v[124:127], v27, s[48:51], s4 offen sc1
    s_add_u32 s86, s86, 1024
    s_cmp_eq_u32 s86, 27648
    s_cselect_b32 s86, 0, s86
    s_add_u32 s4, s80, s86
    buffer_load_dwordx4 v[136:139], v27, s[48:51], s4 offen sc1
    s_add_u32 s4, s81, s86
    buffer_load_dwordx4 v[140:143], v27, s[48:51], s4 offen sc1
    s_add_u32 s4, s82, s86
    buffer_load_dwordx4 v[144:147], v27, s[48:51], s4 offen sc1
    s_add_u32 s86, s86, 1024
    s_cmp_eq_u32 s86, 27648
    s_cselect_b32 s86, 0, s86
    s_setprio 3
    s_mul_i32 s88, s84, 40960
    s_lshl_b32 s4, s6, 6
    s_add_u32 s88, s88, s4
    s_mul_i32 s89, s84, 40960
    s_lshl_b32 s4, s7, 6
    s_add_u32 s89, s89, s4
    s_mul_i32 s90, s84, 40960
    s_lshl_b32 s4, s8, 6
    s_add_u32 s90, s90, s4
    s_mul_i32 s91, s85, 40960
    s_lshl_b32 s4, s6, 6
    s_add_u32 s91, s91, s4
    s_mul_i32 s92, s85, 40960
    s_lshl_b32 s4, s7, 6
    s_add_u32 s92, s92, s4
    s_mul_i32 s93, s3, 20480
    v_lshrrev_b32 v2, 3, v0
    s_lshl_b32 s4, s3, 3
    v_add_u32 v2, s4, v2
    v_and_b32 v3, 7, v0
    v_mul_u32_u24 v28, 1280, v2
    v_lshl_add_u32 v28, v3, 3, v28
    v_xor_b32 v3, v3, v2
    v_and_b32 v3, 7, v3
    v_lshlrev_b32 v29, 7, v2
    v_lshl_add_u32 v29, v3, 4, v29
    v_add_u32 v44, 61440, v29
    v_add_u32 v16, s93, v27
    v_and_b32 v2, 31, v0
    v_lshrrev_b32 v3, 5, v0
    v_xor_b32 v3, v3, v0
    v_and_b32 v3, 7, v3
    v_lshlrev_b32 v2, 7, v2
    v_add_u32 v2, s93, v2
    v_xor_b32 v4, 0, v3
    v_lshl_add_u32 v40, v4, 4, v2
    v_xor_b32 v4, 2, v3
    v_lshl_add_u32 v41, v4, 4, v2
    v_xor_b32 v4, 4, v3
    v_lshl_add_u32 v42, v4, 4, v2
    v_xor_b32 v4, 6, v3
    v_lshl_add_u32 v43, v4, 4, v2
    s_bfe_u32 s4, s2, 0x30003
    s_mul_i32 s4, s4, 54
    v_add_u32 v2, s4, v0
    v_lshlrev_b32 v45, 7, v2
    v_add_u32 v3, 82944, v45
    v_cmp_lt_u32 vcc, 215, v2
    s_mul_i32 s14, s76, 221184
    s_lshl_b32 s4, s12, 10
    v_cndmask_b32 v45, v45, v3, vcc
    v_mov_b32 v46, s64
    s_setprio 0
    s_add_u32 s14, s14, s4
    s_add_u32 s14, s14, 0x400000
    s_mul_i32 s94, s84, 110592
    s_add_u32 s94, s94, s4
    s_add_u32 s94, s94, 0x400000
    s_mul_i32 s96, s84, 40960
    s_mul_i32 s5, s3, 10240
    s_add_u32 s96, s96, s5
    s_add_u32 s96, s96, 0x100000
    s_mul_i32 s95, s85, 110592
    s_add_u32 s95, s95, s4
    s_add_u32 s95, s95, 0x400000
    s_mul_i32 s97, s85, 40960
    s_mul_i32 s5, s3, 10240
    s_add_u32 s97, s97, s5
    s_add_u32 s97, s97, 0x100000
    buffer_load_dwordx2 v[30:31], v28, s[40:43], s88 offen
    buffer_load_dwordx2 v[32:33], v28, s[40:43], s89 offen
    buffer_load_dwordx2 v[34:35], v28, s[40:43], s90 offen
    buffer_load_dwordx2 v[36:37], v28, s[40:43], s91 offen
    buffer_load_dwordx2 v[38:39], v28, s[40:43], s92 offen
    s_waitcnt vmcnt(14)
    s_mov_b64 exec, 1
    buffer_store_dword v46, off, s[48:51], s15 sc1
    s_mov_b64 exec, -1
    s_barrier
    s_lshl_b32 s4, s76, 12
    s_lshl_b32 s5, s13, 7
    s_add_u32 s4, s4, s5
    s_add_u32 s98, s4, 0xe0000
    s_mul_i32 s5, s3, 3
    s_and_b32 s5, s5, 2
    s_lshl_b32 s5, s5, 6
    s_or_b32 s7, s5, 0x7f
    s_mov_b32 s70, 40000
    s_waitcnt vmcnt(0)
    s_setprio 3
    s_mov_b32 s66, s7
    s_mov_b32 s67, 0
    s_mov_b64 exec, s[66:67]
    buffer_load_dword v12, v47, s[48:51], s98 offen sc1
    s_mov_b64 exec, -1
    s_waitcnt vmcnt(0)
    v_cmp_eq_u32 vcc, s64, v12
    s_nop 0
    s_and_b64 s[68:69], vcc, s[66:67]
    s_cmp_eq_u64 s[68:69], s[66:67]
    s_cbranch_scc1 L_poll9_done
    s_mov_b64 exec, s[66:67]
    buffer_load_dword v12, v47, s[48:51], s98 offen sc1
L_poll9:
    s_sleep 2
    buffer_load_dword v13, v47, s[48:51], s98 offen sc1
    s_waitcnt vmcnt(1)
    v_cmp_eq_u32 vcc, s64, v12
    s_nop 0
    s_cmp_eq_u64 vcc, s[66:67]
    s_cbranch_scc1 L_poll9_hit
    s_sleep 2
    buffer_load_dword v12, v47, s[48:51], s98 offen sc1
    s_waitcnt vmcnt(1)
    v_cmp_eq_u32 vcc, s64, v13
    s_nop 0
    s_cmp_eq_u64 vcc, s[66:67]
    s_cbranch_scc1 L_poll9_hit
    s_sub_u32 s70, s70, 1
    s_cmp_lg_u32 s70, 0
    s_cbranch_scc1 L_poll9
L_poll9_hit:
    s_mov_b64 exec, -1
L_poll9_done:
    s_setprio 0
    s_add_u32 s4, s94, s87
    buffer_load_dwordx4 v[108:111], v27, s[48:51], s4 offen sc1
    s_add_u32 s4, s95, s87
    buffer_load_dwordx4 v[112:115], v27, s[48:51], s4 offen sc1
    s_add_u32 s87, s87, 1024
    s_cmp_eq_u32 s87, 27648
    s_cselect_b32 s87, 0, s87
    s_add_u32 s4, s94, s87
    buffer_load_dwordx4 v[128:131], v27, s[48:51], s4 offen sc1
    s_add_u32 s4, s95, s87
    buffer_load_dwordx4 v[132:135], v27, s[48:51], s4 offen sc1
    s_add_u32 s87, s87, 1024
    s_cmp_eq_u32 s87, 27648
    s_cselect_b32 s87, 0, s87
    s_add_u32 s4, s94, s87
    buffer_load_dwordx4 v[148:151], v27, s[48:51], s4 offen sc1
    s_add_u32 s4, s95, s87
    buffer_load_dwordx4 v[152:155], v27, s[48:51], s4 offen sc1
    s_add_u32 s87, s87, 1024
    s_cmp_eq_u32 s87, 27648
    s_cselect_b32 s87, 0, s87
    s_waitcnt vmcnt(4)
    v_mfma_f32_32x32x16_bf16 v[176:191], v[96:99], v[108:111], 0
    s_add_u32 s4, s80, s86
    buffer_load_dwordx4 v[156:159], v27, s[48:51], s4 offen sc1
    v_mfma_f32_32x32x16_bf16 v[224:239], v[96:99], v[112:115], 0
    s_add_u32 s4, s81, s86
    buffer_load_dwordx4 v[160:163], v27, s[48:51], s4 offen sc1
    v_mfma_f32_32x32x16_bf16 v[192:207], v[100:103], v[108:111], 0
    s_add_u32 s4, s82, s86
    buffer_load_dwordx4 v[164:167], v27, s[48:51], s4 offen sc1
    s_add_u32 s86, s86, 1024
    s_cmp_eq_u32 s86, 27648
    s_cselect_b32 s86, 0, s86
    v_mfma_f32_32x32x16_bf16 v[240:255], v[100:103], v[112:115], 0
    s_add_u32 s4, s94, s87
    buffer_load_dwordx4 v[168:171], v27, s[48:51], s4 offen sc1
    v_mfma_f32_32x32x16_bf16 v[208:223], v[104:107], v[108:111], 0
    s_add_u32 s4, s95, s87
    buffer_load_dwordx4 v[172:175], v27, s[48:51], s4 offen sc1
    s_add_u32 s87, s87, 1024
    s_cmp_eq_u32 s87, 27648
    s_cselect_b32 s87, 0, s87
    s_add_u32 s4, s83, s71
    buffer_load_dwordx4 v[48:51], v27, s[48:51], s4 offen sc1
    s_add_u32 s4, s10, s71
    buffer_load_dwordx4 v[52:55], v27, s[48:51], s4 offen sc1
    s_waitcnt vmcnt(9)
    v_mfma_f32_32x32x16_bf16 v[176:191], v[116:119], v[128:131], v[176:191]
    s_add_u32 s4, s80, s86
    buffer_load_dwordx4 v[96:99], v27, s[48:51], s4 offen sc1
    v_mfma_f32_32x32x16_bf16 v[224:239], v[116:119], v[132:135], v[224:239]
    s_add_u32 s4, s81, s86
    buffer_load_dwordx4 v[100:103], v27, s[48:51], s4 offen sc1
    v_mfma_f32_32x32x16_bf16 v[192:207], v[120:123], v[128:131], v[192:207]
    s_add_u32 s4, s82, s86
    buffer_load_dwordx4 v[104:107], v27, s[48:51], s4 offen sc1
    s_add_u32 s86, s86, 1024
    s_cmp_eq_u32 s86, 27648
    s_cselect_b32 s86, 0, s86
    v_mfma_f32_32x32x16_bf16 v[240:255], v[120:123], v[132:135], v[240:255]
    s_add_u32 s4, s94, s87
    buffer_load_dwordx4 v[108:111], v27, s[48:51], s4 offen sc1
    v_mfma_f32_32x32x16_bf16 v[208:223], v[124:127], v[128:131], v[208:223]
    s_add_u32 s4, s95, s87
    buffer_load_dwordx4 v[112:115], v27, s[48:51], s4 offen sc1
    s_add_u32 s87, s87, 1024
    s_cmp_eq_u32 s87, 27648
    s_cselect_b32 s87, 0, s87
    s_add_u32 s4, s11, s71
    buffer_load_dwordx4 v[56:59], v27, s[48:51], s4 offen sc1
    s_add_u32 s71, s71, 1024
    s_cmp_eq_u32 s71, 10240
    s_cselect_b32 s71, 0, s71
    s_add_u32 s4, s83, s71
    buffer_load_dwordx4 v[60:63], v27, s[48:51], s4 offen sc1
    s_waitcnt vmcnt(14)
    v_mfma_f32_32x32x16_bf16 v[176:191], v[136:139], v[148:151], v[176:191]
    s_add_u32 s4, s80, s86
    buffer_load_dwordx4 v[116:119], v27, s[48:51], s4 offen sc1
    v_mfma_f32_32x32x16_bf16 v[224:239], v[136:139], v[152:155], v[224:239]
    s_add_u32 s4, s81, s86
    buffer_load_dwordx4 v[120:123], v27, s[48:51], s4 offen sc1
    v_mfma_f32_32x32x16_bf16 v[192:207], v[140:143], v[148:151], v[192:207]
    s_add_u32 s4, s82, s86
    buffer_load_dwordx4 v[124:127], v27, s[48:51], s4 offen sc1
    s_add_u32 s86, s86, 1024
    s_cmp_eq_u32 s86, 27648
    s_cselect_b32 s86, 0, s86
    v_mfma_f32_32x32x16_bf16 v[240:255], v[140:143], v[152:155], v[240:255]
    s_add_u32 s4, s94, s87
    buffer_load_dwordx4 v[128:131], v27, s[48:51], s4 offen sc1
    v_mfma_f32_32x32x16_bf16 v[208:223], v[144:147], v[148:151], v[208:223]
    s_add_u32 s4, s95, s87
    buffer_load_dwordx4 v[132:135], v27, s[48:51], s4 offen sc1
    s_add_u32 s87, s87, 1024
    s_cmp_eq_u32 s87, 27648
    s_cselect_b32 s87, 0, s87
    s_add_u32 s4, s10, s71
    buffer_load_dwordx4 v[64:67], v27, s[48:51], s4 offen sc1
    s_add_u32 s4, s11, s71
    buffer_load_dwordx4 v[68:71], v27, s[48:51], s4 offen sc1
    s_add_u32 s71, s71, 1024
    s_cmp_eq_u32 s71, 10240
    s_cselect_b32 s71, 0, s71
    s_waitcnt vmcnt(16)
    v_mfma_f32_32x32x16_bf16 v[176:191], v[156:159], v[168:171], v[176:191]
    s_add_u32 s4, s80, s86
    buffer_load_dwordx4 v[136:139], v27, s[48:51], s4 offen sc1
    v_mfma_f32_32x32x16_bf16 v[224:239], v[156:159], v[172:175], v[224:239]
    s_add_u32 s4, s81, s86
    buffer_load_dwordx4 v[140:143], v27, s[48:51], s4 offen sc1
    v_mfma_f32_32x32x16_bf16 v[192:207], v[160:163], v[168:171], v[192:207]
    s_add_u32 s4, s82, s86
    buffer_load_dwordx4 v[144:147], v27, s[48:51], s4 offen sc1
    s_add_u32 s86, s86, 1024
    s_cmp_eq_u32 s86, 27648
    s_cselect_b32 s86, 0, s86
    v_mfma_f32_32x32x16_bf16 v[240:255], v[160:163], v[172:175], v[240:255]
    s_add_u32 s4, s94, s87
    buffer_load_dwordx4 v[148:151], v27, s[48:51], s4 offen sc1
    v_mfma_f32_32x32x16_bf16 v[208:223], v[164:167], v[168:171], v[208:223]
    s_add_u32 s4, s95, s87
    buffer_load_dwordx4 v[152:155], v27, s[48:51], s4 offen sc1
    s_add_u32 s87, s87, 1024
    s_cmp_eq_u32 s87, 27648
    s_cselect_b32 s87, 0, s87
    s_add_u32 s4, s83, s71
    buffer_load_dwordx4 v[72:75], v27, s[48:51], s4 offen sc1
    s_add_u32 s4, s10, s71
    buffer_load_dwordx4 v[76:79], v27, s[48:51], s4 offen sc1
    s_waitcnt vmcnt(16)
    v_mfma_f32_32x32x16_bf16 v[176:191], v[96:99], v[108:111], v[176:191]
    s_add_u32 s4, s80, s86
    buffer_load_dwordx4 v[156:159], v27, s[48:51], s4 offen sc1
    v_mfma_f32_32x32x16_bf16 v[224:239], v[96:99], v[112:115], v[224:239]
    s_add_u32 s4, s81, s86
    buffer_load_dwordx4 v[160:163], v27, s[48:51], s4 offen sc1
    v_mfma_f32_32x32x16_bf16 v[192:207], v[100:103], v[108:111], v[192:207]
    s_add_u32 s4, s82, s86
    buffer_load_dwordx4 v[164:167], v27, s[48:51], s4 offen sc1
    s_add_u32 s86, s86, 1024
    s_cmp_eq_u32 s86, 27648
    s_cselect_b32 s86, 0, s86
    v_mfma_f32_32x32x16_bf16 v[240:255], v[100:103], v[112:115], v[240:255]
    s_add_u32 s4, s94, s87
    buffer_load_dwordx4 v[168:171], v27, s[48:51], s4 offen sc1
    v_mfma_f32_32x32x16_bf16 v[208:223], v[104:107], v[108:111], v[208:223]
    s_add_u32 s4, s95, s87
    buffer_load_dwordx4 v[172:175], v27, s[48:51], s4 offen sc1
    s_add_u32 s87, s87, 1024
    s_cmp_eq_u32 s87, 27648
    s_cselect_b32 s87, 0, s87
    s_add_u32 s4, s11, s71
    buffer_load_dwordx4 v[80:83], v27, s[48:51], s4 offen sc1
    s_add_u32 s71, s71, 1024
    s_cmp_eq_u32 s71, 10240
    s_cselect_b32 s71, 0, s71
    s_add_u32 s4, s83, s71
    buffer_load_dwordx4 v[84:87], v27, s[48:51], s4 offen sc1
    s_waitcnt vmcnt(16)
    v_mfma_f32_32x32x16_bf16 v[176:191], v[116:119], v[128:131], v[176:191]
    s_add_u32 s4, s80, s86
    buffer_load_dwordx4 v[96:99], v27, s[48:51], s4 offen sc1
    v_mfma_f32_32x32x16_bf16 v[224:239], v[116:119], v[132:135], v[224:239]
    s_add_u32 s4, s81, s86
    buffer_load_dwordx4 v[100:103], v27, s[48:51], s4 offen sc1
    v_mfma_f32_32x32x16_bf16 v[192:207], v[120:123], v[128:131], v[192:207]
    s_add_u32 s4, s82, s86
    buffer_load_dwordx4 v[104:107], v27, s[48:51], s4 offen sc1
    s_add_u32 s86, s86, 1024
    s_cmp_eq_u32 s86, 27648
    s_cselect_b32 s86, 0, s86
    v_mfma_f32_32x32x16_bf16 v[240:255], v[120:123], v[132:135], v[240:255]
    s_add_u32 s4, s94, s87
    buffer_load_dwordx4 v[108:111], v27, s[48:51], s4 offen sc1
    v_mfma_f32_32x32x16_bf16 v[208:223], v[124:127], v[128:131], v[208:223]
    s_add_u32 s4, s95, s87
    buffer_load_dwordx4 v[112:115], v27, s[48:51], s4 offen sc1
    s_add_u32 s87, s87, 1024
    s_cmp_eq_u32 s87, 27648
    s_cselect_b32 s87, 0, s87
    s_add_u32 s4, s10, s71
    buffer_load_dwordx4 v[88:91], v27, s[48:51], s4 offen sc1
    s_add_u32 s4, s11, s71
    buffer_load_dwordx4 v[92:95], v27, s[48:51], s4 offen sc1
    s_add_u32 s71, s71, 1024
    s_cmp_eq_u32 s71, 10240
    s_cselect_b32 s71, 0, s71
    s_waitcnt vmcnt(16)
    v_mfma_f32_32x32x16_bf16 v[176:191], v[136:139], v[148:151], v[176:191]
    s_add_u32 s4, s80, s86
    buffer_load_dwordx4 v[116:119], v27, s[48:51], s4 offen sc1
    v_mfma_f32_32x32x16_bf16 v[224:239], v[136:139], v[152:155], v[224:239]
    s_add_u32 s4, s81, s86
    buffer_load_dwordx4 v[120:123], v27, s[48:51], s4 offen sc1
    v_mfma_f32_32x32x16_bf16 v[192:207], v[140:143], v[148:151], v[192:207]
    s_add_u32 s4, s82, s86
    buffer_load_dwordx4 v[124:127], v27, s[48:51], s4 offen sc1
    s_add_u32 s86, s86, 1024
    s_cmp_eq_u32 s86, 27648
    s_cselect_b32 s86, 0, s86
    v_mfma_f32_32x32x16_bf16 v[240:255], v[140:143], v[152:155], v[240:255]
    s_add_u32 s4, s94, s87
    buffer_load_dwordx4 v[128:131], v27, s[48:51], s4 offen sc1
    v_mfma_f32_32x32x16_bf16 v[208:223], v[144:147], v[148:151], v[208:223]
    s_add_u32 s4, s95, s87
    buffer_load_dwordx4 v[132:135], v27, s[48:51], s4 offen sc1
    s_add_u32 s87, s87, 1024
    s_cmp_eq_u32 s87, 27648
    s_cselect_b32 s87, 0, s87
    s_add_u32 m0, s93, 0
    s_add_u32 s4, s83, s71
    buffer_load_dwordx4 v27, s[48:51], s4 offen sc1 lds
    s_add_u32 m0, s93, 1024
    s_add_u32 s4, s10, s71
    buffer_load_dwordx4 v27, s[48:51], s4 offen sc1 lds
    s_waitcnt vmcnt(16)
    v_mfma_f32_32x32x16_bf16 v[176:191], v[156:159], v[168:171], v[176:191]
    s_add_u32 s4, s80, s86
    buffer_load_dwordx4 v[136:139], v27, s[48:51], s4 offen sc1
    v_mfma_f32_32x32x16_bf16 v[224:239], v[156:159], v[172:175], v[224:239]
    s_add_u32 s4, s81, s86
    buffer_load_dwordx4 v[140:143], v27, s[48:51], s4 offen sc1
    v_mfma_f32_32x32x16_bf16 v[192:207], v[160:163], v[168:171], v[192:207]
    s_add_u32 s4, s82, s86
    buffer_load_dwordx4 v[144:147], v27, s[48:51], s4 offen sc1
    s_add_u32 s86, s86, 1024
    s_cmp_eq_u32 s86, 27648
    s_cselect_b32 s86, 0, s86
    v_mfma_f32_32x32x16_bf16 v[240:255], v[160:163], v[172:175], v[240:255]
    s_add_u32 s4, s94, s87
    buffer_load_dwordx4 v[148:151], v27, s[48:51], s4 offen sc1
    v_mfma_f32_32x32x16_bf16 v[208:223], v[164:167], v[168:171], v[208:223]
    s_add_u32 s4, s95, s87
    buffer_load_dwordx4 v[152:155], v27, s[48:51], s4 offen sc1
    s_add_u32 s87, s87, 1024
    s_cmp_eq_u32 s87, 27648
    s_cselect_b32 s87, 0, s87
    s_add_u32 m0, s93, 2048
    s_add_u32 s4, s11, s71
    buffer_load_dwordx4 v27, s[48:51], s4 offen sc1 lds
    s_add_u32 s71, s71, 1024
    s_cmp_eq_u32 s71, 10240
    s_cselect_b32 s71, 0, s71
    s_add_u32 m0, s93, 3072
    s_add_u32 s4, s83, s71
    buffer_load_dwordx4 v27, s[48:51], s4 offen sc1 lds
    s_waitcnt vmcnt(16)
    v_mfma_f32_32x32x16_bf16 v[176:191], v[96:99], v[108:111], v[176:191]
    s_add_u32 s4, s80, s86
    buffer_load_dwordx4 v[156:159], v27, s[48:51], s4 offen sc1
    v_mfma_f32_32x32x16_bf16 v[224:239], v[96:99], v[112:115], v[224:239]
    s_add_u32 s4, s81, s86
    buffer_load_dwordx4 v[160:163], v27, s[48:51], s4 offen sc1
    v_mfma_f32_32x32x16_bf16 v[192:207], v[100:103], v[108:111], v[192:207]
    s_add_u32 s4, s82, s86
    buffer_load_dwordx4 v[164:167], v27, s[48:51], s4 offen sc1
    s_add_u32 s86, s86, 1024
    s_cmp_eq_u32 s86, 27648
    s_cselect_b32 s86, 0, s86
    v_mfma_f32_32x32x16_bf16 v[240:255], v[100:103], v[112:115], v[240:255]
    s_add_u32 s4, s94, s87
    buffer_load_dwordx4 v[168:171], v27, s[48:51], s4 offen sc1
    v_mfma_f32_32x32x16_bf16 v[208:223], v[104:107], v[108:111], v[208:223]
    s_add_u32 s4, s95, s87
    buffer_load_dwordx4 v[172:175], v27, s[48:51], s4 offen sc1
    s_add_u32 s87, s87, 1024
    s_cmp_eq_u32 s87, 27648
    s_cselect_b32 s87, 0, s87
    s_add_u32 m0, s93, 4096
    s_add_u32 s4, s10, s71
    buffer_load_dwordx4 v27, s[48:51], s4 offen sc1 lds
    s_waitcnt vmcnt(15)
    v_mfma_f32_32x32x16_bf16 v[176:191], v[116:119], v[128:131], v[176:191]
    s_add_u32 s4, s80, s86
    buffer_load_dwordx4 v[96:99], v27, s[48:51], s4 offen sc1
    v_mfma_f32_32x32x16_bf16 v[224:239], v[116:119], v[132:135], v[224:239]
    s_add_u32 s4, s81, s86
    buffer_load_dwordx4 v[100:103], v27, s[48:51], s4 offen sc1
    v_mfma_f32_32x32x16_bf16 v[192:207], v[120:123], v[128:131], v[192:207]
    s_add_u32 s4, s82, s86
    buffer_load_dwordx4 v[104:107], v27, s[48:51], s4 offen sc1
    s_add_u32 s86, s86, 1024
    s_cmp_eq_u32 s86, 27648
    s_cselect_b32 s86, 0, s86
    v_mfma_f32_32x32x16_bf16 v[240:255], v[120:123], v[132:135], v[240:255]
    s_add_u32 s4, s94, s87
    buffer_load_dwordx4 v[108:111], v27, s[48:51], s4 offen sc1
    v_mfma_f32_32x32x16_bf16 v[208:223], v[124:127], v[128:131], v[208:223]
    s_add_u32 s4, s95, s87
    buffer_load_dwordx4 v[112:115], v27, s[48:51], s4 offen sc1
    s_add_u32 s87, s87, 1024
    s_cmp_eq_u32 s87, 27648
    s_cselect_b32 s87, 0, s87
    s_add_u32 m0, s93, 5120
    s_add_u32 s4, s11, s71
    buffer_load_dwordx4 v27, s[48:51], s4 offen sc1 lds
    s_add_u32 s71, s71, 1024
    s_cmp_eq_u32 s71, 10240
    s_cselect_b32 s71, 0, s71
    s_waitcnt vmcnt(14)
    v_mfma_f32_32x32x16_bf16 v[176:191], v[136:139], v[148:151], v[176:191]
    s_add_u32 s4, s80, s86
    buffer_load_dwordx4 v[116:119], v27, s[48:51], s4 offen sc1
    v_mfma_f32_32x32x16_bf16 v[224:239], v[136:139], v[152:155], v[224:239]
    s_add_u32 s4, s81, s86
    buffer_load_dwordx4 v[120:123], v27, s[48:51], s4 offen sc1
    v_mfma_f32_32x32x16_bf16 v[192:207], v[140:143], v[148:151], v[192:207]
    s_add_u32 s4, s82, s86
    buffer_load_dwordx4 v[124:127], v27, s[48:51], s4 offen sc1
    s_add_u32 s86, s86, 1024
    s_cmp_eq_u32 s86, 27648
    s_cselect_b32 s86, 0, s86
    v_mfma_f32_32x32x16_bf16 v[240:255], v[140:143], v[152:155], v[240:255]
    s_add_u32 s4, s94, s87
    buffer_load_dwordx4 v[128:131], v27, s[48:51], s4 offen sc1
    v_mfma_f32_32x32x16_bf16 v[208:223], v[144:147], v[148:151], v[208:223]
    s_add_u32 s4, s95, s87
    buffer_load_dwordx4 v[132:135], v27, s[48:51], s4 offen sc1
    s_add_u32 s87, s87, 1024
    s_cmp_eq_u32 s87, 27648
    s_cselect_b32 s87, 0, s87
    s_add_u32 m0, s93, 6144
    s_add_u32 s4, s83, s71
    buffer_load_dwordx4 v27, s[48:51], s4 offen sc1 lds
    s_waitcnt vmcnt(13)
    v_mfma_f32_32x32x16_bf16 v[176:191], v[156:159], v[168:171], v[176:191]
    s_add_u32 s4, s80, s86
    buffer_load_dwordx4 v[136:139], v27, s[48:51], s4 offen sc1
    v_mfma_f32_32x32x16_bf16 v[224:239], v[156:159], v[172:175], v[224:239]
    s_add_u32 s4, s81, s86
    buffer_load_dwordx4 v[140:143], v27, s[48:51], s4 offen sc1
    v_mfma_f32_32x32x16_bf16 v[192:207], v[160:163], v[168:171], v[192:207]
    s_add_u32 s4, s82, s86
    buffer_load_dwordx4 v[144:147], v27, s[48:51], s4 offen sc1
    s_add_u32 s86, s86, 1024
    s_cmp_eq_u32 s86, 27648
    s_cselect_b32 s86, 0, s86
    v_mfma_f32_32x32x16_bf16 v[240:255], v[160:163], v[172:175], v[240:255]
    s_add_u32 s4, s94, s87
    buffer_load_dwordx4 v[148:151], v27, s[48:51], s4 offen sc1
    v_mfma_f32_32x32x16_bf16 v[208:223], v[164:167], v[168:171], v[208:223]
    s_add_u32 s4, s95, s87
    buffer_load_dwordx4 v[152:155], v27, s[48:51], s4 offen sc1
    s_add_u32 s87, s87, 1024
    s_cmp_eq_u32 s87, 27648
    s_cselect_b32 s87, 0, s87
    s_add_u32 m0, s93, 7168
    s_add_u32 s4, s10, s71
    buffer_load_dwordx4 v27, s[48:51], s4 offen sc1 lds
    s_waitcnt vmcnt(13)
    v_mfma_f32_32x32x16_bf16 v[176:191], v[96:99], v[108:111], v[176:191]
    s_add_u32 s4, s80, s86
    buffer_load_dwordx4 v[156:159], v27, s[48:51], s4 offen sc1
    v_mfma_f32_32x32x16_bf16 v[224:239], v[96:99], v[112:115], v[224:239]
    s_add_u32 s4, s81, s86
    buffer_load_dwordx4 v[160:163], v27, s[48:51], s4 offen sc1
    v_mfma_f32_32x32x16_bf16 v[192:207], v[100:103], v[108:111], v[192:207]
    s_add_u32 s4, s82, s86
    buffer_load_dwordx4 v[164:167], v27, s[48:51], s4 offen sc1
    s_add_u32 s86, s86, 1024
    s_cmp_eq_u32 s86, 27648
    s_cselect_b32 s86, 0, s86
    v_mfma_f32_32x32x16_bf16 v[240:255], v[100:103], v[112:115], v[240:255]
    s_add_u32 s4, s94, s87
    buffer_load_dwordx4 v[168:171], v27, s[48:51], s4 offen sc1
    v_mfma_f32_32x32x16_bf16 v[208:223], v[104:107], v[108:111], v[208:223]
    s_add_u32 s4, s95, s87
    buffer_load_dwordx4 v[172:175], v27, s[48:51], s4 offen sc1
    s_add_u32 s87, s87, 1024
    s_cmp_eq_u32 s87, 27648
    s_cselect_b32 s87, 0, s87
    s_add_u32 m0, s93, 8192
    s_add_u32 s4, s11, s71
    buffer_load_dwordx4 v27, s[48:51], s4 offen sc1 lds
    s_add_u32 s71, s71, 1024
    s_cmp_eq_u32 s71, 10240
    s_cselect_b32 s71, 0, s71
    s_waitcnt vmcnt(13)
    v_mfma_f32_32x32x16_bf16 v[176:191], v[116:119], v[128:131], v[176:191]
    s_add_u32 s4, s80, s86
    buffer_load_dwordx4 v[96:99], v27, s[48:51], s4 offen sc1
    v_mfma_f32_32x32x16_bf16 v[224:239], v[116:119], v[132:135], v[224:239]
    s_add_u32 s4, s81, s86
    buffer_load_dwordx4 v[100:103], v27, s[48:51], s4 offen sc1
    v_mfma_f32_32x32x16_bf16 v[192:207], v[120:123], v[128:131], v[192:207]
    s_add_u32 s4, s82, s86
    buffer_load_dwordx4 v[104:107], v27, s[48:51], s4 offen sc1
    s_add_u32 s86, s86, 1024
    s_cmp_eq_u32 s86, 27648
    s_cselect_b32 s86, 0, s86
    v_mfma_f32_32x32x16_bf16 v[240:255], v[120:123], v[132:135], v[240:255]
    s_add_u32 s4, s94, s87
    buffer_load_dwordx4 v[108:111], v27, s[48:51], s4 offen sc1
    v_mfma_f32_32x32x16_bf16 v[208:223], v[124:127], v[128:131], v[208:223]
    s_add_u32 s4, s95, s87
    buffer_load_dwordx4 v[112:115], v27, s[48:51], s4 offen sc1
    s_add_u32 s87, s87, 1024
    s_cmp_eq_u32 s87, 27648
    s_cselect_b32 s87, 0, s87
    s_add_u32 m0, s93, 9216
    s_add_u32 s4, s83, s71
    buffer_load_dwordx4 v27, s[48:51], s4 offen sc1 lds
    s_waitcnt vmcnt(13)
    v_mfma_f32_32x32x16_bf16 v[176:191], v[136:139], v[148:151], v[176:191]
    s_add_u32 s4, s80, s86
    buffer_load_dwordx4 v[116:119], v27, s[48:51], s4 offen sc1
    v_mfma_f32_32x32x16_bf16 v[224:239], v[136:139], v[152:155], v[224:239]
    s_add_u32 s4, s81, s86
    buffer_load_dwordx4 v[120:123], v27, s[48:51], s4 offen sc1
    v_mfma_f32_32x32x16_bf16 v[192:207], v[140:143], v[148:151], v[192:207]
    s_add_u32 s4, s82, s86
    buffer_load_dwordx4 v[124:127], v27, s[48:51], s4 offen sc1
    s_add_u32 s86, s86, 1024
    s_cmp_eq_u32 s86, 27648
    s_cselect_b32 s86, 0, s86
    v_mfma_f32_32x32x16_bf16 v[240:255], v[140:143], v[152:155], v[240:255]
    s_add_u32 s4, s94, s87
    buffer_load_dwordx4 v[128:131], v27, s[48:51], s4 offen sc1
    v_mfma_f32_32x32x16_bf16 v[208:223], v[144:147], v[148:151], v[208:223]
    s_add_u32 s4, s95, s87
    buffer_load_dwordx4 v[132:135], v27, s[48:51], s4 offen sc1
    s_add_u32 s87, s87, 1024
    s_cmp_eq_u32 s87, 27648
    s_cselect_b32 s87, 0, s87
    s_add_u32 m0, s93, 10240
    s_add_u32 s4, s10, s71
    buffer_load_dwordx4 v27, s[48:51], s4 offen sc1 lds
    s_waitcnt vmcnt(13)
    v_mfma_f32_32x32x16_bf16 v[176:191], v[156:159], v[168:171], v[176:191]
    s_add_u32 s4, s80, s86
    buffer_load_dwordx4 v[136:139], v27, s[48:51], s4 offen sc1
    v_mfma_f32_32x32x16_bf16 v[224:239], v[156:159], v[172:175], v[224:239]
    s_add_u32 s4, s81, s86
    buffer_load_dwordx4 v[140:143], v27, s[48:51], s4 offen sc1
    v_mfma_f32_32x32x16_bf16 v[192:207], v[160:163], v[168:171], v[192:207]
    s_add_u32 s4, s82, s86
    buffer_load_dwordx4 v[144:147], v27, s[48:51], s4 offen sc1
    s_add_u32 s86, s86, 1024
    s_cmp_eq_u32 s86, 27648
    s_cselect_b32 s86, 0, s86
    v_mfma_f32_32x32x16_bf16 v[240:255], v[160:163], v[172:175], v[240:255]
    s_add_u32 s4, s94, s87
    buffer_load_dwordx4 v[148:151], v27, s[48:51], s4 offen sc1
    v_mfma_f32_32x32x16_bf16 v[208:223], v[164:167], v[168:171], v[208:223]
    s_add_u32 s4, s95, s87
    buffer_load_dwordx4 v[152:155], v27, s[48:51], s4 offen sc1
    s_add_u32 s87, s87, 1024
    s_cmp_eq_u32 s87, 27648
    s_cselect_b32 s87, 0, s87
    s_add_u32 m0, s93, 11264
    s_add_u32 s4, s11, s71
    buffer_load_dwordx4 v27, s[48:51], s4 offen sc1 lds
    s_add_u32 s71, s71, 1024
    s_cmp_eq_u32 s71, 10240
    s_cselect_b32 s71, 0, s71
    s_waitcnt vmcnt(13)
    v_mfma_f32_32x32x16_bf16 v[176:191], v[96:99], v[108:111], v[176:191]
    s_add_u32 s4, s80, s86
    buffer_load_dwordx4 v[156:159], v27, s[48:51], s4 offen sc1
    v_mfma_f32_32x32x16_bf16 v[224:239], v[96:99], v[112:115], v[224:239]
    s_add_u32 s4, s81, s86
    buffer_load_dwordx4 v[160:163], v27, s[48:51], s4 offen sc1
    v_mfma_f32_32x32x16_bf16 v[192:207], v[100:103], v[108:111], v[192:207]
    s_add_u32 s4, s82, s86
    buffer_load_dwordx4 v[164:167], v27, s[48:51], s4 offen sc1
    s_add_u32 s86, s86, 1024
    s_cmp_eq_u32 s86, 27648
    s_cselect_b32 s86, 0, s86
    v_mfma_f32_32x32x16_bf16 v[240:255], v[100:103], v[112:115], v[240:255]
    s_add_u32 s4, s94, s87
    buffer_load_dwordx4 v[168:171], v27, s[48:51], s4 offen sc1
    v_mfma_f32_32x32x16_bf16 v[208:223], v[104:107], v[108:111], v[208:223]
    s_add_u32 s4, s95, s87
    buffer_load_dwordx4 v[172:175], v27, s[48:51], s4 offen sc1
    s_add_u32 s87, s87, 1024
    s_cmp_eq_u32 s87, 27648
    s_cselect_b32 s87, 0, s87
    s_add_u32 m0, s93, 12288
    s_add_u32 s4, s83, s71
    buffer_load_dwordx4 v27, s[48:51], s4 offen sc1 lds
    s_waitcnt vmcnt(13)
    v_mfma_f32_32x32x16_bf16 v[176:191], v[116:119], v[128:131], v[176:191]
    s_add_u32 s4, s80, s86
    buffer_load_dwordx4 v[96:99], v27, s[48:51], s4 offen sc1
    v_mfma_f32_32x32x16_bf16 v[224:239], v[116:119], v[132:135], v[224:239]
    s_add_u32 s4, s81, s86
    buffer_load_dwordx4 v[100:103], v27, s[48:51], s4 offen sc1
    v_mfma_f32_32x32x16_bf16 v[192:207], v[120:123], v[128:131], v[192:207]
    s_add_u32 s4, s82, s86
    buffer_load_dwordx4 v[104:107], v27, s[48:51], s4 offen sc1
    s_add_u32 s86, s86, 1024
    s_cmp_eq_u32 s86, 27648
    s_cselect_b32 s86, 0, s86
    v_mfma_f32_32x32x16_bf16 v[240:255], v[120:123], v[132:135], v[240:255]
    s_add_u32 s4, s94, s87
    buffer_load_dwordx4 v[108:111], v27, s[48:51], s4 offen sc1
    v_mfma_f32_32x32x16_bf16 v[208:223], v[124:127], v[128:131], v[208:223]
    s_add_u32 s4, s95, s87
    buffer_load_dwordx4 v[112:115], v27, s[48:51], s4 offen sc1
    s_add_u32 s87, s87, 1024
    s_cmp_eq_u32 s87, 27648
    s_cselect_b32 s87, 0, s87
    s_add_u32 m0, s93, 13312
    s_add_u32 s4, s10, s71
    buffer_load_dwordx4 v27, s[48:51], s4 offen sc1 lds
    s_waitcnt vmcnt(13)
    v_mfma_f32_32x32x16_bf16 v[176:191], v[136:139], v[148:151], v[176:191]
    s_add_u32 s4, s80, s86
    buffer_load_dwordx4 v[116:119], v27, s[48:51], s4 offen sc1
    v_mfma_f32_32x32x16_bf16 v[224:239], v[136:139], v[152:155], v[224:239]
    s_add_u32 s4, s81, s86
    buffer_load_dwordx4 v[120:123], v27, s[48:51], s4 offen sc1
    v_mfma_f32_32x32x16_bf16 v[192:207], v[140:143], v[148:151], v[192:207]
    s_add_u32 s4, s82, s86
    buffer_load_dwordx4 v[124:127], v27, s[48:51], s4 offen sc1
    s_add_u32 s86, s86, 1024
    s_cmp_eq_u32 s86, 27648
    s_cselect_b32 s86, 0, s86
    v_mfma_f32_32x32x16_bf16 v[240:255], v[140:143], v[152:155], v[240:255]
    s_add_u32 s4, s94, s87
    buffer_load_dwordx4 v[128:131], v27, s[48:51], s4 offen sc1
    v_mfma_f32_32x32x16_bf16 v[208:223], v[144:147], v[148:151], v[208:223]
    s_add_u32 s4, s95, s87
    buffer_load_dwordx4 v[132:135], v27, s[48:51], s4 offen sc1
    s_add_u32 s87, s87, 1024
    s_cmp_eq_u32 s87, 27648
    s_cselect_b32 s87, 0, s87
    s_add_u32 m0, s93, 14336
    s_add_u32 s4, s11, s71
    buffer_load_dwordx4 v27, s[48:51], s4 offen sc1 lds
    s_add_u32 s71, s71, 1024
    s_cmp_eq_u32 s71, 10240
    s_cselect_b32 s71, 0, s71
    s_waitcnt vmcnt(13)
    v_mfma_f32_32x32x16_bf16 v[176:191], v[156:159], v[168:171], v[176:191]
    s_add_u32 s4, s80, s86
    buffer_load_dwordx4 v[136:139], v27, s[48:51], s4 offen sc1
    v_mfma_f32_32x32x16_bf16 v[224:239], v[156:159], v[172:175], v[224:239]
    s_add_u32 s4, s81, s86
    buffer_load_dwordx4 v[140:143], v27, s[48:51], s4 offen sc1
    v_mfma_f32_32x32x16_bf16 v[192:207], v[160:163], v[168:171], v[192:207]
    s_add_u32 s4, s82, s86
    buffer_load_dwordx4 v[144:147], v27, s[48:51], s4 offen sc1
    s_add_u32 s86, s86, 1024
    s_cmp_eq_u32 s86, 27648
    s_cselect_b32 s86, 0, s86
    v_mfma_f32_32x32x16_bf16 v[240:255], v[160:163], v[172:175], v[240:255]
    s_add_u32 s4, s94, s87
    buffer_load_dwordx4 v[148:151], v27, s[48:51], s4 offen sc1
    v_mfma_f32_32x32x16_bf16 v[208:223], v[164:167], v[168:171], v[208:223]
    s_add_u32 s4, s95, s87
    buffer_load_dwordx4 v[152:155], v27, s[48:51], s4 offen sc1
    s_add_u32 s87, s87, 1024
    s_cmp_eq_u32 s87, 27648
    s_cselect_b32 s87, 0, s87
    s_add_u32 m0, s93, 15360
    s_add_u32 s4, s83, s71
    buffer_load_dwordx4 v27, s[48:51], s4 offen sc1 lds
    s_waitcnt vmcnt(13)
    v_mfma_f32_32x32x16_bf16 v[176:191], v[96:99], v[108:111], v[176:191]
    s_add_u32 s4, s80, s86
    buffer_load_dwordx4 v[156:159], v27, s[48:51], s4 offen sc1
    v_mfma_f32_32x32x16_bf16 v[224:239], v[96:99], v[112:115], v[224:239]
    s_add_u32 s4, s81, s86
    buffer_load_dwordx4 v[160:163], v27, s[48:51], s4 offen sc1
    v_mfma_f32_32x32x16_bf16 v[192:207], v[100:103], v[108:111], v[192:207]
    s_add_u32 s4, s82, s86
    buffer_load_dwordx4 v[164:167], v27, s[48:51], s4 offen sc1
    s_add_u32 s86, s86, 1024
    s_cmp_eq_u32 s86, 27648
    s_cselect_b32 s86, 0, s86
    v_mfma_f32_32x32x16_bf16 v[240:255], v[100:103], v[112:115], v[240:255]
    s_add_u32 s4, s94, s87
    buffer_load_dwordx4 v[168:171], v27, s[48:51], s4 offen sc1
    v_mfma_f32_32x32x16_bf16 v[208:223], v[104:107], v[108:111], v[208:223]
    s_add_u32 s4, s95, s87
    buffer_load_dwordx4 v[172:175], v27, s[48:51], s4 offen sc1
    s_add_u32 s87, s87, 1024
    s_cmp_eq_u32 s87, 27648
    s_cselect_b32 s87, 0, s87
    s_add_u32 m0, s93, 16384
    s_add_u32 s4, s10, s71
    buffer_load_dwordx4 v27, s[48:51], s4 offen sc1 lds
    s_waitcnt vmcnt(13)
    v_mfma_f32_32x32x16_bf16 v[176:191], v[116:119], v[128:131], v[176:191]
    s_add_u32 s4, s80, s86
    buffer_load_dwordx4 v[96:99], v27, s[48:51], s4 offen sc1
    v_mfma_f32_32x32x16_bf16 v[224:239], v[116:119], v[132:135], v[224:239]
    s_add_u32 s4, s81, s86
    buffer_load_dwordx4 v[100:103], v27, s[48:51], s4 offen sc1
    v_mfma_f32_32x32x16_bf16 v[192:207], v[120:123], v[128:131], v[192:207]
    s_add_u32 s4, s82, s86
    buffer_load_dwordx4 v[104:107], v27, s[48:51], s4 offen sc1
    s_add_u32 s86, s86, 1024
    s_cmp_eq_u32 s86, 27648
    s_cselect_b32 s86, 0, s86
    v_mfma_f32_32x32x16_bf16 v[240:255], v[120:123], v[132:135], v[240:255]
    s_add_u32 s4, s94, s87
    buffer_load_dwordx4 v[108:111], v27, s[48:51], s4 offen sc1
    v_mfma_f32_32x32x16_bf16 v[208:223], v[124:127], v[128:131], v[208:223]
    s_add_u32 s4, s95, s87
    buffer_load_dwordx4 v[112:115], v27, s[48:51], s4 offen sc1
    s_add_u32 s87, s87, 1024
    s_cmp_eq_u32 s87, 27648
    s_cselect_b32 s87, 0, s87
    s_add_u32 m0, s93, 17408
    s_add_u32 s4, s11, s71
    buffer_load_dwordx4 v27, s[48:51], s4 offen sc1 lds
    s_add_u32 s71, s71, 1024
    s_cmp_eq_u32 s71, 10240
    s_cselect_b32 s71, 0, s71
    s_waitcnt vmcnt(13)
    v_mfma_f32_32x32x16_bf16 v[176:191], v[136:139], v[148:151], v[176:191]
    s_add_u32 s4, s80, s86
    buffer_load_dwordx4 v[116:119], v27, s[48:51], s4 offen sc1
    v_mfma_f32_32x32x16_bf16 v[224:239], v[136:139], v[152:155], v[224:239]
    s_add_u32 s4, s81, s86
    buffer_load_dwordx4 v[120:123], v27, s[48:51], s4 offen sc1
    v_mfma_f32_32x32x16_bf16 v[192:207], v[140:143], v[148:151], v[192:207]
    s_add_u32 s4, s82, s86
    buffer_load_dwordx4 v[124:127], v27, s[48:51], s4 offen sc1
    s_add_u32 s86, s86, 1024
    s_cmp_eq_u32 s86, 27648
    s_cselect_b32 s86, 0, s86
    v_mfma_f32_32x32x16_bf16 v[240:255], v[140:143], v[152:155], v[240:255]
    s_add_u32 s4, s94, s87
    buffer_load_dwordx4 v[128:131], v27, s[48:51], s4 offen sc1
    v_mfma_f32_32x32x16_bf16 v[208:223], v[144:147], v[148:151], v[208:223]
    s_add_u32 s4, s95, s87
    buffer_load_dwordx4 v[132:135], v27, s[48:51], s4 offen sc1
    s_add_u32 s87, s87, 1024
    s_cmp_eq_u32 s87, 27648
    s_cselect_b32 s87, 0, s87
    s_lshl_b32 s4, s76, 12
    s_lshl_b32 s5, s3, 10
    s_add_u32 s4, s4, s5
    s_add_u32 s98, s4, 0xc0000
    s_mov_b32 s66, 0xff
    s_mov_b32 s67, 0
    s_mov_b64 exec, s[66:67]
    buffer_load_dword v12, v47, s[48:51], s98 offen sc1
    s_mov_b64 exec, -1
    s_waitcnt vmcnt(13)
    v_mfma_f32_32x32x16_bf16 v[176:191], v[156:159], v[168:171], v[176:191]
    s_add_u32 s4, s80, s86
    buffer_load_dwordx4 v[136:139], v27, s[48:51], s4 offen sc1
    v_mfma_f32_32x32x16_bf16 v[224:239], v[156:159], v[172:175], v[224:239]
    s_add_u32 s4, s81, s86
    buffer_load_dwordx4 v[140:143], v27, s[48:51], s4 offen sc1
    v_mfma_f32_32x32x16_bf16 v[192:207], v[160:163], v[168:171], v[192:207]
    s_add_u32 s4, s82, s86
    buffer_load_dwordx4 v[144:147], v27, s[48:51], s4 offen sc1
    s_add_u32 s86, s86, 1024
    s_cmp_eq_u32 s86, 27648
    s_cselect_b32 s86, 0, s86
    v_mfma_f32_32x32x16_bf16 v[240:255], v[160:163], v[172:175], v[240:255]
    s_add_u32 s4, s94, s87
    buffer_load_dwordx4 v[148:151], v27, s[48:51], s4 offen sc1
    v_mfma_f32_32x32x16_bf16 v[208:223], v[164:167], v[168:171], v[208:223]
    s_add_u32 s4, s95, s87
    buffer_load_dwordx4 v[152:155], v27, s[48:51], s4 offen sc1
    s_add_u32 s87, s87, 1024
    s_cmp_eq_u32 s87, 27648
    s_cselect_b32 s87, 0, s87
    s_waitcnt vmcnt(5)
    s_setprio 3
    v_cmp_eq_u32 vcc, s64, v12
    s_nop 0
    s_and_b64 s[68:69], vcc, s[66:67]
    s_cmp_eq_u64 s[68:69], s[66:67]
    s_cbranch_scc0 L_g2_late
    v_mfma_f32_32x32x16_bf16 v[176:191], v[96:99], v[108:111], v[176:191]
    s_add_u32 s4, s96, 0
    buffer_load_dwordx4 v[156:159], v27, s[48:51], s4 offen offset:0 sc1
    v_mfma_f32_32x32x16_bf16 v[224:239], v[96:99], v[112:115], v[224:239]
    s_add_u32 s4, s97, 0
    buffer_load_dwordx4 v[160:163], v27, s[48:51], s4 offen offset:0 sc1
    v_mfma_f32_32x32x16_bf16 v[192:207], v[100:103], v[108:111], v[192:207]
    s_add_u32 s4, s96, 0
    buffer_load_dwordx4 v[164:167], v27, s[48:51], s4 offen offset:1024 sc1
    v_mfma_f32_32x32x16_bf16 v[240:255], v[100:103], v[112:115], v[240:255]
    s_add_u32 s4, s97, 0
    buffer_load_dwordx4 v[168:171], v27, s[48:51], s4 offen offset:1024 sc1
    v_mfma_f32_32x32x16_bf16 v[208:223], v[104:107], v[108:111], v[208:223]
    s_add_u32 s4, s96, 0
    buffer_load_dwordx4 v[172:175], v27, s[48:51], s4 offen offset:2048 sc1
    v_mfma_f32_32x32x16_bf16 v[176:191], v[116:119], v[128:131], v[176:191]
    s_add_u32 s4, s97, 0
    buffer_load_dwordx4 v[96:99], v27, s[48:51], s4 offen offset:2048 sc1
    v_mfma_f32_32x32x16_bf16 v[224:239], v[116:119], v[132:135], v[224:239]
    s_add_u32 s4, s96, 0
    buffer_load_dwordx4 v[100:103], v27, s[48:51], s4 offen offset:3072 sc1
    v_mfma_f32_32x32x16_bf16 v[192:207], v[120:123], v[128:131], v[192:207]
    s_add_u32 s4, s97, 0
    buffer_load_dwordx4 v[104:107], v27, s[48:51], s4 offen offset:3072 sc1
    v_mfma_f32_32x32x16_bf16 v[240:255], v[120:123], v[132:135], v[240:255]
    s_add_u32 s4, s96, 4096
    buffer_load_dwordx4 v[108:111], v27, s[48:51], s4 offen offset:0 sc1
    v_mfma_f32_32x32x16_bf16 v[208:223], v[124:127], v[128:131], v[208:223]
    s_add_u32 s4, s97, 4096
    buffer_load_dwordx4 v[112:115], v27, s[48:51], s4 offen offset:0 sc1
    s_waitcnt vmcnt(10)
    v_mfma_f32_32x32x16_bf16 v[176:191], v[136:139], v[148:151], v[176:191]
    s_add_u32 s4, s96, 4096
    buffer_load_dwordx4 v[116:119], v27, s[48:51], s4 offen offset:1024 sc1
    v_mfma_f32_32x32x16_bf16 v[224:239], v[136:139], v[152:155], v[224:239]
    s_add_u32 s4, s97, 4096
    buffer_load_dwordx4 v[120:123], v27, s[48:51], s4 offen offset:1024 sc1
    v_mfma_f32_32x32x16_bf16 v[192:207], v[140:143], v[148:151], v[192:207]
    s_add_u32 s4, s96, 4096
    buffer_load_dwordx4 v[124:127], v27, s[48:51], s4 offen offset:2048 sc1
    v_mfma_f32_32x32x16_bf16 v[240:255], v[140:143], v[152:155], v[240:255]
    s_add_u32 s4, s97, 4096
    buffer_load_dwordx4 v[128:131], v27, s[48:51], s4 offen offset:2048 sc1
    v_mfma_f32_32x32x16_bf16 v[208:223], v[144:147], v[148:151], v[208:223]
    s_add_u32 s4, s96, 4096
    buffer_load_dwordx4 v[132:135], v27, s[48:51], s4 offen offset:3072 sc1
    s_add_u32 s4, s97, 4096
    buffer_load_dwordx4 v[136:139], v27, s[48:51], s4 offen offset:3072 sc1
    s_add_u32 s4, s96, 8192
    buffer_load_dwordx4 v[140:143], v27, s[48:51], s4 offen offset:0 sc1
    s_add_u32 s4, s97, 8192
    buffer_load_dwordx4 v[144:147], v27, s[48:51], s4 offen offset:0 sc1
    s_add_u32 s4, s96, 8192
    buffer_load_dwordx4 v[148:151], v27, s[48:51], s4 offen offset:1024 sc1
    s_add_u32 s4, s97, 8192
    buffer_load_dwordx4 v[152:155], v27, s[48:51], s4 offen offset:1024 sc1
L_g3:
    s_waitcnt vmcnt(18)
    v_mfma_f32_32x32x16_bf16 v[176:191], v[48:51], v[156:159], v[176:191]
    v_mfma_f32_32x32x16_bf16 v[224:239], v[48:51], v[160:163], v[224:239]
    v_mfma_f32_32x32x16_bf16 v[192:207], v[52:55], v[156:159], v[192:207]
    v_mfma_f32_32x32x16_bf16 v[240:255], v[52:55], v[160:163], v[240:255]
    v_mfma_f32_32x32x16_bf16 v[208:223], v[56:59], v[156:159], v[208:223]
    ds_read_b128 v[48:51], v16 offset:0
    ds_read_b128 v[52:55], v16 offset:1024
    ds_read_b128 v[56:59], v16 offset:2048
    s_waitcnt vmcnt(16)
    v_mfma_f32_32x32x16_bf16 v[176:191], v[60:63], v[164:167], v[176:191]
    v_mfma_f32_32x32x16_bf16 v[224:239], v[60:63], v[168:171], v[224:239]
    v_mfma_f32_32x32x16_bf16 v[192:207], v[64:67], v[164:167], v[192:207]
    v_mfma_f32_32x32x16_bf16 v[240:255], v[64:67], v[168:171], v[240:255]
    v_mfma_f32_32x32x16_bf16 v[208:223], v[68:71], v[164:167], v[208:223]
    ds_read_b128 v[60:63], v16 offset:3072
    ds_read_b128 v[64:67], v16 offset:4096
    ds_read_b128 v[68:71], v16 offset:5120
    s_waitcnt vmcnt(14)
    v_mfma_f32_32x32x16_bf16 v[176:191], v[72:75], v[172:175], v[176:191]
    v_mfma_f32_32x32x16_bf16 v[224:239], v[72:75], v[96:99], v[224:239]
    v_mfma_f32_32x32x16_bf16 v[192:207], v[76:79], v[172:175], v[192:207]
    v_mfma_f32_32x32x16_bf16 v[240:255], v[76:79], v[96:99], v[240:255]
    v_mfma_f32_32x32x16_bf16 v[208:223], v[80:83], v[172:175], v[208:223]
    ds_read_b128 v[72:75], v16 offset:6144
    ds_read_b128 v[76:79], v16 offset:7168
    ds_read_b128 v[80:83], v16 offset:8192
    s_waitcnt vmcnt(12)
    v_mfma_f32_32x32x16_bf16 v[176:191], v[84:87], v[100:103], v[176:191]
    v_mfma_f32_32x32x16_bf16 v[224:239], v[84:87], v[104:107], v[224:239]
    v_mfma_f32_32x32x16_bf16 v[192:207], v[88:91], v[100:103], v[192:207]
    v_mfma_f32_32x32x16_bf16 v[240:255], v[88:91], v[104:107], v[240:255]
    v_mfma_f32_32x32x16_bf16 v[208:223], v[92:95], v[100:103], v[208:223]
    ds_read_b128 v[84:87], v16 offset:9216
    ds_read_b128 v[88:91], v16 offset:10240
    ds_read_b128 v[92:95], v16 offset:11264
    s_waitcnt vmcnt(10) lgkmcnt(9)
    v_mfma_f32_32x32x16_bf16 v[176:191], v[48:51], v[108:111], v[176:191]
    v_mfma_f32_32x32x16_bf16 v[224:239], v[48:51], v[112:115], v[224:239]
    v_mfma_f32_32x32x16_bf16 v[192:207], v[52:55], v[108:111], v[192:207]
    v_mfma_f32_32x32x16_bf16 v[240:255], v[52:55], v[112:115], v[240:255]
    v_mfma_f32_32x32x16_bf16 v[208:223], v[56:59], v[108:111], v[208:223]
    ds_read_b128 v[48:51], v16 offset:12288
    ds_read_b128 v[52:55], v16 offset:13312
    ds_read_b128 v[56:59], v16 offset:14336
    s_waitcnt vmcnt(8) lgkmcnt(9)
    v_mfma_f32_32x32x16_bf16 v[176:191], v[60:63], v[116:119], v[176:191]
    v_mfma_f32_32x32x16_bf16 v[224:239], v[60:63], v[120:123], v[224:239]
    v_mfma_f32_32x32x16_bf16 v[192:207], v[64:67], v[116:119], v[192:207]
    v_mfma_f32_32x32x16_bf16 v[240:255], v[64:67], v[120:123], v[240:255]
    v_mfma_f32_32x32x16_bf16 v[208:223], v[68:71], v[116:119], v[208:223]
    ds_read_b128 v[60:63], v16 offset:15360
    ds_read_b128 v[64:67], v16 offset:16384
    ds_read_b128 v[68:71], v16 offset:17408
    s_waitcnt vmcnt(6) lgkmcnt(9)
    v_mfma_f32_32x32x16_bf16 v[176:191], v[72:75], v[124:127], v[176:191]
    v_mfma_f32_32x32x16_bf16 v[224:239], v[72:75], v[128:131], v[224:239]
    v_mfma_f32_32x32x16_bf16 v[192:207], v[76:79], v[124:127], v[192:207]
    v_mfma_f32_32x32x16_bf16 v[240:255], v[76:79], v[128:131], v[240:255]
    v_mfma_f32_32x32x16_bf16 v[208:223], v[80:83], v[124:127], v[208:223]
    s_waitcnt vmcnt(4) lgkmcnt(6)
    v_mfma_f32_32x32x16_bf16 v[176:191], v[84:87], v[132:135], v[176:191]
    v_mfma_f32_32x32x16_bf16 v[224:239], v[84:87], v[136:139], v[224:239]
    v_mfma_f32_32x32x16_bf16 v[192:207], v[88:91], v[132:135], v[192:207]
    v_mfma_f32_32x32x16_bf16 v[240:255], v[88:91], v[136:139], v[240:255]
    v_mfma_f32_32x32x16_bf16 v[208:223], v[92:95], v[132:135], v[208:223]
    s_waitcnt vmcnt(0) lgkmcnt(0)
    v_mfma_f32_32x32x16_bf16 v[176:191], v[48:51], v[140:143], v[176:191]
    v_mfma_f32_32x32x16_bf16 v[176:191], v[60:63], v[148:151], v[176:191]
    v_mfma_f32_32x32x16_bf16 v[224:239], v[48:51], v[144:147], v[224:239]
    v_mfma_f32_32x32x16_bf16 v[224:239], v[60:63], v[152:155], v[224:239]
    v_mfma_f32_32x32x16_bf16 v[192:207], v[52:55], v[140:143], v[192:207]
    v_mfma_f32_32x32x16_bf16 v[192:207], v[64:67], v[148:151], v[192:207]
    s_nop 7
    ds_write_b128 v40, v[176:179] offset:0
    ds_write_b128 v41, v[180:183] offset:0
    v_mfma_f32_32x32x16_bf16 v[240:255], v[52:55], v[144:147], v[240:255]
    ds_write_b128 v42, v[184:187] offset:0
    ds_write_b128 v43, v[188:191] offset:0
    v_mfma_f32_32x32x16_bf16 v[240:255], v[64:67], v[152:155], v[240:255]
    ds_write_b128 v40, v[224:227] offset:12288
    ds_write_b128 v41, v[228:231] offset:12288
    v_mfma_f32_32x32x16_bf16 v[208:223], v[56:59], v[140:143], v[208:223]
    ds_write_b128 v42, v[232:235] offset:12288
    ds_write_b128 v43, v[236:239] offset:12288
    v_mfma_f32_32x32x16_bf16 v[208:223], v[68:71], v[148:151], v[208:223]
    ds_write_b128 v40, v[192:195] offset:4096
    ds_write_b128 v41, v[196:199] offset:4096
    ds_write_b128 v42, v[200:203] offset:4096
    ds_write_b128 v43, v[204:207] offset:4096
    s_nop 1
    ds_write_b128 v40, v[240:243] offset:16384
    ds_write_b128 v41, v[244:247] offset:16384
    ds_write_b128 v42, v[248:251] offset:16384
    ds_write_b128 v43, v[252:255] offset:16384
    s_nop 1
    ds_write_b128 v40, v[208:211] offset:8192
    ds_write_b128 v41, v[212:215] offset:8192
    ds_write_b128 v42, v[216:219] offset:8192
    ds_write_b128 v43, v[220:223] offset:8192
    s_waitcnt lgkmcnt(0)
    s_barrier
    ds_read_b128 v[64:67], v29 offset:0
    ds_read_b128 v[68:71], v29 offset:20480
    ds_read_b128 v[72:75], v29 offset:40960
    ds_read_b128 v[76:79], v44 offset:0
    ds_read_b128 v[80:83], v29 offset:4096
    ds_read_b128 v[84:87], v29 offset:24576
    ds_read_b128 v[88:91], v29 offset:45056
    ds_read_b128 v[92:95], v44 offset:4096
    ds_read_b128 v[96:99], v29 offset:8192
    ds_read_b128 v[100:103], v29 offset:28672
    ds_read_b128 v[104:107], v29 offset:49152
    ds_read_b128 v[108:111], v44 offset:8192
    ds_read_b128 v[112:115], v29 offset:12288
    ds_read_b128 v[116:119], v29 offset:32768
    ds_read_b128 v[120:123], v29 offset:53248
    ds_read_b128 v[124:127], v44 offset:12288
    ds_read_b128 v[128:131], v29 offset:16384
    ds_read_b128 v[132:135], v29 offset:36864
    ds_read_b128 v[136:139], v29 offset:57344
    ds_read_b128 v[140:143], v44 offset:16384
    s_mov_b32 s4, 0xffff0000
    v_lshlrev_b32 v48, 16, v30
    v_and_b32 v49, s4, v30
    v_lshlrev_b32 v50, 16, v31
    v_and_b32 v51, s4, v31
    s_waitcnt lgkmcnt(15)
    v_pk_add_f32 v[64:65], v[64:65], v[68:69]
    v_pk_add_f32 v[72:73], v[72:73], v[76:77]
    v_pk_add_f32 v[66:67], v[66:67], v[70:71]
    v_pk_add_f32 v[74:75], v[74:75], v[78:79]
    v_pk_add_f32 v[64:65], v[64:65], v[48:49]
    v_pk_add_f32 v[66:67], v[66:67], v[50:51]
    v_pk_add_f32 v[64:65], v[64:65], v[72:73]
    v_pk_add_f32 v[66:67], v[66:67], v[74:75]
    v_cvt_pk_bf16_f32 v68, v64, v65
    v_cvt_pk_bf16_f32 v69, v66, v67
    buffer_store_dwordx2 v[68:69], v28, s[56:59], s88 offen
    v_lshlrev_b32 v48, 16, v32
    v_and_b32 v49, s4, v32
    v_lshlrev_b32 v50, 16, v33
    v_and_b32 v51, s4, v33
    s_waitcnt lgkmcnt(12)
    v_pk_add_f32 v[80:81], v[80:81], v[84:85]
    v_pk_add_f32 v[88:89], v[88:89], v[92:93]
    v_pk_add_f32 v[82:83], v[82:83], v[86:87]
    v_pk_add_f32 v[90:91], v[90:91], v[94:95]
    v_pk_add_f32 v[80:81], v[80:81], v[48:49]
    v_pk_add_f32 v[82:83], v[82:83], v[50:51]
    v_pk_add_f32 v[80:81], v[80:81], v[88:89]
    v_pk_add_f32 v[82:83], v[82:83], v[90:91]
    v_cvt_pk_bf16_f32 v84, v80, v81
    v_cvt_pk_bf16_f32 v85, v82, v83
    buffer_store_dwordx2 v[84:85], v28, s[56:59], s89 offen
    v_lshlrev_b32 v48, 16, v34
    v_and_b32 v49, s4, v34
    v_lshlrev_b32 v50, 16, v35
    v_and_b32 v51, s4, v35
    s_waitcnt lgkmcnt(8)
    v_pk_add_f32 v[96:97], v[96:97], v[100:101]
    v_pk_add_f32 v[104:105], v[104:105], v[108:109]
    v_pk_add_f32 v[98:99], v[98:99], v[102:103]
    v_pk_add_f32 v[106:107], v[106:107], v[110:111]
    v_pk_add_f32 v[96:97], v[96:97], v[48:49]
    v_pk_add_f32 v[98:99], v[98:99], v[50:51]
    v_pk_add_f32 v[96:97], v[96:97], v[104:105]
    v_pk_add_f32 v[98:99], v[98:99], v[106:107]
    v_cvt_pk_bf16_f32 v100, v96, v97
    v_cvt_pk_bf16_f32 v101, v98, v99
    buffer_store_dwordx2 v[100:101], v28, s[56:59], s90 offen
    v_lshlrev_b32 v48, 16, v36
    v_and_b32 v49, s4, v36
    v_lshlrev_b32 v50, 16, v37
    v_and_b32 v51, s4, v37
    s_waitcnt lgkmcnt(4)
    v_pk_add_f32 v[112:113], v[112:113], v[116:117]
    v_pk_add_f32 v[120:121], v[120:121], v[124:125]
    v_pk_add_f32 v[114:115], v[114:115], v[118:119]
    v_pk_add_f32 v[122:123], v[122:123], v[126:127]
    v_pk_add_f32 v[112:113], v[112:113], v[48:49]
    v_pk_add_f32 v[114:115], v[114:115], v[50:51]
    v_pk_add_f32 v[112:113], v[112:113], v[120:121]
    v_pk_add_f32 v[114:115], v[114:115], v[122:123]
    v_cvt_pk_bf16_f32 v116, v112, v113
    v_cvt_pk_bf16_f32 v117, v114, v115
    buffer_store_dwordx2 v[116:117], v28, s[56:59], s91 offen
    v_lshlrev_b32 v48, 16, v38
    v_and_b32 v49, s4, v38
    v_lshlrev_b32 v50, 16, v39
    v_and_b32 v51, s4, v39
    s_waitcnt lgkmcnt(0)
    v_pk_add_f32 v[128:129], v[128:129], v[132:133]
    v_pk_add_f32 v[136:137], v[136:137], v[140:141]
    v_pk_add_f32 v[130:131], v[130:131], v[134:135]
    v_pk_add_f32 v[138:139], v[138:139], v[142:143]
    v_pk_add_f32 v[128:129], v[128:129], v[48:49]
    v_pk_add_f32 v[130:131], v[130:131], v[50:51]
    v_pk_add_f32 v[128:129], v[128:129], v[136:137]
    v_pk_add_f32 v[130:131], v[130:131], v[138:139]
    v_cvt_pk_bf16_f32 v132, v128, v129
    v_cvt_pk_bf16_f32 v133, v130, v131
    buffer_store_dwordx2 v[132:133], v28, s[56:59], s92 offen
    s_branch L_fin
L_g2_late:
    s_setprio 0
    v_mfma_f32_32x32x16_bf16 v[176:191], v[96:99], v[108:111], v[176:191]
    v_mfma_f32_32x32x16_bf16 v[224:239], v[96:99], v[112:115], v[224:239]
    v_mfma_f32_32x32x16_bf16 v[192:207], v[100:103], v[108:111], v[192:207]
    v_mfma_f32_32x32x16_bf16 v[240:255], v[100:103], v[112:115], v[240:255]
    v_mfma_f32_32x32x16_bf16 v[208:223], v[104:107], v[108:111], v[208:223]
    v_mfma_f32_32x32x16_bf16 v[176:191], v[116:119], v[128:131], v[176:191]
    v_mfma_f32_32x32x16_bf16 v[224:239], v[116:119], v[132:135], v[224:239]
    v_mfma_f32_32x32x16_bf16 v[192:207], v[120:123], v[128:131], v[192:207]
    v_mfma_f32_32x32x16_bf16 v[240:255], v[120:123], v[132:135], v[240:255]
    v_mfma_f32_32x32x16_bf16 v[208:223], v[124:127], v[128:131], v[208:223]
    s_waitcnt vmcnt(0)
    v_mfma_f32_32x32x16_bf16 v[176:191], v[136:139], v[148:151], v[176:191]
    s_mov_b32 s66, 0xff
    s_mov_b32 s67, 0
    s_mov_b64 exec, s[66:67]
    buffer_load_dword v12, v47, s[48:51], s98 offen sc1
    s_mov_b64 exec, -1
    v_mfma_f32_32x32x16_bf16 v[224:239], v[136:139], v[152:155], v[224:239]
    v_mfma_f32_32x32x16_bf16 v[192:207], v[140:143], v[148:151], v[192:207]
    v_mfma_f32_32x32x16_bf16 v[240:255], v[140:143], v[152:155], v[240:255]
    v_mfma_f32_32x32x16_bf16 v[208:223], v[144:147], v[148:151], v[208:223]
    s_mov_b32 s70, 40000
    s_waitcnt vmcnt(0)
    s_setprio 3
    s_waitcnt vmcnt(0)
    v_cmp_eq_u32 vcc, s64, v12
    s_nop 0
    s_and_b64 s[68:69], vcc, s[66:67]
    s_cmp_eq_u64 s[68:69], s[66:67]
    s_cbranch_scc1 L_poll10_done
    s_mov_b64 exec, s[66:67]
    buffer_load_dword v12, v47, s[48:51], s98 offen sc1
L_poll10:
    s_sleep 2
    buffer_load_dword v13, v47, s[48:51], s98 offen sc1
    s_waitcnt vmcnt(1)
    v_cmp_eq_u32 vcc, s64, v12
    s_nop 0
    s_cmp_eq_u64 vcc, s[66:67]
    s_cbranch_scc1 L_poll10_hit
    s_sleep 2
    buffer_load_dword v12, v47, s[48:51], s98 offen sc1
    s_waitcnt vmcnt(1)
    v_cmp_eq_u32 vcc, s64, v13
    s_nop 0
    s_cmp_eq_u64 vcc, s[66:67]
    s_cbranch_scc1 L_poll10_hit
    s_sub_u32 s70, s70, 1
    s_cmp_lg_u32 s70, 0
    s_cbranch_scc1 L_poll10
L_poll10_hit:
    s_mov_b64 exec, -1
L_poll10_done:
    s_setprio 3
    s_add_u32 s4, s96, 0
    buffer_load_dwordx4 v[156:159], v27, s[48:51], s4 offen offset:0 sc1
    s_add_u32 s4, s97, 0
    buffer_load_dwordx4 v[160:163], v27, s[48:51], s4 offen offset:0 sc1
    s_add_u32 s4, s96, 0
    buffer_load_dwordx4 v[164:167], v27, s[48:51], s4 offen offset:1024 sc1
    s_add_u32 s4, s97, 0
    buffer_load_dwordx4 v[168:171], v27, s[48:51], s4 offen offset:1024 sc1
    s_add_u32 s4, s96, 0
    buffer_load_dwordx4 v[172:175], v27, s[48:51], s4 offen offset:2048 sc1
    s_add_u32 s4, s97, 0
    buffer_load_dwordx4 v[96:99], v27, s[48:51], s4 offen offset:2048 sc1
    s_add_u32 s4, s96, 0
    buffer_load_dwordx4 v[100:103], v27, s[48:51], s4 offen offset:3072 sc1
    s_add_u32 s4, s97, 0
    buffer_load_dwordx4 v[104:107], v27, s[48:51], s4 offen offset:3072 sc1
    s_add_u32 s4, s96, 4096
    buffer_load_dwordx4 v[108:111], v27, s[48:51], s4 offen offset:0 sc1
    s_add_u32 s4, s97, 4096
    buffer_load_dwordx4 v[112:115], v27, s[48:51], s4 offen offset:0 sc1
    s_add_u32 s4, s96, 4096
    buffer_load_dwordx4 v[116:119], v27, s[48:51], s4 offen offset:1024 sc1
    s_add_u32 s4, s97, 4096
    buffer_load_dwordx4 v[120:123], v27, s[48:51], s4 offen offset:1024 sc1
    s_add_u32 s4, s96, 4096
    buffer_load_dwordx4 v[124:127], v27, s[48:51], s4 offen offset:2048 sc1
    s_add_u32 s4, s97, 4096
    buffer_load_dwordx4 v[128:131], v27, s[48:51], s4 offen offset:2048 sc1
    s_add_u32 s4, s96, 4096
    buffer_load_dwordx4 v[132:135], v27, s[48:51], s4 offen offset:3072 sc1
    s_add_u32 s4, s97, 4096
    buffer_load_dwordx4 v[136:139], v27, s[48:51], s4 offen offset:3072 sc1
    s_add_u32 s4, s96, 8192
    buffer_load_dwordx4 v[140:143], v27, s[48:51], s4 offen offset:0 sc1
    s_add_u32 s4, s97, 8192
    buffer_load_dwordx4 v[144:147], v27, s[48:51], s4 offen offset:0 sc1
    s_add_u32 s4, s96, 8192
    buffer_load_dwordx4 v[148:151], v27, s[48:51], s4 offen offset:1024 sc1
    s_add_u32 s4, s97, 8192
    buffer_load_dwordx4 v[152:155], v27, s[48:51], s4 offen offset:1024 sc1
    s_branch L_g3
L_fin:
L_end:
    s_endpgm
L_code_end:
.set CODE_BYTES, L_code_end - parallel_sum__grouped_kv_mqa__geglu_ffn__prompt_kernel - 256
.section .rodata,"a"
.p2align 6
.amdhsa_kernel parallel_sum__grouped_kv_mqa__geglu_ffn__prompt_kernel
  .amdhsa_next_free_vgpr 256
  .amdhsa_next_free_sgpr 102
  .amdhsa_accum_offset 256
  .amdhsa_group_segment_fixed_size 0
  .amdhsa_kernarg_size 96
  .amdhsa_user_sgpr_count 2
  .amdhsa_user_sgpr_kernarg_segment_ptr 1
  .amdhsa_system_sgpr_workgroup_id_x 1
.end_amdhsa_kernel
```
